```python
import torch

def _softmax(x, axis=-1):
    return torch.softmax(x, dim=axis)
def _gelu(x):
    return torch.nn.functional.gelu(x, approximate="tanh")
def _silu(x):
    return torch.nn.functional.silu(x)
def _sigmoid(x):
    return torch.sigmoid(x)
def _layernorm(x, axis=-1, eps=1e-5):
    m = x.mean(dim=axis, keepdim=True)
    v = x.var(dim=axis, keepdim=True, unbiased=False)
    return (x - m) / torch.sqrt(v + eps)
def _scatter_add(tgt, idx, src, axis=0):
    return tgt.clone().index_add_(axis, idx, src)
def _segment_sum(src, seg, n):
    out = torch.zeros((n,) + src.shape[1:], dtype=src.dtype)
    return out.index_add_(0, seg, src)
def _pad(x, pw):
    flat = tuple(v for pair in reversed(pw) for v in pair)
    return torch.nn.functional.pad(x, flat)

kernel_name = 'parallel_sum__sliding_local_dilated__dense_activation_silu__prompt'

def setup_inputs():

    _w = (lambda a: (lambda t: t.to(torch.bfloat16) if t.is_floating_point() else t)(torch.as_tensor(a)))
    def _A_setup():
        B, S, D = 1, 2048, 640
        return {
            "x": _w((lambda *s: torch.randn(*s, dtype=torch.bfloat16) * 0.05)(B, S, D)),
            "wqkv": _w((lambda *s: torch.randn(*s, dtype=torch.bfloat16) * 0.05)(D, 3 * D)),
            "wo": _w((lambda *s: torch.randn(*s, dtype=torch.bfloat16) * 0.05)(D, D)),
        }
    _A_in = _A_setup()

    def _B_setup():
        B, S, D, F = 1, 2048, 640, 1536
        return {
            "x": _w((lambda *s: torch.randn(*s, dtype=torch.bfloat16) * 0.05)(B, S, D)),
            "w1": _w((lambda *s: torch.randn(*s, dtype=torch.bfloat16) * 3.2)(D, F) * (D ** -0.5)),
            "w2": _w((lambda *s: torch.randn(*s, dtype=torch.bfloat16) * 0.4)(F, D) * (F ** -0.5)),
        }
    _B_in = _B_setup()

    return {
        "A_x": _A_in["x"],
        "A_wqkv": _A_in["wqkv"],
        "A_wo": _A_in["wo"],
        "B_x": _B_in["x"],
        "B_w1": _B_in["w1"],
        "B_w2": _B_in["w2"],
    }

def reference(A_x, A_wqkv, A_wo, B_x, B_w1, B_w2):
    def _A_ref(x, wqkv, wo):
        B, S, D = x.shape
        H = 32; Dh = D // H
        W, dil = 8, 2
        qkv = (lambda x, *d: x.permute(*d))((x @ wqkv).reshape(B, S, 3, H, Dh), 2, 0, 3, 1, 4)
        q, k, v = qkv[0], qkv[1], qkv[2]
        scale = Dh ** -0.5
        pos = torch.arange(S)
        off = torch.arange(W) * dil
        idx = pos[:, None] - off[None, :]
        mask = idx >= 0
        idx_c = torch.where(mask, idx, 0).reshape(-1)
        kg = k[:, :, idx_c, :].reshape(B, H, S, W, Dh)
        vg = v[:, :, idx_c, :].reshape(B, H, S, W, Dh)
        logits = torch.einsum("bhsd,bhswd->bhsw", q, kg) * scale
        logits = torch.where(mask[None, None, :, :], logits, -1e9)
        attn = _softmax(logits, axis=-1)
        o = torch.einsum("bhsw,bhswd->bhsd", attn, vg)
        return (lambda x, *d: x.permute(*d))(o, 0, 2, 1, 3).reshape(B, S, D) @ wo

    def _B_ref(x, w1, w2):
        h = torch.einsum("bsd,df->bsf", x, w1)
        h = _silu(h)
        out = torch.einsum("bsf,fd->bsd", h, w2)
        return out

    x = A_x
    xn = _layernorm(x, axis=-1)
    return x + _A_ref(xn, A_wqkv, A_wo) + _B_ref(xn, B_w1, B_w2)
```

```asm
; @launch grid=(256,1,1) block=(512,1,1) lds=163840
.amdgcn_target "amdgcn-amd-amdhsa--gfx950"
.text
.globl parallel_sum__sliding_local_dilated__dense_activation_silu__prompt_kernel
.p2align 8
.type parallel_sum__sliding_local_dilated__dense_activation_silu__prompt_kernel,@function
parallel_sum__sliding_local_dilated__dense_activation_silu__prompt_kernel:
    s_cmp_ge_u32 s2, 256
    s_cbranch_scc1 L_end
    s_load_dwordx4 s[4:7], s[0:1], 0
    s_load_dwordx8 s[12:19], s[0:1], 32
    s_load_dwordx2 s[8:9], s[0:1], 16
    s_load_dwordx2 s[20:21], s[0:1], 64
    v_lshrrev_b32 v1, 6, v0
    s_nop 0
    v_readfirstlane_b32 s22, v1
    v_and_b32 v0, 63, v0
    s_and_b32 s54, s2, 7
    s_lshr_b32 s53, s2, 3
    s_lshr_b32 s49, s54, 1
    s_lshl_b32 s49, s49, 2
    s_and_b32 s50, s53, 3
    s_add_u32 s23, s49, s50
    s_and_b32 s49, s54, 1
    s_lshl_b32 s49, s49, 2
    s_bfe_u32 s50, s53, 0x20002
    s_add_u32 s48, s49, s50
    s_lshr_b32 s49, s53, 4
    s_lshl_b32 s49, s49, 3
    s_add_u32 s3, s48, s49
    s_xor_b32 s10, s23, s48
    s_and_b32 s10, s10, 3
    s_sub_u32 s68, s22, 4
    v_lshrrev_b32 v1, 3, v0
    v_mul_u32_u24 v1, 1280, v1
    v_lshrrev_b32 v2, 4, v0
    v_and_b32 v3, 7, v0
    s_and_b32 s49, s3, 8
    s_add_u32 s49, s49, s22
    s_cmp_eq_u32 s49, 15
    s_cbranch_scc1 LFL_X
    s_cmp_ge_u32 s49, 12
    s_cbranch_scc1 LFL_W
    s_cmp_ge_u32 s49, 8
    s_cbranch_scc1 L_FC
    s_cmp_eq_u32 s49, 7
    s_cbranch_scc1 LQL_X
    s_cmp_lt_u32 s49, 4
    s_cbranch_scc1 L_QC
LQL_W:
    s_mul_i32 s51, s68, 320
    s_mov_b32 s50, 2185
    s_mul_i32 s55, s48, 160
    s_mul_i32 s59, s68, 5120
    s_and_b32 s56, s10, 3
    s_mul_i32 s49, s10, 122880
    s_add_u32 m0, s59, 78848
    s_add_u32 s49, s49, s55
    v_add_u32 v4, s51, v0
    v_mul_u32_u24 v5, s50, v4
    v_lshrrev_b32 v5, 16, v5
    v_mul_u32_u24 v8, 30, v5
    v_sub_u32 v6, v4, v8
    v_and_b32 v7, 12, v5
    v_add_u32 v7, v7, v5
    v_lshrrev_b32 v8, 4, v5
    v_mad_i32_i24 v7, v8, -12, v7
    v_mul_u32_u24 v7, 3840, v7
    v_mul_u32_u24 v8, 205, v6
    v_lshrrev_b32 v8, 11, v8
    v_mul_u32_u24 v8, 1120, v8
    v_add_u32 v7, v7, v8
    v_lshl_add_u32 v10, v6, 4, v7
    s_waitcnt lgkmcnt(0)
    s_mov_b32 s28, s6
    s_mov_b32 s29, s7
    s_mov_b32 s30, 2457600
    s_mov_b32 s31, 0x20000
    buffer_load_dwordx4 v10, s[28:31], s49 offen offset:0 lds
    v_add_u32 v4, 64, v4
    v_mul_u32_u24 v5, s50, v4
    v_lshrrev_b32 v5, 16, v5
    v_mul_u32_u24 v8, 30, v5
    v_sub_u32 v6, v4, v8
    v_and_b32 v7, 12, v5
    v_add_u32 v7, v7, v5
    v_lshrrev_b32 v8, 4, v5
    v_mad_i32_i24 v7, v8, -12, v7
    v_mul_u32_u24 v7, 3840, v7
    v_mul_u32_u24 v8, 205, v6
    v_lshrrev_b32 v8, 11, v8
    v_mul_u32_u24 v8, 1120, v8
    v_add_u32 v7, v7, v8
    v_lshl_add_u32 v11, v6, 4, v7
    v_subrev_u32 v11, 1024, v11
    buffer_load_dwordx4 v11, s[28:31], s49 offen offset:1024 lds
    v_add_u32 v4, 64, v4
    v_mul_u32_u24 v5, s50, v4
    v_lshrrev_b32 v5, 16, v5
    v_mul_u32_u24 v8, 30, v5
    v_sub_u32 v6, v4, v8
    v_and_b32 v7, 12, v5
    v_add_u32 v7, v7, v5
    v_lshrrev_b32 v8, 4, v5
    v_mad_i32_i24 v7, v8, -12, v7
    v_mul_u32_u24 v7, 3840, v7
    v_mul_u32_u24 v8, 205, v6
    v_lshrrev_b32 v8, 11, v8
    v_mul_u32_u24 v8, 1120, v8
    v_add_u32 v7, v7, v8
    v_lshl_add_u32 v12, v6, 4, v7
    v_subrev_u32 v12, 2048, v12
    buffer_load_dwordx4 v12, s[28:31], s49 offen offset:2048 lds
    v_add_u32 v4, 64, v4
    v_mul_u32_u24 v5, s50, v4
    v_lshrrev_b32 v5, 16, v5
    v_mul_u32_u24 v8, 30, v5
    v_sub_u32 v6, v4, v8
    v_and_b32 v7, 12, v5
    v_add_u32 v7, v7, v5
    v_lshrrev_b32 v8, 4, v5
    v_mad_i32_i24 v7, v8, -12, v7
    v_mul_u32_u24 v7, 3840, v7
    v_mul_u32_u24 v8, 205, v6
    v_lshrrev_b32 v8, 11, v8
    v_mul_u32_u24 v8, 1120, v8
    v_add_u32 v7, v7, v8
    v_lshl_add_u32 v13, v6, 4, v7
    v_subrev_u32 v13, 3072, v13
    buffer_load_dwordx4 v13, s[28:31], s49 offen offset:3072 lds
    v_add_u32 v4, 64, v4
    v_mul_u32_u24 v5, s50, v4
    v_lshrrev_b32 v5, 16, v5
    v_mul_u32_u24 v8, 30, v5
    v_sub_u32 v6, v4, v8
    v_and_b32 v7, 12, v5
    v_add_u32 v7, v7, v5
    v_lshrrev_b32 v8, 4, v5
    v_mad_i32_i24 v7, v8, -12, v7
    v_mul_u32_u24 v7, 3840, v7
    v_mul_u32_u24 v8, 205, v6
    v_lshrrev_b32 v8, 11, v8
    v_mul_u32_u24 v8, 1120, v8
    v_add_u32 v7, v7, v8
    v_lshl_add_u32 v14, v6, 4, v7
    s_add_u32 m0, s59, 82944
    s_nop 0
    buffer_load_dwordx4 v14, s[28:31], s49 offen offset:0 lds
    s_xor_b32 s49, s10, 1
    s_mul_i32 s49, s49, 122880
    s_add_u32 m0, s59, 94208
    s_add_u32 s49, s49, s55
    buffer_load_dwordx4 v10, s[28:31], s49 offen offset:0 lds
    buffer_load_dwordx4 v11, s[28:31], s49 offen offset:1024 lds
    buffer_load_dwordx4 v12, s[28:31], s49 offen offset:2048 lds
    buffer_load_dwordx4 v13, s[28:31], s49 offen offset:3072 lds
    s_add_u32 m0, s59, 98304
    s_nop 0
    buffer_load_dwordx4 v14, s[28:31], s49 offen lds
    s_mov_b64 s[60:61], s[12:13]
    v_lshlrev_b32 v2, 1, v2
    v_xor_b32 v2, v2, v3
    v_lshl_add_u32 v26, v2, 4, v1
    v_add_u32 v27, 9216, v26
    v_lshlrev_b32 v20, 4, v0
    v_lshlrev_b32 v21, 2, v0
    v_mov_b32 v28, 0
    v_mov_b32 v24, 0
    s_mov_b32 s58, 0
    s_mov_b32 s36, s20
    s_mov_b32 s37, s21
    s_mov_b32 s38, 11640832
    s_mov_b32 s39, 0x20000
    s_mov_b32 s40, s14
    s_mov_b32 s41, s15
    s_mov_b32 s42, 1966080
    s_mov_b32 s43, 0x20000
    s_mov_b32 s32, s8
    s_mov_b32 s33, s9
    s_mov_b32 s34, 819200
    s_mov_b32 s35, 0x20000
    s_mov_b32 s72, s18
    s_mov_b32 s73, s19
    s_mov_b32 s74, 256
    s_mov_b32 s75, 0x20000
    s_lshr_b32 s50, s53, 1
    s_and_b32 s51, s53, 1
    s_add_u32 s51, s51, 6
    s_cmp_ge_u32 s53, 11
    s_cselect_b32 s52, 4, 3
    s_cselect_b32 s49, 8, 3
    s_sub_u32 s49, s53, s49
    s_cmp_lt_u32 s53, 6
    s_cselect_b32 s71, s50, s52
    s_cselect_b32 s70, s51, s49
    s_lshl_b32 s70, s70, 2
    s_lshr_b32 s50, s70, 1
    s_mul_i32 s11, s71, 3
    s_add_u32 s11, s11, s50
    s_lshr_b32 s49, s54, 1
    s_lshl_b32 s49, s49, 5
    s_add_u32 s70, s70, s49
    s_and_b32 s49, s54, 1
    s_mul_i32 s49, s49, 5
    s_add_u32 s71, s71, s49
    s_and_b32 s11, s11, 0
    s_lshl_b32 s50, s71, 7
    s_lshr_b32 s51, s68, 1
    s_mul_i32 s49, s51, 122880
    s_and_b32 s52, s68, 1
    s_mul_i32 s52, s52, 20480
    s_add_u32 s64, s50, s49
    s_add_u32 s64, s64, s52
    s_mul_i32 s49, s68, 20480
    s_add_u32 s65, s50, s49
    s_mul_i32 s51, s51, 204800
    s_lshr_b32 s52, s52, 1
    s_add_u32 s51, s51, s52
    s_add_u32 s66, s50, s51
    s_add_u32 s66, s66, 81920
    s_lshl_b32 s69, s68, 11
    v_add_u32 v29, s69, v20
    v_add_u32 v29, 23552, v29
    v_add_u32 v30, 0x10000, v29
    s_mov_b32 s24, s4
    s_mov_b32 s25, s5
    s_mov_b32 s26, 2621440
    s_mov_b32 s27, 0x20000
    s_xor_b32 s49, s11, 0
    s_mul_i32 s50, s49, 245760
    s_add_u32 s12, s50, s64
    s_mul_i32 s50, s49, 102400
    s_add_u32 s4, s50, s65
    s_xor_b32 s49, s11, 1
    s_mul_i32 s50, s49, 245760
    s_add_u32 s13, s50, s64
    s_mul_i32 s50, s49, 102400
    s_add_u32 s5, s50, s65
    s_xor_b32 s49, s11, 2
    s_mul_i32 s50, s49, 245760
    s_add_u32 s14, s50, s64
    s_mul_i32 s50, s49, 102400
    s_add_u32 s6, s50, s65
    s_xor_b32 s49, s11, 3
    s_mul_i32 s50, s49, 245760
    s_add_u32 s15, s50, s64
    s_mul_i32 s50, s49, 102400
    s_add_u32 s7, s50, s65
    s_xor_b32 s49, s11, 4
    s_mul_i32 s50, s49, 245760
    s_add_u32 s16, s50, s64
    s_mul_i32 s50, s49, 102400
    s_add_u32 s44, s50, s65
    s_xor_b32 s49, s11, 5
    s_mul_i32 s50, s49, 245760
    s_add_u32 s17, s50, s64
    s_mul_i32 s50, s49, 102400
    s_add_u32 s45, s50, s65
    s_xor_b32 s49, s11, 6
    s_mul_i32 s50, s49, 245760
    s_add_u32 s18, s50, s64
    s_mul_i32 s50, s49, 102400
    s_add_u32 s46, s50, s65
    s_xor_b32 s49, s11, 7
    s_mul_i32 s50, s49, 245760
    s_add_u32 s19, s50, s64
    s_mul_i32 s50, s49, 102400
    s_add_u32 s47, s50, s65
    s_mul_i32 s62, s48, 15360
    s_mul_i32 s49, s68, 5120
    s_add_u32 s62, s62, s49
    s_add_u32 s62, s62, 9183232
    v_and_b32 v4, 15, v0
    v_lshlrev_b32 v4, 14, v4
    s_mov_b32 s61, 0xffff
    s_add_u32 s49, s48, 8
    s_lshl_b32 s49, s49, 10
    s_add_u32 s49, s49, 8921344
    v_add_u32 v32, s49, v4
    s_mov_b32 s57, 1044480
    v_mul_u32_u24 v4, 13108, v0
    v_lshrrev_b32 v4, 16, v4
    v_mul_u32_u24 v5, 5, v4
    v_sub_u32 v5, v0, v5
    s_and_b32 s51, s53, 15
    s_mul_i32 s51, s51, 3
    s_add_u32 s51, s51, s68
    s_mul_i32 s51, s51, 32
    s_lshr_b32 s52, s54, 1
    s_add_u32 s51, s51, s52
    s_add_u32 s51, s51, 0
    s_mul_i32 s51, s51, 1280
    s_and_b32 s52, s54, 1
    s_mul_i32 s52, s52, 640
    s_add_u32 s51, s51, s52
    v_mul_u32_u24 v4, 5120, v4
    v_lshl_add_u32 v4, v5, 7, v4
    v_add_u32 v4, s51, v4
    v_cmp_gt_u32 vcc, 40, v0
    v_mov_b32 v5, 0x7ffffff0
    s_nop 0
    v_cndmask_b32 v15, v5, v4, vcc
    v_mul_u32_u24 v4, 13108, v0
    v_lshrrev_b32 v4, 16, v4
    v_mul_u32_u24 v5, 5, v4
    v_sub_u32 v5, v0, v5
    s_and_b32 s51, s53, 15
    s_mul_i32 s51, s51, 3
    s_add_u32 s51, s51, s68
    s_mul_i32 s51, s51, 16
    s_lshr_b32 s52, s54, 1
    s_add_u32 s51, s51, s52
    s_add_u32 s51, s51, 0
    s_mul_i32 s51, s51, 1280
    s_and_b32 s52, s54, 1
    s_mul_i32 s52, s52, 640
    s_add_u32 s51, s51, s52
    v_mul_u32_u24 v4, 5120, v4
    v_lshl_add_u32 v4, v5, 7, v4
    v_add_u32 v4, s51, v4
    v_cmp_gt_u32 vcc, 20, v0
    v_mov_b32 v5, 0x7ffffff0
    s_nop 0
    v_cndmask_b32 v16, v5, v4, vcc
    s_waitcnt vmcnt(5)
    s_barrier
    s_xor_b32 s49, s10, 2
    s_mul_i32 s49, s49, 122880
    s_add_u32 m0, s59, 109568
    s_add_u32 s49, s49, s55
    buffer_load_dwordx4 v10, s[28:31], s49 offen offset:0 lds
    buffer_load_dwordx4 v11, s[28:31], s49 offen offset:1024 lds
    buffer_load_dwordx4 v12, s[28:31], s49 offen offset:2048 lds
    buffer_load_dwordx4 v13, s[28:31], s49 offen offset:3072 lds
    s_add_u32 m0, s59, 113664
    s_nop 0
    buffer_load_dwordx4 v14, s[28:31], s49 offen lds
    s_xor_b32 s49, s10, 3
    s_mul_i32 s49, s49, 122880
    s_add_u32 m0, s59, 124928
    s_add_u32 s49, s49, s55
    buffer_load_dwordx4 v10, s[28:31], s49 offen offset:0 lds
    buffer_load_dwordx4 v11, s[28:31], s49 offen offset:1024 lds
    buffer_load_dwordx4 v12, s[28:31], s49 offen offset:2048 lds
    buffer_load_dwordx4 v13, s[28:31], s49 offen offset:3072 lds
    s_add_u32 m0, s59, 129024
    s_nop 0
    buffer_load_dwordx4 v14, s[28:31], s49 offen lds
    s_waitcnt vmcnt(10)
    s_barrier
    s_xor_b32 s49, s10, 4
    s_mul_i32 s49, s49, 122880
    s_add_u32 m0, s59, 140288
    s_add_u32 s49, s49, s55
    buffer_load_dwordx4 v10, s[28:31], s49 offen offset:0 lds
    buffer_load_dwordx4 v11, s[28:31], s49 offen offset:1024 lds
    buffer_load_dwordx4 v12, s[28:31], s49 offen offset:2048 lds
    buffer_load_dwordx4 v13, s[28:31], s49 offen offset:3072 lds
    s_add_u32 m0, s59, 144384
    s_nop 0
    buffer_load_dwordx4 v14, s[28:31], s49 offen lds
    buffer_load_dword v17, v15, s[40:43], 0 offen
    s_waitcnt vmcnt(11)
    s_barrier
    s_xor_b32 s49, s10, 5
    s_mul_i32 s49, s49, 122880
    s_add_u32 m0, s59, 78848
    s_add_u32 s49, s49, s55
    buffer_load_dwordx4 v10, s[28:31], s49 offen offset:0 lds
    buffer_load_dwordx4 v11, s[28:31], s49 offen offset:1024 lds
    buffer_load_dwordx4 v12, s[28:31], s49 offen offset:2048 lds
    buffer_load_dwordx4 v13, s[28:31], s49 offen offset:3072 lds
    s_add_u32 m0, s59, 82944
    s_nop 0
    buffer_load_dwordx4 v14, s[28:31], s49 offen lds
    s_waitcnt vmcnt(11)
    s_barrier
    s_xor_b32 s49, s10, 6
    s_mul_i32 s49, s49, 122880
    s_add_u32 m0, s59, 94208
    s_add_u32 s49, s49, s55
    buffer_load_dwordx4 v10, s[28:31], s49 offen offset:0 lds
    buffer_load_dwordx4 v11, s[28:31], s49 offen offset:1024 lds
    buffer_load_dwordx4 v12, s[28:31], s49 offen offset:2048 lds
    buffer_load_dwordx4 v13, s[28:31], s49 offen offset:3072 lds
    s_add_u32 m0, s59, 98304
    s_nop 0
    buffer_load_dwordx4 v14, s[28:31], s49 offen lds
    s_waitcnt vmcnt(11)
    s_barrier
    s_xor_b32 s49, s10, 7
    s_mul_i32 s49, s49, 122880
    s_add_u32 m0, s59, 109568
    s_add_u32 s49, s49, s55
    buffer_load_dwordx4 v10, s[28:31], s49 offen offset:0 lds
    buffer_load_dwordx4 v11, s[28:31], s49 offen offset:1024 lds
    buffer_load_dwordx4 v12, s[28:31], s49 offen offset:2048 lds
    buffer_load_dwordx4 v13, s[28:31], s49 offen offset:3072 lds
    s_add_u32 m0, s59, 113664
    s_nop 0
    buffer_load_dwordx4 v14, s[28:31], s49 offen lds
    s_waitcnt vmcnt(10)
    s_barrier
    v_mov_b32 v33, 0
    ds_read_b32 v33, v33 offset:3040
    s_or_b32 exec_lo, s61, 1
    s_mov_b32 exec_hi, 0
    buffer_load_dword v24, v32, s[36:39], 0 offen sc1
    s_mov_b64 exec, -1
    s_xor_b32 s49, s10, 8
    s_mul_i32 s49, s49, 122880
    s_add_u32 m0, s59, 124928
    s_add_u32 s49, s49, s55
    buffer_load_dwordx4 v10, s[28:31], s49 offen offset:0 lds
    buffer_load_dwordx4 v11, s[28:31], s49 offen offset:1024 lds
    buffer_load_dwordx4 v12, s[28:31], s49 offen offset:2048 lds
    buffer_load_dwordx4 v13, s[28:31], s49 offen offset:3072 lds
    s_add_u32 m0, s59, 129024
    s_nop 0
    buffer_load_dwordx4 v14, s[28:31], s49 offen lds
    buffer_load_dword v17, v16, s[32:35], 0 offen
    s_waitcnt vmcnt(12)
    s_barrier
    s_xor_b32 s49, s10, 9
    s_mul_i32 s49, s49, 122880
    s_add_u32 m0, s59, 140288
    s_add_u32 s49, s49, s55
    buffer_load_dwordx4 v10, s[28:31], s49 offen offset:0 lds
    buffer_load_dwordx4 v11, s[28:31], s49 offen offset:1024 lds
    buffer_load_dwordx4 v12, s[28:31], s49 offen offset:2048 lds
    buffer_load_dwordx4 v13, s[28:31], s49 offen offset:3072 lds
    s_add_u32 m0, s59, 144384
    s_nop 0
    buffer_load_dwordx4 v14, s[28:31], s49 offen lds
    s_waitcnt vmcnt(11)
    s_barrier
    s_waitcnt lgkmcnt(0)
    v_readfirstlane_b32 s58, v33
    s_nop 1
    v_cmp_ne_u32 vcc, s58, v24
    s_nop 0
    s_and_b32 s61, s61, vcc_lo
    s_lshr_b32 s49, s61, 8
    s_or_b32 s49, s49, s61
    s_lshl_b32 s57, s49, 12
    s_or_b32 exec_lo, s61, 1
    s_mov_b32 exec_hi, 0
    buffer_load_dword v24, v32, s[36:39], 0 offen sc1
    s_mov_b64 exec, -1
    s_xor_b32 s49, s10, 10
    s_mul_i32 s49, s49, 122880
    s_add_u32 m0, s59, 78848
    s_add_u32 s49, s49, s55
    buffer_load_dwordx4 v10, s[28:31], s49 offen offset:0 lds
    buffer_load_dwordx4 v11, s[28:31], s49 offen offset:1024 lds
    buffer_load_dwordx4 v12, s[28:31], s49 offen offset:2048 lds
    buffer_load_dwordx4 v13, s[28:31], s49 offen offset:3072 lds
    s_add_u32 m0, s59, 82944
    s_nop 0
    buffer_load_dwordx4 v14, s[28:31], s49 offen lds
    s_waitcnt vmcnt(12)
    s_barrier
    s_xor_b32 s49, s10, 11
    s_mul_i32 s49, s49, 122880
    s_add_u32 m0, s59, 94208
    s_add_u32 s49, s49, s55
    buffer_load_dwordx4 v10, s[28:31], s49 offen offset:0 lds
    buffer_load_dwordx4 v11, s[28:31], s49 offen offset:1024 lds
    buffer_load_dwordx4 v12, s[28:31], s49 offen offset:2048 lds
    buffer_load_dwordx4 v13, s[28:31], s49 offen offset:3072 lds
    s_add_u32 m0, s59, 98304
    s_nop 0
    buffer_load_dwordx4 v14, s[28:31], s49 offen lds
    s_waitcnt vmcnt(10)
    s_barrier
    v_cmp_ne_u32 vcc, s58, v24
    s_nop 0
    s_and_b32 s61, s61, vcc_lo
    s_lshr_b32 s49, s61, 8
    s_or_b32 s49, s49, s61
    s_lshl_b32 s57, s49, 12
    s_or_b32 exec_lo, s61, 1
    s_mov_b32 exec_hi, 0
    buffer_load_dword v24, v32, s[36:39], 0 offen sc1
    s_mov_b64 exec, -1
    s_xor_b32 s49, s10, 12
    s_add_u32 m0, s59, 109568
    s_bitcmp1_b32 s57, s49
    s_cbranch_scc1 LQL_o12
    s_mul_i32 s49, s49, 122880
    s_add_u32 s49, s49, s62
    buffer_load_dwordx4 v20, s[36:39], s49 offen offset:0 sc1 lds
    buffer_load_dwordx4 v20, s[36:39], s49 offen offset:1024 sc1 lds
    buffer_load_dwordx4 v20, s[36:39], s49 offen offset:2048 sc1 lds
    buffer_load_dwordx4 v20, s[36:39], s49 offen offset:3072 sc1 lds
    s_add_u32 m0, s59, 113664
    s_add_u32 s49, s49, 4096
    buffer_load_dwordx4 v20, s[36:39], s49 offen sc1 lds
    s_branch LQL_e12
LQL_o12:
    s_mul_i32 s49, s49, 122880
    s_add_u32 s49, s49, s55
    buffer_load_dwordx4 v10, s[28:31], s49 offen offset:0 lds
    buffer_load_dwordx4 v11, s[28:31], s49 offen offset:1024 lds
    buffer_load_dwordx4 v12, s[28:31], s49 offen offset:2048 lds
    buffer_load_dwordx4 v13, s[28:31], s49 offen offset:3072 lds
    s_add_u32 m0, s59, 113664
    s_nop 0
    buffer_load_dwordx4 v14, s[28:31], s49 offen lds
LQL_e12:
    s_waitcnt vmcnt(11)
    s_barrier
    s_xor_b32 s49, s10, 13
    s_add_u32 m0, s59, 124928
    s_bitcmp1_b32 s57, s49
    s_cbranch_scc1 LQL_o13
    s_mul_i32 s49, s49, 122880
    s_add_u32 s49, s49, s62
    buffer_load_dwordx4 v20, s[36:39], s49 offen offset:0 sc1 lds
    buffer_load_dwordx4 v20, s[36:39], s49 offen offset:1024 sc1 lds
    buffer_load_dwordx4 v20, s[36:39], s49 offen offset:2048 sc1 lds
    buffer_load_dwordx4 v20, s[36:39], s49 offen offset:3072 sc1 lds
    s_add_u32 m0, s59, 129024
    s_add_u32 s49, s49, 4096
    buffer_load_dwordx4 v20, s[36:39], s49 offen sc1 lds
    s_branch LQL_e13
LQL_o13:
    s_mul_i32 s49, s49, 122880
    s_add_u32 s49, s49, s55
    buffer_load_dwordx4 v10, s[28:31], s49 offen offset:0 lds
    buffer_load_dwordx4 v11, s[28:31], s49 offen offset:1024 lds
    buffer_load_dwordx4 v12, s[28:31], s49 offen offset:2048 lds
    buffer_load_dwordx4 v13, s[28:31], s49 offen offset:3072 lds
    s_add_u32 m0, s59, 129024
    s_nop 0
    buffer_load_dwordx4 v14, s[28:31], s49 offen lds
LQL_e13:
    s_waitcnt vmcnt(10)
    s_barrier
    v_cmp_ne_u32 vcc, s58, v24
    s_nop 0
    s_and_b32 s61, s61, vcc_lo
    s_lshr_b32 s49, s61, 8
    s_or_b32 s49, s49, s61
    s_lshl_b32 s57, s49, 12
    s_xor_b32 s49, s10, 14
    s_add_u32 m0, s59, 140288
    s_bitcmp1_b32 s57, s49
    s_cbranch_scc1 LQL_o14
    s_mul_i32 s49, s49, 122880
    s_add_u32 s49, s49, s62
    buffer_load_dwordx4 v20, s[36:39], s49 offen offset:0 sc1 lds
    buffer_load_dwordx4 v20, s[36:39], s49 offen offset:1024 sc1 lds
    buffer_load_dwordx4 v20, s[36:39], s49 offen offset:2048 sc1 lds
    buffer_load_dwordx4 v20, s[36:39], s49 offen offset:3072 sc1 lds
    s_add_u32 m0, s59, 144384
    s_add_u32 s49, s49, 4096
    buffer_load_dwordx4 v20, s[36:39], s49 offen sc1 lds
    s_branch LQL_e14
LQL_o14:
    s_mul_i32 s49, s49, 122880
    s_add_u32 s49, s49, s55
    buffer_load_dwordx4 v10, s[28:31], s49 offen offset:0 lds
    buffer_load_dwordx4 v11, s[28:31], s49 offen offset:1024 lds
    buffer_load_dwordx4 v12, s[28:31], s49 offen offset:2048 lds
    buffer_load_dwordx4 v13, s[28:31], s49 offen offset:3072 lds
    s_add_u32 m0, s59, 144384
    s_nop 0
    buffer_load_dwordx4 v14, s[28:31], s49 offen lds
LQL_e14:
    s_waitcnt vmcnt(10)
    s_barrier
    s_or_b32 exec_lo, s61, 1
    s_mov_b32 exec_hi, 0
    buffer_load_dword v24, v32, s[36:39], 0 offen sc1
    s_mov_b64 exec, -1
    s_xor_b32 s49, s10, 15
    s_add_u32 m0, s59, 78848
    s_bitcmp1_b32 s57, s49
    s_cbranch_scc1 LQL_o15
    s_mul_i32 s49, s49, 122880
    s_add_u32 s49, s49, s62
    buffer_load_dwordx4 v20, s[36:39], s49 offen offset:0 sc1 lds
    buffer_load_dwordx4 v20, s[36:39], s49 offen offset:1024 sc1 lds
    buffer_load_dwordx4 v20, s[36:39], s49 offen offset:2048 sc1 lds
    buffer_load_dwordx4 v20, s[36:39], s49 offen offset:3072 sc1 lds
    s_add_u32 m0, s59, 82944
    s_add_u32 s49, s49, 4096
    buffer_load_dwordx4 v20, s[36:39], s49 offen sc1 lds
    s_branch LQL_e15
LQL_o15:
    s_mul_i32 s49, s49, 122880
    s_add_u32 s49, s49, s55
    buffer_load_dwordx4 v10, s[28:31], s49 offen offset:0 lds
    buffer_load_dwordx4 v11, s[28:31], s49 offen offset:1024 lds
    buffer_load_dwordx4 v12, s[28:31], s49 offen offset:2048 lds
    buffer_load_dwordx4 v13, s[28:31], s49 offen offset:3072 lds
    s_add_u32 m0, s59, 82944
    s_nop 0
    buffer_load_dwordx4 v14, s[28:31], s49 offen lds
LQL_e15:
    s_waitcnt vmcnt(11)
    s_barrier
    s_xor_b32 s49, s56, 16
    s_add_u32 m0, s59, 94208
    s_bitcmp1_b32 s57, s49
    s_cbranch_scc1 LQL_o16
    s_mul_i32 s49, s49, 122880
    s_add_u32 s49, s49, s62
    buffer_load_dwordx4 v20, s[36:39], s49 offen offset:0 sc1 lds
    buffer_load_dwordx4 v20, s[36:39], s49 offen offset:1024 sc1 lds
    buffer_load_dwordx4 v20, s[36:39], s49 offen offset:2048 sc1 lds
    buffer_load_dwordx4 v20, s[36:39], s49 offen offset:3072 sc1 lds
    s_add_u32 m0, s59, 98304
    s_add_u32 s49, s49, 4096
    buffer_load_dwordx4 v20, s[36:39], s49 offen sc1 lds
    s_branch LQL_e16
LQL_o16:
    s_mul_i32 s49, s49, 122880
    s_add_u32 s49, s49, s55
    buffer_load_dwordx4 v10, s[28:31], s49 offen offset:0 lds
    buffer_load_dwordx4 v11, s[28:31], s49 offen offset:1024 lds
    buffer_load_dwordx4 v12, s[28:31], s49 offen offset:2048 lds
    buffer_load_dwordx4 v13, s[28:31], s49 offen offset:3072 lds
    s_add_u32 m0, s59, 98304
    s_nop 0
    buffer_load_dwordx4 v14, s[28:31], s49 offen lds
LQL_e16:
    s_waitcnt vmcnt(10)
    s_barrier
    v_cmp_ne_u32 vcc, s58, v24
    s_nop 0
    s_and_b32 s61, s61, vcc_lo
    s_lshr_b32 s49, s61, 8
    s_or_b32 s49, s49, s61
    s_lshl_b32 s57, s49, 12
    s_xor_b32 s49, s56, 17
    s_add_u32 m0, s59, 109568
    s_bitcmp1_b32 s57, s49
    s_cbranch_scc1 LQL_o17
    s_mul_i32 s49, s49, 122880
    s_add_u32 s49, s49, s62
    buffer_load_dwordx4 v20, s[36:39], s49 offen offset:0 sc1 lds
    buffer_load_dwordx4 v20, s[36:39], s49 offen offset:1024 sc1 lds
    buffer_load_dwordx4 v20, s[36:39], s49 offen offset:2048 sc1 lds
    buffer_load_dwordx4 v20, s[36:39], s49 offen offset:3072 sc1 lds
    s_add_u32 m0, s59, 113664
    s_add_u32 s49, s49, 4096
    buffer_load_dwordx4 v20, s[36:39], s49 offen sc1 lds
    s_branch LQL_e17
LQL_o17:
    s_mul_i32 s49, s49, 122880
    s_add_u32 s49, s49, s55
    buffer_load_dwordx4 v10, s[28:31], s49 offen offset:0 lds
    buffer_load_dwordx4 v11, s[28:31], s49 offen offset:1024 lds
    buffer_load_dwordx4 v12, s[28:31], s49 offen offset:2048 lds
    buffer_load_dwordx4 v13, s[28:31], s49 offen offset:3072 lds
    s_add_u32 m0, s59, 113664
    s_nop 0
    buffer_load_dwordx4 v14, s[28:31], s49 offen lds
LQL_e17:
    s_waitcnt vmcnt(10)
    s_barrier
    s_xor_b32 s49, s56, 18
    s_add_u32 m0, s59, 124928
    s_bitcmp1_b32 s57, s49
    s_cbranch_scc1 LQL_o18
    s_mul_i32 s49, s49, 122880
    s_add_u32 s49, s49, s62
    buffer_load_dwordx4 v20, s[36:39], s49 offen offset:0 sc1 lds
    buffer_load_dwordx4 v20, s[36:39], s49 offen offset:1024 sc1 lds
    buffer_load_dwordx4 v20, s[36:39], s49 offen offset:2048 sc1 lds
    buffer_load_dwordx4 v20, s[36:39], s49 offen offset:3072 sc1 lds
    s_add_u32 m0, s59, 129024
    s_add_u32 s49, s49, 4096
    buffer_load_dwordx4 v20, s[36:39], s49 offen sc1 lds
    s_branch LQL_e18
LQL_o18:
    s_mul_i32 s49, s49, 122880
    s_add_u32 s49, s49, s55
    buffer_load_dwordx4 v10, s[28:31], s49 offen offset:0 lds
    buffer_load_dwordx4 v11, s[28:31], s49 offen offset:1024 lds
    buffer_load_dwordx4 v12, s[28:31], s49 offen offset:2048 lds
    buffer_load_dwordx4 v13, s[28:31], s49 offen offset:3072 lds
    s_add_u32 m0, s59, 129024
    s_nop 0
    buffer_load_dwordx4 v14, s[28:31], s49 offen lds
LQL_e18:
    s_waitcnt vmcnt(10)
    s_barrier
    s_xor_b32 s49, s56, 19
    s_add_u32 m0, s59, 140288
    s_bitcmp1_b32 s57, s49
    s_cbranch_scc1 LQL_o19
    s_mul_i32 s49, s49, 122880
    s_add_u32 s49, s49, s62
    buffer_load_dwordx4 v20, s[36:39], s49 offen offset:0 sc1 lds
    buffer_load_dwordx4 v20, s[36:39], s49 offen offset:1024 sc1 lds
    buffer_load_dwordx4 v20, s[36:39], s49 offen offset:2048 sc1 lds
    buffer_load_dwordx4 v20, s[36:39], s49 offen offset:3072 sc1 lds
    s_add_u32 m0, s59, 144384
    s_add_u32 s49, s49, 4096
    buffer_load_dwordx4 v20, s[36:39], s49 offen sc1 lds
    s_branch LQL_e19
LQL_o19:
    s_mul_i32 s49, s49, 122880
    s_add_u32 s49, s49, s55
    buffer_load_dwordx4 v10, s[28:31], s49 offen offset:0 lds
    buffer_load_dwordx4 v11, s[28:31], s49 offen offset:1024 lds
    buffer_load_dwordx4 v12, s[28:31], s49 offen offset:2048 lds
    buffer_load_dwordx4 v13, s[28:31], s49 offen offset:3072 lds
    s_add_u32 m0, s59, 144384
    s_nop 0
    buffer_load_dwordx4 v14, s[28:31], s49 offen lds
LQL_e19:
    s_add_u32 s49, s12, 81920
    buffer_load_dwordx4 v[64:67], v26, s[40:43], s49 offen
    buffer_load_dwordx4 v[68:71], v27, s[40:43], s49 offen offset:1024
    s_waitcnt vmcnt(12)
    s_barrier
    s_add_u32 s49, s13, 81920
    buffer_load_dwordx4 v[72:75], v26, s[40:43], s49 offen
    buffer_load_dwordx4 v[76:79], v27, s[40:43], s49 offen offset:1024
    s_add_u32 s49, s15, 81920
    buffer_load_dwordx4 v[80:83], v26, s[40:43], s49 offen
    buffer_load_dwordx4 v[84:87], v27, s[40:43], s49 offen offset:1024
    s_add_u32 s49, s16, 81920
    buffer_load_dwordx4 v[88:91], v26, s[40:43], s49 offen
    buffer_load_dwordx4 v[92:95], v27, s[40:43], s49 offen offset:1024
    s_add_u32 s49, s17, 81920
    buffer_load_dwordx4 v[96:99], v26, s[40:43], s49 offen
    buffer_load_dwordx4 v[100:103], v27, s[40:43], s49 offen offset:1024
    s_waitcnt vmcnt(15)
    s_barrier
    s_add_u32 s49, s19, 81920
    buffer_load_dwordx4 v[104:107], v26, s[40:43], s49 offen
    buffer_load_dwordx4 v[108:111], v27, s[40:43], s49 offen offset:1024
    buffer_load_dwordx4 v[112:115], v26, s[32:35], s4 offen
    buffer_load_dwordx4 v[116:119], v27, s[32:35], s4 offen offset:1024
    buffer_load_dwordx4 v[120:123], v26, s[32:35], s5 offen
    buffer_load_dwordx4 v[124:127], v27, s[32:35], s5 offen offset:1024
    buffer_load_dwordx4 v[128:131], v26, s[32:35], s7 offen
    buffer_load_dwordx4 v[132:135], v27, s[32:35], s7 offen offset:1024
    s_waitcnt vmcnt(18)
    s_barrier
    buffer_load_dwordx4 v[136:139], v26, s[32:35], s44 offen
    buffer_load_dwordx4 v[140:143], v27, s[32:35], s44 offen offset:1024
    buffer_load_dwordx4 v[144:147], v26, s[32:35], s45 offen
    buffer_load_dwordx4 v[148:151], v27, s[32:35], s45 offen offset:1024
    buffer_load_dwordx4 v[152:155], v26, s[32:35], s47 offen
    buffer_load_dwordx4 v[156:159], v27, s[32:35], s47 offen offset:1024
    s_add_u32 s49, s66, 0
    buffer_load_dwordx4 v[160:163], v26, s[32:35], s49 offen
    s_add_u32 s49, s49, 92160
    buffer_load_dwordx4 v[164:167], v27, s[32:35], s49 offen offset:1024
    s_barrier
    s_add_u32 s49, s66, 409600
    buffer_load_dwordx4 v[168:171], v26, s[32:35], s49 offen
    s_add_u32 s49, s49, 92160
    buffer_load_dwordx4 v[172:175], v27, s[32:35], s49 offen offset:1024
    s_add_u32 s49, s19, 40960
    buffer_load_dwordx4 v[176:179], v26, s[40:43], s49 offen
    buffer_load_dwordx4 v[180:183], v27, s[40:43], s49 offen offset:1024
LQL_tail:
    s_mov_b32 s57, 8921088
    s_mov_b32 s62, 0
    s_mov_b32 s63, -1
    s_add_u32 s51, s70, s68
    s_mul_i32 s51, s51, 20480
    s_lshl_b32 s52, s71, 7
    s_add_u32 s51, s51, s52
    s_barrier
    s_add_u32 m0, s69, 154624
    s_nop 0
    buffer_load_dwordx4 v26, s[24:27], s51 offen lds
    buffer_load_dwordx4 v27, s[24:27], s51 offen offset:1024 lds
    s_add_u32 m0, s69, 23552
    s_nop 0
    buffer_load_dwordx4 v26, s[40:43], s12 offen lds
    buffer_load_dwordx4 v27, s[40:43], s12 offen offset:1024 lds
    s_waitcnt vmcnt(6)
    s_add_u32 m0, s69, 31744
    s_nop 0
    buffer_load_dwordx4 v26, s[40:43], s13 offen lds
    buffer_load_dwordx4 v27, s[40:43], s13 offen offset:1024 lds
    s_waitcnt vmcnt(6)
    s_add_u32 m0, s69, 39936
    s_nop 0
    buffer_load_dwordx4 v26, s[40:43], s14 offen lds
    buffer_load_dwordx4 v27, s[40:43], s14 offen offset:1024 lds
    s_waitcnt vmcnt(6)
    s_add_u32 m0, s69, 48128
    s_nop 0
    buffer_load_dwordx4 v26, s[40:43], s15 offen lds
    buffer_load_dwordx4 v27, s[40:43], s15 offen offset:1024 lds
    s_waitcnt vmcnt(6)
    s_add_u32 m0, s69, 56320
    s_nop 0
    buffer_load_dwordx4 v26, s[40:43], s16 offen lds
    buffer_load_dwordx4 v27, s[40:43], s16 offen offset:1024 lds
    s_waitcnt vmcnt(6)
    s_add_u32 m0, s69, 64512
    s_nop 0
    buffer_load_dwordx4 v26, s[40:43], s17 offen lds
    buffer_load_dwordx4 v27, s[40:43], s17 offen offset:1024 lds
    s_add_u32 m0, s69, 72704
    s_nop 0
    buffer_load_dwordx4 v26, s[40:43], s18 offen lds
    buffer_load_dwordx4 v27, s[40:43], s18 offen offset:1024 lds
    s_add_u32 m0, s69, 80896
    s_nop 0
    buffer_load_dwordx4 v26, s[40:43], s19 offen lds
    buffer_load_dwordx4 v27, s[40:43], s19 offen offset:1024 lds
    s_barrier
    s_add_u32 m0, s69, 89088
    s_add_u32 s49, s12, 40960
    buffer_load_dwordx4 v26, s[40:43], s49 offen lds
    buffer_load_dwordx4 v27, s[40:43], s49 offen offset:1024 lds
    s_waitcnt vmcnt(6)
    s_add_u32 m0, s69, 97280
    s_add_u32 s49, s13, 40960
    buffer_load_dwordx4 v26, s[40:43], s49 offen lds
    buffer_load_dwordx4 v27, s[40:43], s49 offen offset:1024 lds
    s_waitcnt vmcnt(6)
    s_add_u32 m0, s69, 105472
    s_add_u32 s49, s14, 40960
    buffer_load_dwordx4 v26, s[40:43], s49 offen lds
    buffer_load_dwordx4 v27, s[40:43], s49 offen offset:1024 lds
    s_waitcnt vmcnt(6)
    s_add_u32 m0, s69, 113664
    s_add_u32 s49, s15, 40960
    buffer_load_dwordx4 v26, s[40:43], s49 offen lds
    buffer_load_dwordx4 v27, s[40:43], s49 offen offset:1024 lds
    s_waitcnt vmcnt(6)
    s_add_u32 m0, s69, 121856
    s_add_u32 s49, s16, 40960
    buffer_load_dwordx4 v26, s[40:43], s49 offen lds
    buffer_load_dwordx4 v27, s[40:43], s49 offen offset:1024 lds
    s_waitcnt vmcnt(6)
    s_add_u32 m0, s69, 130048
    s_add_u32 s49, s17, 40960
    buffer_load_dwordx4 v26, s[40:43], s49 offen lds
    buffer_load_dwordx4 v27, s[40:43], s49 offen offset:1024 lds
    s_waitcnt vmcnt(6)
    s_add_u32 m0, s69, 138240
    s_add_u32 s49, s18, 40960
    buffer_load_dwordx4 v26, s[40:43], s49 offen lds
    buffer_load_dwordx4 v27, s[40:43], s49 offen offset:1024 lds
    s_waitcnt vmcnt(6)
    ds_write_b128 v30, v[176:179] offset:57344
    ds_write_b128 v30, v[180:183] offset:58368
    s_cmp_lg_u32 s68, 3
    s_cbranch_scc1 LQL_pi0
    s_and_b32 s49, s63, 0xffff
    s_cbranch_scc0 LQL_pi0
    s_mov_b32 exec_hi, s49
    s_mov_b32 exec_lo, 0
    buffer_load_dword v24, v28, s[36:39], s57 offen sc1
    s_mov_b64 exec, -1
LQL_pi0:
    s_cmp_lg_u32 s68, 3
    s_cbranch_scc1 LQL_ok0
    s_and_b32 s49, s63, 0xffff
    s_cbranch_scc0 LQL_ok0
    s_mov_b32 s67, 262144
    s_waitcnt vmcnt(0)
LQL_sp0:
    v_cmp_ne_u32 vcc, s58, v24
    s_nop 0
    s_and_b64 s[62:63], s[62:63], vcc
    s_and_b32 s49, s63, 0xffff
    s_cbranch_scc0 LQL_ok0
    s_sleep 2
    s_mov_b32 exec_hi, s49
    s_mov_b32 exec_lo, 0
    buffer_load_dword v24, v28, s[36:39], s57 offen sc1
    s_mov_b64 exec, -1
    s_sub_u32 s67, s67, 1
    s_cmp_lg_u32 s67, 0
    s_waitcnt vmcnt(0)
    s_cbranch_scc1 LQL_sp0
LQL_ok0:
    s_waitcnt vmcnt(0) lgkmcnt(0)
    s_barrier
    s_cmp_lg_u32 s68, 3
    s_cbranch_scc1 LQL_pi1
    s_and_b32 s49, s63, 0xffff
    s_cbranch_scc0 LQL_pi1
    s_mov_b32 exec_hi, s49
    s_mov_b32 exec_lo, 0
    buffer_load_dword v24, v28, s[36:39], s57 offen sc1
    s_mov_b64 exec, -1
LQL_pi1:
    s_cmp_lg_u32 s68, 3
    s_cbranch_scc1 LQL_ok1
    s_and_b32 s49, s63, 0xffff
    s_cbranch_scc0 LQL_ok1
    s_mov_b32 s67, 262144
    s_waitcnt vmcnt(0)
LQL_sp1:
    v_cmp_ne_u32 vcc, s58, v24
    s_nop 0
    s_and_b64 s[62:63], s[62:63], vcc
    s_and_b32 s49, s63, 0xffff
    s_cbranch_scc0 LQL_ok1
    s_sleep 2
    s_mov_b32 exec_hi, s49
    s_mov_b32 exec_lo, 0
    buffer_load_dword v24, v28, s[36:39], s57 offen sc1
    s_mov_b64 exec, -1
    s_sub_u32 s67, s67, 1
    s_cmp_lg_u32 s67, 0
    s_waitcnt vmcnt(0)
    s_cbranch_scc1 LQL_sp1
LQL_ok1:
    s_waitcnt vmcnt(0)
    s_barrier
    s_add_u32 m0, s69, 39936
    s_add_u32 s49, s14, 81920
    buffer_load_dwordx4 v26, s[40:43], s49 offen lds
    buffer_load_dwordx4 v27, s[40:43], s49 offen offset:1024 lds
    ds_write_b128 v29, v[64:67] offset:0
    ds_write_b128 v29, v[68:71] offset:1024
    ds_write_b128 v29, v[72:75] offset:8192
    ds_write_b128 v29, v[76:79] offset:9216
    s_waitcnt lgkmcnt(0)
    s_barrier
    s_cmp_lg_u32 s68, 3
    s_cbranch_scc1 LQL_pi2
    s_and_b32 s49, s63, 0xffff
    s_cbranch_scc0 LQL_pi2
    s_mov_b32 exec_hi, s49
    s_mov_b32 exec_lo, 0
    buffer_load_dword v24, v28, s[36:39], s57 offen sc1
    s_mov_b64 exec, -1
LQL_pi2:
    s_add_u32 m0, s69, 72704
    s_add_u32 s49, s18, 81920
    buffer_load_dwordx4 v26, s[40:43], s49 offen lds
    buffer_load_dwordx4 v27, s[40:43], s49 offen offset:1024 lds
    ds_write_b128 v29, v[80:83] offset:24576
    ds_write_b128 v29, v[84:87] offset:25600
    ds_write_b128 v29, v[88:91] offset:32768
    ds_write_b128 v29, v[92:95] offset:33792
    ds_write_b128 v29, v[96:99] offset:40960
    ds_write_b128 v29, v[100:103] offset:41984
    s_cmp_lg_u32 s68, 3
    s_cbranch_scc1 LQL_ok2
    s_and_b32 s49, s63, 0xffff
    s_cbranch_scc0 LQL_ok2
    s_mov_b32 s67, 262144
    s_waitcnt vmcnt(2)
LQL_sp2:
    v_cmp_ne_u32 vcc, s58, v24
    s_nop 0
    s_and_b64 s[62:63], s[62:63], vcc
    s_and_b32 s49, s63, 0xffff
    s_cbranch_scc0 LQL_ok2
    s_sleep 2
    s_mov_b32 exec_hi, s49
    s_mov_b32 exec_lo, 0
    buffer_load_dword v24, v28, s[36:39], s57 offen sc1
    s_mov_b64 exec, -1
    s_sub_u32 s67, s67, 1
    s_cmp_lg_u32 s67, 0
    s_waitcnt vmcnt(0)
    s_cbranch_scc1 LQL_sp2
LQL_ok2:
    s_waitcnt vmcnt(2) lgkmcnt(0)
    s_barrier
    s_add_u32 m0, s69, 105472
    s_nop 0
    buffer_load_dwordx4 v26, s[32:35], s6 offen lds
    buffer_load_dwordx4 v27, s[32:35], s6 offen offset:1024 lds
    ds_write_b128 v29, v[104:107] offset:57344
    ds_write_b128 v29, v[108:111] offset:58368
    ds_write_b128 v30, v[112:115] offset:0
    ds_write_b128 v30, v[116:119] offset:1024
    s_waitcnt vmcnt(2) lgkmcnt(0)
    s_barrier
    s_cmp_lg_u32 s68, 3
    s_cbranch_scc1 LQL_pi3
    s_and_b32 s49, s63, 0xffff0000
    s_cbranch_scc0 LQL_pi3
    s_mov_b32 exec_hi, s49
    s_mov_b32 exec_lo, 0
    buffer_load_dword v24, v28, s[36:39], s57 offen sc1
    s_mov_b64 exec, -1
LQL_pi3:
    s_add_u32 m0, s69, 138240
    s_nop 0
    buffer_load_dwordx4 v26, s[32:35], s46 offen lds
    buffer_load_dwordx4 v27, s[32:35], s46 offen offset:1024 lds
    ds_write_b128 v30, v[120:123] offset:8192
    ds_write_b128 v30, v[124:127] offset:9216
    ds_write_b128 v30, v[128:131] offset:24576
    ds_write_b128 v30, v[132:135] offset:25600
    s_cmp_lg_u32 s68, 3
    s_cbranch_scc1 LQL_ok3
    s_and_b32 s49, s63, 0xffff0000
    s_cbranch_scc0 LQL_ok3
    s_mov_b32 s67, 262144
    s_waitcnt vmcnt(2)
LQL_sp3:
    v_cmp_ne_u32 vcc, s58, v24
    s_nop 0
    s_and_b64 s[62:63], s[62:63], vcc
    s_and_b32 s49, s63, 0xffff0000
    s_cbranch_scc0 LQL_ok3
    s_sleep 2
    s_mov_b32 exec_hi, s49
    s_mov_b32 exec_lo, 0
    buffer_load_dword v24, v28, s[36:39], s57 offen sc1
    s_mov_b64 exec, -1
    s_sub_u32 s67, s67, 1
    s_cmp_lg_u32 s67, 0
    s_waitcnt vmcnt(0)
    s_cbranch_scc1 LQL_sp3
LQL_ok3:
    s_waitcnt vmcnt(2) lgkmcnt(0)
    s_barrier
    ds_write_b128 v30, v[136:139] offset:32768
    ds_write_b128 v30, v[140:143] offset:33792
    ds_write_b128 v30, v[144:147] offset:40960
    ds_write_b128 v30, v[148:151] offset:41984
    s_waitcnt vmcnt(0) lgkmcnt(0)
    s_barrier
    ds_write_b128 v30, v[152:155] offset:57344
    ds_write_b128 v30, v[156:159] offset:58368
    s_waitcnt lgkmcnt(0)
    s_barrier
    ds_write_b128 v29, v[160:163] offset:0
    ds_write_b128 v29, v[164:167] offset:1024
    ds_write_b128 v29, v[168:171] offset:8192
    ds_write_b128 v29, v[172:175] offset:9216
    s_waitcnt lgkmcnt(0)
    s_barrier
    s_endpgm
LQL_X:
    v_xor_b32 v4, v2, v3
    v_lshl_add_u32 v10, v4, 4, v1
    v_xor_b32 v11, 64, v10
    v_add_u32 v12, 18432, v10
    v_add_u32 v13, 27648, v11
    v_add_u32 v11, 9216, v11
    s_mul_i32 s55, s23, 163840
    s_lshr_b32 s59, s10, 1
    s_lshl_b32 s59, s59, 7
    s_and_b32 s60, s59, 128
    s_sub_i32 s57, s55, 20480
    s_max_i32 s57, s57, 0
    s_waitcnt lgkmcnt(0)
    s_mov_b32 s24, s4
    s_mov_b32 s25, s5
    s_mov_b32 s26, 2621440
    s_mov_b32 s27, 0x20000
    s_xor_b32 s50, s59, 0
    s_add_u32 s61, s55, s50
    s_add_u32 s49, s57, s50
    s_mov_b32 m0, 60416
    s_mov_b32 exec_lo, 0xffffff00
    buffer_load_dwordx4 v10, s[24:27], s49 offen lds
    s_mov_b32 exec_lo, -1
    buffer_load_dwordx4 v11, s[24:27], s49 offen offset:1024 lds
    s_mov_b32 m0, 62464
    s_add_u32 s49, s61, 0
    buffer_load_dwordx4 v10, s[24:27], s49 offen offset:0 lds
    buffer_load_dwordx4 v11, s[24:27], s49 offen offset:1024 lds
    buffer_load_dwordx4 v12, s[24:27], s49 offen offset:2048 lds
    buffer_load_dwordx4 v13, s[24:27], s49 offen offset:3072 lds
    s_mov_b32 m0, 66560
    s_add_u32 s49, s61, 40960
    buffer_load_dwordx4 v10, s[24:27], s49 offen offset:0 lds
    buffer_load_dwordx4 v11, s[24:27], s49 offen offset:1024 lds
    buffer_load_dwordx4 v12, s[24:27], s49 offen offset:2048 lds
    buffer_load_dwordx4 v13, s[24:27], s49 offen offset:3072 lds
    s_mov_b32 m0, 70656
    s_add_u32 s49, s61, 81920
    buffer_load_dwordx4 v10, s[24:27], s49 offen offset:0 lds
    buffer_load_dwordx4 v11, s[24:27], s49 offen offset:1024 lds
    buffer_load_dwordx4 v12, s[24:27], s49 offen offset:2048 lds
    buffer_load_dwordx4 v13, s[24:27], s49 offen offset:3072 lds
    s_mov_b32 m0, 74752
    s_add_u32 s49, s61, 122880
    buffer_load_dwordx4 v10, s[24:27], s49 offen offset:0 lds
    buffer_load_dwordx4 v11, s[24:27], s49 offen offset:1024 lds
    buffer_load_dwordx4 v12, s[24:27], s49 offen offset:2048 lds
    buffer_load_dwordx4 v13, s[24:27], s49 offen offset:3072 lds
    v_lshlrev_b32 v2, 1, v2
    v_xor_b32 v2, v2, v3
    v_lshl_add_u32 v26, v2, 4, v1
    v_add_u32 v27, 9216, v26
    v_lshlrev_b32 v20, 4, v0
    v_lshlrev_b32 v21, 2, v0
    v_mov_b32 v28, 0
    v_mov_b32 v24, 0
    s_mov_b32 s58, 0
    s_mov_b32 s36, s20
    s_mov_b32 s37, s21
    s_mov_b32 s38, 11640832
    s_mov_b32 s39, 0x20000
    s_mov_b32 s40, s14
    s_mov_b32 s41, s15
    s_mov_b32 s42, 1966080
    s_mov_b32 s43, 0x20000
    s_mov_b32 s32, s8
    s_mov_b32 s33, s9
    s_mov_b32 s34, 819200
    s_mov_b32 s35, 0x20000
    s_mov_b32 s72, s18
    s_mov_b32 s73, s19
    s_mov_b32 s74, 256
    s_mov_b32 s75, 0x20000
    s_lshr_b32 s50, s53, 1
    s_and_b32 s51, s53, 1
    s_add_u32 s51, s51, 6
    s_cmp_ge_u32 s53, 11
    s_cselect_b32 s52, 4, 3
    s_cselect_b32 s49, 8, 3
    s_sub_u32 s49, s53, s49
    s_cmp_lt_u32 s53, 6
    s_cselect_b32 s71, s50, s52
    s_cselect_b32 s70, s51, s49
    s_lshl_b32 s70, s70, 2
    s_lshr_b32 s50, s70, 1
    s_mul_i32 s11, s71, 3
    s_add_u32 s11, s11, s50
    s_lshr_b32 s49, s54, 1
    s_lshl_b32 s49, s49, 5
    s_add_u32 s70, s70, s49
    s_and_b32 s49, s54, 1
    s_mul_i32 s49, s49, 5
    s_add_u32 s71, s71, s49
    s_and_b32 s11, s11, 0
    s_lshl_b32 s50, s71, 7
    s_lshr_b32 s51, s68, 1
    s_mul_i32 s49, s51, 122880
    s_and_b32 s52, s68, 1
    s_mul_i32 s52, s52, 20480
    s_add_u32 s64, s50, s49
    s_add_u32 s64, s64, s52
    s_mul_i32 s49, s68, 20480
    s_add_u32 s65, s50, s49
    s_mul_i32 s51, s51, 204800
    s_lshr_b32 s52, s52, 1
    s_add_u32 s51, s51, s52
    s_add_u32 s66, s50, s51
    s_add_u32 s66, s66, 81920
    s_lshl_b32 s69, s68, 11
    v_add_u32 v29, s69, v20
    v_add_u32 v29, 23552, v29
    v_add_u32 v30, 0x10000, v29
    s_mov_b32 s24, s4
    s_mov_b32 s25, s5
    s_mov_b32 s26, 2621440
    s_mov_b32 s27, 0x20000
    s_xor_b32 s49, s11, 0
    s_mul_i32 s50, s49, 245760
    s_add_u32 s12, s50, s64
    s_mul_i32 s50, s49, 102400
    s_add_u32 s4, s50, s65
    s_xor_b32 s49, s11, 1
    s_mul_i32 s50, s49, 245760
    s_add_u32 s13, s50, s64
    s_mul_i32 s50, s49, 102400
    s_add_u32 s5, s50, s65
    s_xor_b32 s49, s11, 2
    s_mul_i32 s50, s49, 245760
    s_add_u32 s14, s50, s64
    s_mul_i32 s50, s49, 102400
    s_add_u32 s6, s50, s65
    s_xor_b32 s49, s11, 3
    s_mul_i32 s50, s49, 245760
    s_add_u32 s15, s50, s64
    s_mul_i32 s50, s49, 102400
    s_add_u32 s7, s50, s65
    s_xor_b32 s49, s11, 4
    s_mul_i32 s50, s49, 245760
    s_add_u32 s16, s50, s64
    s_mul_i32 s50, s49, 102400
    s_add_u32 s44, s50, s65
    s_xor_b32 s49, s11, 5
    s_mul_i32 s50, s49, 245760
    s_add_u32 s17, s50, s64
    s_mul_i32 s50, s49, 102400
    s_add_u32 s45, s50, s65
    s_xor_b32 s49, s11, 6
    s_mul_i32 s50, s49, 245760
    s_add_u32 s18, s50, s64
    s_mul_i32 s50, s49, 102400
    s_add_u32 s46, s50, s65
    s_xor_b32 s49, s11, 7
    s_mul_i32 s50, s49, 245760
    s_add_u32 s19, s50, s64
    s_mul_i32 s50, s49, 102400
    s_add_u32 s47, s50, s65
    v_mov_b32 v4, 0x3f803f80
    v_mov_b32 v5, v4
    v_mov_b32 v6, v4
    v_mov_b32 v7, v4
    s_mov_b64 exec, 0xff
    ds_write_b128 v20, v[4:7] offset:23552
    ds_write_b128 v20, v[4:7] offset:41984
    ds_write_b128 v20, v[4:7] offset:60416
    s_mov_b64 exec, -1
    v_mov_b32 v4, 0
    v_and_b32 v5, 12, v21
    ds_write_b32 v5, v4 offset:3008
    s_lshl_b32 s50, s23, 14
    s_lshl_b32 s51, s3, 10
    s_add_u32 s50, s50, s51
    s_add_u32 s50, s50, 8921088
    v_lshlrev_b32 v3, 3, v0
    v_add_u32 v8, s50, v3
    v_add_u32 v8, 768, v8
    v_and_b32 v9, 28, v21
    v_subrev_u32 v3, 896, v8
    v_cmp_gt_u32 vcc, 16, v0
    s_nop 1
    v_cndmask_b32 v8, v3, v8, vcc
    s_lshr_b32 s49, s70, 3
    s_add_u32 s50, s70, 3
    s_lshr_b32 s50, s50, 3
    s_lshl_b32 s49, s49, 14
    s_lshl_b32 s50, s50, 14
    v_and_b32 v4, 8, v0
    v_cmp_eq_u32 vcc, 0, v4
    v_mov_b32 v3, s49
    v_mov_b32 v4, s50
    v_cndmask_b32 v3, v4, v3, vcc
    v_and_b32 v4, 7, v0
    v_lshl_add_u32 v3, v4, 10, v3
    v_lshrrev_b32 v4, 4, v0
    v_lshlrev_b32 v4, 8, v4
    v_add_u32 v4, 8192, v4
    v_cmp_gt_u32 vcc, 48, v0
    s_nop 1
    v_cndmask_b32 v4, 0, v4, vcc
    v_add_u32 v28, v3, v4
    s_lshl_b32 s49, s23, 7
    v_add_u32 v14, s49, v0
    v_add_u32 v15, 48, v14
    v_and_b32 v16, 15, v0
    v_add_u32 v16, s49, v16
    v_add_u32 v16, 112, v16
    v_subrev_u32 v14, 16, v14
    v_max_i32 v14, 0, v14
    v_and_b32 v3, 7, v14
    v_lshrrev_b32 v14, 3, v14
    v_lshlrev_b32 v14, 10, v14
    v_lshl_add_u32 v14, v3, 3, v14
    v_and_b32 v3, 7, v15
    v_lshrrev_b32 v15, 3, v15
    v_lshlrev_b32 v15, 10, v15
    v_lshl_add_u32 v15, v3, 3, v15
    v_and_b32 v3, 7, v16
    v_lshrrev_b32 v16, 3, v16
    v_lshlrev_b32 v16, 10, v16
    v_lshl_add_u32 v16, v3, 3, v16
    s_xor_b32 s50, s59, 128
    s_add_u32 s61, s55, s50
    s_add_u32 s49, s57, s50
    s_mov_b32 m0, 23552
    s_mov_b32 exec_lo, 0xffffff00
    buffer_load_dwordx4 v10, s[24:27], s49 offen lds
    s_mov_b32 exec_lo, -1
    buffer_load_dwordx4 v11, s[24:27], s49 offen offset:1024 lds
    s_mov_b32 m0, 25600
    s_add_u32 s49, s61, 0
    buffer_load_dwordx4 v10, s[24:27], s49 offen offset:0 lds
    buffer_load_dwordx4 v11, s[24:27], s49 offen offset:1024 lds
    buffer_load_dwordx4 v12, s[24:27], s49 offen offset:2048 lds
    buffer_load_dwordx4 v13, s[24:27], s49 offen offset:3072 lds
    s_mov_b32 m0, 29696
    s_add_u32 s49, s61, 40960
    buffer_load_dwordx4 v10, s[24:27], s49 offen offset:0 lds
    buffer_load_dwordx4 v11, s[24:27], s49 offen offset:1024 lds
    buffer_load_dwordx4 v12, s[24:27], s49 offen offset:2048 lds
    buffer_load_dwordx4 v13, s[24:27], s49 offen offset:3072 lds
    s_waitcnt vmcnt(10) lgkmcnt(0)
    s_barrier
    v_mov_b32 v6, 0
    buffer_load_dword v5, v6, s[72:75], 0 offen sc1
    s_mov_b32 m0, 33792
    s_add_u32 s49, s61, 81920
    buffer_load_dwordx4 v10, s[24:27], s49 offen offset:0 lds
    buffer_load_dwordx4 v11, s[24:27], s49 offen offset:1024 lds
    buffer_load_dwordx4 v12, s[24:27], s49 offen offset:2048 lds
    buffer_load_dwordx4 v13, s[24:27], s49 offen offset:3072 lds
    s_mov_b32 m0, 37888
    s_add_u32 s49, s61, 122880
    buffer_load_dwordx4 v10, s[24:27], s49 offen offset:0 lds
    buffer_load_dwordx4 v11, s[24:27], s49 offen offset:1024 lds
    buffer_load_dwordx4 v12, s[24:27], s49 offen offset:2048 lds
    buffer_load_dwordx4 v13, s[24:27], s49 offen offset:3072 lds
    s_xor_b32 s50, s59, 256
    s_add_u32 s61, s55, s50
    s_add_u32 s49, s57, s50
    s_mov_b32 m0, 41984
    s_mov_b32 exec_lo, 0xffffff00
    buffer_load_dwordx4 v10, s[24:27], s49 offen lds
    s_mov_b32 exec_lo, -1
    buffer_load_dwordx4 v11, s[24:27], s49 offen offset:1024 lds
    s_mov_b32 m0, 44032
    s_add_u32 s49, s61, 0
    buffer_load_dwordx4 v10, s[24:27], s49 offen offset:0 lds
    buffer_load_dwordx4 v11, s[24:27], s49 offen offset:1024 lds
    buffer_load_dwordx4 v12, s[24:27], s49 offen offset:2048 lds
    buffer_load_dwordx4 v13, s[24:27], s49 offen offset:3072 lds
    s_mov_b32 m0, 48128
    s_add_u32 s49, s61, 40960
    buffer_load_dwordx4 v10, s[24:27], s49 offen offset:0 lds
    buffer_load_dwordx4 v11, s[24:27], s49 offen offset:1024 lds
    buffer_load_dwordx4 v12, s[24:27], s49 offen offset:2048 lds
    buffer_load_dwordx4 v13, s[24:27], s49 offen offset:3072 lds
    s_barrier
    s_mov_b32 m0, 52224
    s_add_u32 s49, s61, 81920
    buffer_load_dwordx4 v10, s[24:27], s49 offen offset:0 lds
    buffer_load_dwordx4 v11, s[24:27], s49 offen offset:1024 lds
    buffer_load_dwordx4 v12, s[24:27], s49 offen offset:2048 lds
    buffer_load_dwordx4 v13, s[24:27], s49 offen offset:3072 lds
    s_mov_b32 m0, 56320
    s_add_u32 s49, s61, 122880
    buffer_load_dwordx4 v10, s[24:27], s49 offen offset:0 lds
    buffer_load_dwordx4 v11, s[24:27], s49 offen offset:1024 lds
    buffer_load_dwordx4 v12, s[24:27], s49 offen offset:2048 lds
    buffer_load_dwordx4 v13, s[24:27], s49 offen offset:3072 lds
    s_waitcnt vmcnt(18)
    s_barrier
    ds_read_b32 v4, v9 offset:2944
    s_mov_b32 s67, 262144
LQL_nc:
    v_readfirstlane_b32 s58, v5
    s_nop 0
    s_cmp_lg_u32 s58, 0
    s_cbranch_scc1 LQL_nd
    s_sleep 4
    buffer_load_dword v5, v6, s[72:75], 0 offen sc1
    s_sub_u32 s67, s67, 1
    s_cmp_lg_u32 s67, 0
    s_waitcnt vmcnt(0)
    s_cbranch_scc1 LQL_nc
LQL_nd:
    ds_write_b32 v6, v5 offset:3040
    s_waitcnt lgkmcnt(0)
    s_mov_b32 exec_lo, 0xffff0000
    v_mov_b32 v4, 0
    v_mov_b32 v5, 0
    s_mov_b32 exec_lo, -1
    s_mov_b32 exec_hi, 0
    buffer_store_dwordx2 v[4:5], v8, s[36:39], 0 offen sc1
    s_mov_b64 exec, -1
    s_xor_b32 s50, s59, 384
    s_add_u32 s61, s55, s50
    s_add_u32 s49, s57, s50
    s_mov_b32 m0, 60416
    s_mov_b32 exec_lo, 0xffffff00
    buffer_load_dwordx4 v10, s[24:27], s49 offen lds
    s_mov_b32 exec_lo, -1
    buffer_load_dwordx4 v11, s[24:27], s49 offen offset:1024 lds
    s_mov_b32 m0, 62464
    s_add_u32 s49, s61, 0
    buffer_load_dwordx4 v10, s[24:27], s49 offen offset:0 lds
    buffer_load_dwordx4 v11, s[24:27], s49 offen offset:1024 lds
    buffer_load_dwordx4 v12, s[24:27], s49 offen offset:2048 lds
    buffer_load_dwordx4 v13, s[24:27], s49 offen offset:3072 lds
    s_mov_b32 m0, 66560
    s_add_u32 s49, s61, 40960
    buffer_load_dwordx4 v10, s[24:27], s49 offen offset:0 lds
    buffer_load_dwordx4 v11, s[24:27], s49 offen offset:1024 lds
    buffer_load_dwordx4 v12, s[24:27], s49 offen offset:2048 lds
    buffer_load_dwordx4 v13, s[24:27], s49 offen offset:3072 lds
    s_barrier
    s_mov_b32 m0, 70656
    s_add_u32 s49, s61, 81920
    buffer_load_dwordx4 v10, s[24:27], s49 offen offset:0 lds
    buffer_load_dwordx4 v11, s[24:27], s49 offen offset:1024 lds
    buffer_load_dwordx4 v12, s[24:27], s49 offen offset:2048 lds
    buffer_load_dwordx4 v13, s[24:27], s49 offen offset:3072 lds
    s_mov_b32 m0, 74752
    s_add_u32 s49, s61, 122880
    buffer_load_dwordx4 v10, s[24:27], s49 offen offset:0 lds
    buffer_load_dwordx4 v11, s[24:27], s49 offen offset:1024 lds
    buffer_load_dwordx4 v12, s[24:27], s49 offen offset:2048 lds
    buffer_load_dwordx4 v13, s[24:27], s49 offen offset:3072 lds
    s_waitcnt vmcnt(19)
    s_barrier
    s_xor_b32 s50, s59, 512
    s_add_u32 s61, s55, s50
    s_add_u32 s49, s57, s50
    s_mov_b32 m0, 23552
    s_mov_b32 exec_lo, 0xffffff00
    buffer_load_dwordx4 v10, s[24:27], s49 offen lds
    s_mov_b32 exec_lo, -1
    buffer_load_dwordx4 v11, s[24:27], s49 offen offset:1024 lds
    s_mov_b32 m0, 25600
    s_add_u32 s49, s61, 0
    buffer_load_dwordx4 v10, s[24:27], s49 offen offset:0 lds
    buffer_load_dwordx4 v11, s[24:27], s49 offen offset:1024 lds
    buffer_load_dwordx4 v12, s[24:27], s49 offen offset:2048 lds
    buffer_load_dwordx4 v13, s[24:27], s49 offen offset:3072 lds
    s_mov_b32 m0, 29696
    s_add_u32 s49, s61, 40960
    buffer_load_dwordx4 v10, s[24:27], s49 offen offset:0 lds
    buffer_load_dwordx4 v11, s[24:27], s49 offen offset:1024 lds
    buffer_load_dwordx4 v12, s[24:27], s49 offen offset:2048 lds
    buffer_load_dwordx4 v13, s[24:27], s49 offen offset:3072 lds
    s_barrier
    s_mov_b32 m0, 33792
    s_add_u32 s49, s61, 81920
    buffer_load_dwordx4 v10, s[24:27], s49 offen offset:0 lds
    buffer_load_dwordx4 v11, s[24:27], s49 offen offset:1024 lds
    buffer_load_dwordx4 v12, s[24:27], s49 offen offset:2048 lds
    buffer_load_dwordx4 v13, s[24:27], s49 offen offset:3072 lds
    s_mov_b32 m0, 37888
    s_add_u32 s49, s61, 122880
    buffer_load_dwordx4 v10, s[24:27], s49 offen offset:0 lds
    buffer_load_dwordx4 v11, s[24:27], s49 offen offset:1024 lds
    buffer_load_dwordx4 v12, s[24:27], s49 offen offset:2048 lds
    buffer_load_dwordx4 v13, s[24:27], s49 offen offset:3072 lds
    s_waitcnt vmcnt(18)
    s_barrier
    s_xor_b32 s50, s59, 640
    s_add_u32 s61, s55, s50
    s_add_u32 s49, s57, s50
    s_mov_b32 m0, 41984
    s_mov_b32 exec_lo, 0xffffff00
    buffer_load_dwordx4 v10, s[24:27], s49 offen lds
    s_mov_b32 exec_lo, -1
    buffer_load_dwordx4 v11, s[24:27], s49 offen offset:1024 lds
    s_mov_b32 m0, 44032
    s_add_u32 s49, s61, 0
    buffer_load_dwordx4 v10, s[24:27], s49 offen offset:0 lds
    buffer_load_dwordx4 v11, s[24:27], s49 offen offset:1024 lds
    buffer_load_dwordx4 v12, s[24:27], s49 offen offset:2048 lds
    buffer_load_dwordx4 v13, s[24:27], s49 offen offset:3072 lds
    s_mov_b32 m0, 48128
    s_add_u32 s49, s61, 40960
    buffer_load_dwordx4 v10, s[24:27], s49 offen offset:0 lds
    buffer_load_dwordx4 v11, s[24:27], s49 offen offset:1024 lds
    buffer_load_dwordx4 v12, s[24:27], s49 offen offset:2048 lds
    buffer_load_dwordx4 v13, s[24:27], s49 offen offset:3072 lds
    s_barrier
    s_mov_b32 m0, 52224
    s_add_u32 s49, s61, 81920
    buffer_load_dwordx4 v10, s[24:27], s49 offen offset:0 lds
    buffer_load_dwordx4 v11, s[24:27], s49 offen offset:1024 lds
    buffer_load_dwordx4 v12, s[24:27], s49 offen offset:2048 lds
    buffer_load_dwordx4 v13, s[24:27], s49 offen offset:3072 lds
    s_mov_b32 m0, 56320
    s_add_u32 s49, s61, 122880
    buffer_load_dwordx4 v10, s[24:27], s49 offen offset:0 lds
    buffer_load_dwordx4 v11, s[24:27], s49 offen offset:1024 lds
    buffer_load_dwordx4 v12, s[24:27], s49 offen offset:2048 lds
    buffer_load_dwordx4 v13, s[24:27], s49 offen offset:3072 lds
    s_waitcnt vmcnt(18)
    s_barrier
    s_xor_b32 s50, s59, 768
    s_add_u32 s61, s55, s50
    s_add_u32 s49, s57, s50
    s_mov_b32 m0, 60416
    s_mov_b32 exec_lo, 0xffffff00
    buffer_load_dwordx4 v10, s[24:27], s49 offen lds
    s_mov_b32 exec_lo, -1
    buffer_load_dwordx4 v11, s[24:27], s49 offen offset:1024 lds
    s_mov_b32 m0, 62464
    s_add_u32 s49, s61, 0
    buffer_load_dwordx4 v10, s[24:27], s49 offen offset:0 lds
    buffer_load_dwordx4 v11, s[24:27], s49 offen offset:1024 lds
    buffer_load_dwordx4 v12, s[24:27], s49 offen offset:2048 lds
    buffer_load_dwordx4 v13, s[24:27], s49 offen offset:3072 lds
    s_mov_b32 m0, 66560
    s_add_u32 s49, s61, 40960
    buffer_load_dwordx4 v10, s[24:27], s49 offen offset:0 lds
    buffer_load_dwordx4 v11, s[24:27], s49 offen offset:1024 lds
    buffer_load_dwordx4 v12, s[24:27], s49 offen offset:2048 lds
    buffer_load_dwordx4 v13, s[24:27], s49 offen offset:3072 lds
    s_barrier
    s_mov_b32 m0, 70656
    s_add_u32 s49, s61, 81920
    buffer_load_dwordx4 v10, s[24:27], s49 offen offset:0 lds
    buffer_load_dwordx4 v11, s[24:27], s49 offen offset:1024 lds
    buffer_load_dwordx4 v12, s[24:27], s49 offen offset:2048 lds
    buffer_load_dwordx4 v13, s[24:27], s49 offen offset:3072 lds
    s_mov_b32 m0, 74752
    s_add_u32 s49, s61, 122880
    buffer_load_dwordx4 v10, s[24:27], s49 offen offset:0 lds
    buffer_load_dwordx4 v11, s[24:27], s49 offen offset:1024 lds
    buffer_load_dwordx4 v12, s[24:27], s49 offen offset:2048 lds
    buffer_load_dwordx4 v13, s[24:27], s49 offen offset:3072 lds
    s_waitcnt vmcnt(18)
    s_barrier
    s_xor_b32 s50, s59, 896
    s_add_u32 s61, s55, s50
    s_add_u32 s49, s57, s50
    s_mov_b32 m0, 23552
    s_mov_b32 exec_lo, 0xffffff00
    buffer_load_dwordx4 v10, s[24:27], s49 offen lds
    s_mov_b32 exec_lo, -1
    buffer_load_dwordx4 v11, s[24:27], s49 offen offset:1024 lds
    s_mov_b32 m0, 25600
    s_add_u32 s49, s61, 0
    buffer_load_dwordx4 v10, s[24:27], s49 offen offset:0 lds
    buffer_load_dwordx4 v11, s[24:27], s49 offen offset:1024 lds
    buffer_load_dwordx4 v12, s[24:27], s49 offen offset:2048 lds
    buffer_load_dwordx4 v13, s[24:27], s49 offen offset:3072 lds
    s_mov_b32 m0, 29696
    s_add_u32 s49, s61, 40960
    buffer_load_dwordx4 v10, s[24:27], s49 offen offset:0 lds
    buffer_load_dwordx4 v11, s[24:27], s49 offen offset:1024 lds
    buffer_load_dwordx4 v12, s[24:27], s49 offen offset:2048 lds
    buffer_load_dwordx4 v13, s[24:27], s49 offen offset:3072 lds
    s_barrier
    s_mov_b32 m0, 33792
    s_add_u32 s49, s61, 81920
    buffer_load_dwordx4 v10, s[24:27], s49 offen offset:0 lds
    buffer_load_dwordx4 v11, s[24:27], s49 offen offset:1024 lds
    buffer_load_dwordx4 v12, s[24:27], s49 offen offset:2048 lds
    buffer_load_dwordx4 v13, s[24:27], s49 offen offset:3072 lds
    s_mov_b32 m0, 37888
    s_add_u32 s49, s61, 122880
    buffer_load_dwordx4 v10, s[24:27], s49 offen offset:0 lds
    buffer_load_dwordx4 v11, s[24:27], s49 offen offset:1024 lds
    buffer_load_dwordx4 v12, s[24:27], s49 offen offset:2048 lds
    buffer_load_dwordx4 v13, s[24:27], s49 offen offset:3072 lds
    s_waitcnt vmcnt(18)
    s_barrier
    s_xor_b32 s50, s60, 1024
    s_add_u32 s61, s55, s50
    s_add_u32 s49, s57, s50
    s_mov_b32 m0, 41984
    s_mov_b32 exec_lo, 0xffffff00
    buffer_load_dwordx4 v10, s[24:27], s49 offen lds
    s_mov_b32 exec_lo, -1
    buffer_load_dwordx4 v11, s[24:27], s49 offen offset:1024 lds
    s_mov_b32 m0, 44032
    s_add_u32 s49, s61, 0
    buffer_load_dwordx4 v10, s[24:27], s49 offen offset:0 lds
    buffer_load_dwordx4 v11, s[24:27], s49 offen offset:1024 lds
    buffer_load_dwordx4 v12, s[24:27], s49 offen offset:2048 lds
    buffer_load_dwordx4 v13, s[24:27], s49 offen offset:3072 lds
    s_mov_b32 m0, 48128
    s_add_u32 s49, s61, 40960
    buffer_load_dwordx4 v10, s[24:27], s49 offen offset:0 lds
    buffer_load_dwordx4 v11, s[24:27], s49 offen offset:1024 lds
    buffer_load_dwordx4 v12, s[24:27], s49 offen offset:2048 lds
    buffer_load_dwordx4 v13, s[24:27], s49 offen offset:3072 lds
    s_barrier
    s_mov_b32 m0, 52224
    s_add_u32 s49, s61, 81920
    buffer_load_dwordx4 v10, s[24:27], s49 offen offset:0 lds
    buffer_load_dwordx4 v11, s[24:27], s49 offen offset:1024 lds
    buffer_load_dwordx4 v12, s[24:27], s49 offen offset:2048 lds
    buffer_load_dwordx4 v13, s[24:27], s49 offen offset:3072 lds
    s_mov_b32 m0, 56320
    s_add_u32 s49, s61, 122880
    buffer_load_dwordx4 v10, s[24:27], s49 offen offset:0 lds
    buffer_load_dwordx4 v11, s[24:27], s49 offen offset:1024 lds
    buffer_load_dwordx4 v12, s[24:27], s49 offen offset:2048 lds
    buffer_load_dwordx4 v13, s[24:27], s49 offen offset:3072 lds
    s_waitcnt vmcnt(18)
    s_barrier
    s_mov_b32 s51, 8921088
    buffer_load_dwordx2 v[32:33], v14, s[36:39], s51 offen offset:768 sc1
    buffer_load_dwordx2 v[34:35], v15, s[36:39], s51 offen offset:768 sc1
    buffer_load_dwordx2 v[36:37], v16, s[36:39], s51 offen offset:768 sc1
    s_xor_b32 s50, s60, 1152
    s_add_u32 s61, s55, s50
    s_add_u32 s49, s57, s50
    s_mov_b32 m0, 60416
    s_mov_b32 exec_lo, 0xffffff00
    buffer_load_dwordx4 v10, s[24:27], s49 offen lds
    s_mov_b32 exec_lo, -1
    buffer_load_dwordx4 v11, s[24:27], s49 offen offset:1024 lds
    s_mov_b32 m0, 62464
    s_add_u32 s49, s61, 0
    buffer_load_dwordx4 v10, s[24:27], s49 offen offset:0 lds
    buffer_load_dwordx4 v11, s[24:27], s49 offen offset:1024 lds
    buffer_load_dwordx4 v12, s[24:27], s49 offen offset:2048 lds
    buffer_load_dwordx4 v13, s[24:27], s49 offen offset:3072 lds
    s_mov_b32 m0, 66560
    s_add_u32 s49, s61, 40960
    buffer_load_dwordx4 v10, s[24:27], s49 offen offset:0 lds
    buffer_load_dwordx4 v11, s[24:27], s49 offen offset:1024 lds
    buffer_load_dwordx4 v12, s[24:27], s49 offen offset:2048 lds
    buffer_load_dwordx4 v13, s[24:27], s49 offen offset:3072 lds
    s_barrier
    s_mov_b32 m0, 70656
    s_add_u32 s49, s61, 81920
    buffer_load_dwordx4 v10, s[24:27], s49 offen offset:0 lds
    buffer_load_dwordx4 v11, s[24:27], s49 offen offset:1024 lds
    buffer_load_dwordx4 v12, s[24:27], s49 offen offset:2048 lds
    buffer_load_dwordx4 v13, s[24:27], s49 offen offset:3072 lds
    s_mov_b32 m0, 74752
    s_add_u32 s49, s61, 122880
    buffer_load_dwordx4 v10, s[24:27], s49 offen offset:0 lds
    buffer_load_dwordx4 v11, s[24:27], s49 offen offset:1024 lds
    buffer_load_dwordx4 v12, s[24:27], s49 offen offset:2048 lds
    buffer_load_dwordx4 v13, s[24:27], s49 offen offset:3072 lds
    s_waitcnt vmcnt(21)
    s_barrier
    s_add_u32 s49, s12, 81920
    buffer_load_dwordx4 v[64:67], v26, s[40:43], s49 offen
    buffer_load_dwordx4 v[68:71], v27, s[40:43], s49 offen offset:1024
    s_waitcnt vmcnt(20)
    s_barrier
    s_mov_b32 s67, 262144
    s_mov_b32 s51, 8921088
LQL_rc:
    v_xor_b32 v4, s58, v33
    v_xor_b32 v5, s58, v35
    v_or_b32 v4, v4, v5
    v_xor_b32 v5, s58, v37
    v_or_b32 v4, v4, v5
    v_cmp_ne_u32 vcc, 0, v4
    s_nop 0
    s_cmp_eq_u64 vcc, 0
    s_cbranch_scc1 LQL_rd
    s_sleep 4
    buffer_load_dwordx2 v[32:33], v14, s[36:39], s51 offen offset:768 sc1
    buffer_load_dwordx2 v[34:35], v15, s[36:39], s51 offen offset:768 sc1
    buffer_load_dwordx2 v[36:37], v16, s[36:39], s51 offen offset:768 sc1
    s_sub_u32 s67, s67, 1
    s_cmp_lg_u32 s67, 0
    s_waitcnt vmcnt(0)
    s_cbranch_scc1 LQL_rc
LQL_rd:
    s_add_u32 s49, s13, 81920
    buffer_load_dwordx4 v[72:75], v26, s[40:43], s49 offen
    buffer_load_dwordx4 v[76:79], v27, s[40:43], s49 offen offset:1024
    s_add_u32 s49, s15, 81920
    buffer_load_dwordx4 v[80:83], v26, s[40:43], s49 offen
    buffer_load_dwordx4 v[84:87], v27, s[40:43], s49 offen offset:1024
    s_add_u32 s49, s16, 81920
    buffer_load_dwordx4 v[88:91], v26, s[40:43], s49 offen
    buffer_load_dwordx4 v[92:95], v27, s[40:43], s49 offen offset:1024
    s_add_u32 s49, s17, 81920
    buffer_load_dwordx4 v[96:99], v26, s[40:43], s49 offen
    buffer_load_dwordx4 v[100:103], v27, s[40:43], s49 offen offset:1024
    v_lshlrev_b32 v6, 16, v32
    v_and_b32 v7, 0xffff0000, v32
    v_rcp_f32 v8, v7
    v_xor_b32 v6, 0x80000000, v6
    ds_write_b32 v21, v6 offset:0
    ds_write_b32 v21, v8 offset:640
    s_waitcnt vmcnt(10)
    s_barrier
    s_add_u32 s49, s19, 81920
    buffer_load_dwordx4 v[104:107], v26, s[40:43], s49 offen
    buffer_load_dwordx4 v[108:111], v27, s[40:43], s49 offen offset:1024
    buffer_load_dwordx4 v[112:115], v26, s[32:35], s4 offen
    buffer_load_dwordx4 v[116:119], v27, s[32:35], s4 offen offset:1024
    buffer_load_dwordx4 v[120:123], v26, s[32:35], s5 offen
    buffer_load_dwordx4 v[124:127], v27, s[32:35], s5 offen offset:1024
    buffer_load_dwordx4 v[128:131], v26, s[32:35], s7 offen
    buffer_load_dwordx4 v[132:135], v27, s[32:35], s7 offen offset:1024
    v_lshlrev_b32 v6, 16, v34
    v_and_b32 v7, 0xffff0000, v34
    v_rcp_f32 v8, v7
    v_xor_b32 v6, 0x80000000, v6
    ds_write_b32 v21, v6 offset:256
    ds_write_b32 v21, v8 offset:896
    v_lshlrev_b32 v6, 16, v36
    v_and_b32 v7, 0xffff0000, v36
    v_rcp_f32 v8, v7
    v_xor_b32 v6, 0x80000000, v6
    s_mov_b64 exec, 0xffff
    ds_write_b32 v21, v6 offset:512
    ds_write_b32 v21, v8 offset:1152
    s_mov_b64 exec, -1
    s_waitcnt lgkmcnt(0)
    s_barrier
    buffer_load_dwordx4 v[136:139], v26, s[32:35], s44 offen
    buffer_load_dwordx4 v[140:143], v27, s[32:35], s44 offen offset:1024
    buffer_load_dwordx4 v[144:147], v26, s[32:35], s45 offen
    buffer_load_dwordx4 v[148:151], v27, s[32:35], s45 offen offset:1024
    buffer_load_dwordx4 v[152:155], v26, s[32:35], s47 offen
    buffer_load_dwordx4 v[156:159], v27, s[32:35], s47 offen offset:1024
    s_add_u32 s49, s66, 0
    buffer_load_dwordx4 v[160:163], v26, s[32:35], s49 offen
    s_add_u32 s49, s49, 92160
    buffer_load_dwordx4 v[164:167], v27, s[32:35], s49 offen offset:1024
    s_barrier
    s_add_u32 s49, s66, 409600
    buffer_load_dwordx4 v[168:171], v26, s[32:35], s49 offen
    s_add_u32 s49, s49, 92160
    buffer_load_dwordx4 v[172:175], v27, s[32:35], s49 offen offset:1024
    s_add_u32 s49, s19, 40960
    buffer_load_dwordx4 v[176:179], v26, s[40:43], s49 offen
    buffer_load_dwordx4 v[180:183], v27, s[40:43], s49 offen offset:1024
    s_branch LQL_tail
L_QC:
    v_lshrrev_b32 v1, 5, v0
    v_mul_u32_u24 v1, 1280, v1
    v_and_b32 v2, 31, v0
    v_lshl_add_u32 v1, v2, 3, v1
    s_lshl_b32 s49, s23, 4
    s_add_u32 s49, s49, s3
    s_lshl_b32 s49, s49, 2
    s_add_u32 s49, s49, s22
    s_mul_i32 s49, s49, 2560
    s_getpc_b64 s[56:57]
L_pcQ:
    s_lshl_b32 s51, s53, 2
    s_add_u32 s51, s51, s22
    s_mul_i32 s51, s51, 384
    v_lshlrev_b32 v4, 7, v0
    v_add_u32 v4, s51, v4
    v_min_u32 v4, L_end-parallel_sum__sliding_local_dilated__dense_activation_silu__prompt_kernel, v4
    s_sub_u32 s56, s56, L_pcQ-parallel_sum__sliding_local_dilated__dense_activation_silu__prompt_kernel
    s_subb_u32 s57, s57, 0
    v_mov_b32 v5, s57
    v_add_co_u32 v4, vcc, s56, v4
    s_nop 1
    v_addc_co_u32 v5, vcc, 0, v5, vcc
    s_mov_b64 exec, 7
    global_load_dword v212, v[4:5], off
    s_mov_b64 exec, -1
    s_memrealtime s[58:59]
    s_waitcnt lgkmcnt(0)
    s_or_b32 s50, s2, s22
    s_cbranch_scc1 L_notag
    s_mov_b32 s24, s18
    s_mov_b32 s25, s19
    s_mov_b32 s26, 256
    s_mov_b32 s27, 0x20000
    s_or_b32 s58, s58, 1
    v_mov_b32 v4, s58
    v_mov_b32 v5, 0
    s_mov_b64 exec, 1
    buffer_store_dword v4, v5, s[24:27], 0 offen sc1
    s_mov_b64 exec, -1
L_notag:
    s_mov_b32 s24, s4
    s_mov_b32 s25, s5
    s_mov_b32 s26, 2621440
    s_mov_b32 s27, 0x20000
    buffer_load_dwordx2 v[200:201], v1, s[24:27], s49 offen offset:0
    buffer_load_dwordx2 v[202:203], v1, s[24:27], s49 offen offset:256
    buffer_load_dwordx2 v[204:205], v1, s[24:27], s49 offen offset:512
    buffer_load_dwordx2 v[206:207], v1, s[24:27], s49 offen offset:768
    buffer_load_dwordx2 v[208:209], v1, s[24:27], s49 offen offset:1024
    s_mov_b32 s36, s20
    s_mov_b32 s37, s21
    s_mov_b32 s38, 11640832
    s_mov_b32 s39, 0x20000
    s_mov_b32 s44, s16
    s_mov_b32 s45, s17
    s_mov_b32 s46, 2621440
    s_mov_b32 s47, 0x20000
    s_mov_b32 s28, s20
    s_mov_b32 s29, s21
    s_mov_b32 s30, 8912896
    s_mov_b32 s31, 0x20000
    s_lshr_b32 s50, s53, 1
    s_and_b32 s51, s53, 1
    s_add_u32 s51, s51, 6
    s_cmp_ge_u32 s53, 11
    s_cselect_b32 s52, 4, 3
    s_cselect_b32 s49, 8, 3
    s_sub_u32 s49, s53, s49
    s_cmp_lt_u32 s53, 6
    s_cselect_b32 s71, s50, s52
    s_cselect_b32 s70, s51, s49
    s_lshl_b32 s70, s70, 2
    s_lshr_b32 s50, s70, 1
    s_mul_i32 s11, s71, 3
    s_add_u32 s11, s11, s50
    s_lshr_b32 s49, s54, 1
    s_lshl_b32 s49, s49, 5
    s_add_u32 s70, s70, s49
    s_and_b32 s49, s54, 1
    s_mul_i32 s49, s49, 5
    s_add_u32 s71, s71, s49
    s_and_b32 s11, s11, 0
    s_and_b32 s60, s22, 1
    s_lshr_b32 s61, s22, 1
    s_mul_i32 s49, s60, 2
    s_add_u32 s49, s49, s70
    s_lshl_b32 s4, s49, 11
    s_lshl_b32 s50, s61, 10
    s_add_u32 s4, s4, s50
    s_mul_i32 s49, s49, 20480
    s_lshl_b32 s50, s71, 7
    s_lshl_b32 s51, s61, 6
    s_add_u32 s49, s49, s50
    s_add_u32 s6, s49, s51
    s_add_u32 s7, s6, 20480
    s_xor_b32 s12, s11, 0
    s_lshl_b32 s12, s12, 18
    s_add_u32 s12, s12, s4
    s_xor_b32 s13, s11, 1
    s_lshl_b32 s13, s13, 18
    s_add_u32 s13, s13, s4
    s_xor_b32 s14, s11, 2
    s_lshl_b32 s14, s14, 18
    s_add_u32 s14, s14, s4
    s_xor_b32 s15, s11, 3
    s_lshl_b32 s15, s15, 18
    s_add_u32 s15, s15, s4
    s_xor_b32 s16, s11, 4
    s_lshl_b32 s16, s16, 18
    s_add_u32 s16, s16, s4
    s_xor_b32 s17, s11, 5
    s_lshl_b32 s17, s17, 18
    s_add_u32 s17, s17, s4
    s_xor_b32 s18, s11, 6
    s_lshl_b32 s18, s18, 18
    s_add_u32 s18, s18, s4
    s_xor_b32 s19, s11, 7
    s_lshl_b32 s19, s19, 18
    s_add_u32 s19, s19, s4
    s_add_u32 s5, s4, 8650752
    s_add_u32 s4, s4, 8388608
    s_lshl_b32 s9, s23, 14
    s_lshl_b32 s49, s3, 10
    s_add_u32 s9, s9, s49
    s_add_u32 s9, s9, 8921088
    v_lshlrev_b32 v251, 4, v0
    v_add_u32 v250, 4096, v251
    v_lshrrev_b32 v1, 2, v0
    v_and_b32 v2, 3, v0
    v_mul_u32_u24 v3, 1280, v1
    v_lshl_add_u32 v247, v2, 4, v3
    v_mul_u32_u24 v3, 80, v1
    v_lshl_add_u32 v243, v2, 4, v3
    v_lshlrev_b32 v1, 7, v1
    v_lshl_add_u32 v1, v2, 3, v1
    v_bfe_u32 v2, v0, 3, 2
    s_lshl_b32 s49, s61, 12
    s_add_u32 s49, s49, 23552
    v_add_u32 v1, s49, v1
    s_lshl_b32 s49, s61, 1
    s_xor_b32 s50, s49, 0
    v_xor_b32 v3, s50, v2
    v_lshl_add_u32 v255, v3, 5, v1
    s_xor_b32 s50, s49, 1
    v_xor_b32 v3, s50, v2
    v_lshl_add_u32 v254, v3, 5, v1
    s_xor_b32 s50, s49, 2
    v_xor_b32 v3, s50, v2
    v_lshl_add_u32 v253, v3, 5, v1
    s_xor_b32 s50, s49, 3
    v_xor_b32 v3, s50, v2
    v_lshl_add_u32 v252, v3, 5, v1
    v_and_b32 v4, 15, v0
    v_lshlrev_b32 v1, 7, v4
    v_lshrrev_b32 v5, 4, v0
    v_lshl_add_u32 v1, v5, 3, v1
    v_bfe_u32 v2, v0, 1, 2
    s_mul_i32 s50, s60, 4096
    s_add_u32 s50, s50, 154624
    v_add_u32 v1, s50, v1
    s_xor_b32 s50, s49, 0
    v_xor_b32 v3, s50, v2
    v_lshl_add_u32 v249, v3, 5, v1
    s_xor_b32 s50, s49, 1
    v_xor_b32 v3, s50, v2
    v_lshl_add_u32 v248, v3, 5, v1
    s_mul_i32 s49, s22, 4096
    s_add_u32 s49, s49, 56320
    v_add_u32 v246, s49, v251
    s_xor_b32 s50, s22, 2
    s_mul_i32 s50, s50, 4096
    s_add_u32 s50, s50, 56320
    v_add_u32 v245, s50, v251
    v_mul_u32_u24 v1, 80, v4
    v_lshl_add_u32 v1, v5, 3, v1
    v_add_u32 v244, s50, v1
    v_add_u32 v243, s50, v243
    v_and_b32 v242, 0x30, v0
    v_lshlrev_b32 v241, 2, v4
    v_lshlrev_b32 v240, 3, v0
    v_and_b32 v239, 31, v0
    v_lshlrev_b32 v239, 4, v239
    v_lshrrev_b32 v1, 5, v0
    v_lshl_add_u32 v239, v1, 11, v239
    s_mov_b32 s58, 0xffff0000
    s_mov_b32 s59, -1
    s_mov_b32 s60, 0
    s_mov_b32 s61, -1
    s_mov_b32 s62, 0
    s_mov_b32 s63, 0xffff0000
    s_mov_b32 s64, 0xaaaaaaaa
    s_mov_b32 s65, 0xaaaaaaaa
    s_mov_b32 s66, 0xfff0ffff
    s_mov_b32 s67, 0xf000ff00
    s_mov_b32 s68, 0xffc0fffc
    s_mov_b32 s69, 0xc000fc00
    v_mov_b32 v1, 0x0c0c0100
    v_mov_b32 v2, 0x01000c0c
    v_cndmask_b32_e64 v234, v1, v2, s[64:65]
    v_mov_b32 v1, 0x0c0c0302
    v_mov_b32 v2, 0x03020c0c
    v_cndmask_b32_e64 v235, v1, v2, s[64:65]
    v_mov_b32 v1, 0x0c0c0c0c
    v_cndmask_b32_e64 v232, v234, v1, s[66:67]
    v_cndmask_b32_e64 v233, v235, v1, s[68:69]
    v_cndmask_b32_e64 v234, v1, v234, s[66:67]
    v_cndmask_b32_e64 v235, v1, v235, s[68:69]
    s_or_b32 s49, s23, s22
    s_cselect_b32 s74, 0, 0xf149f2ca
    s_lshl_b32 s49, s23, 2
    s_add_u32 s49, s49, s22
    s_lshl_b32 s49, s49, 12
    s_add_u32 s50, s48, 24
    s_lshl_b32 s50, s50, 18
    s_add_u32 s72, s50, s49
    s_lshr_b32 s51, s48, 2
    s_add_u32 s51, s51, 32
    s_lshl_b32 s51, s51, 18
    s_add_u32 s51, s51, s49
    s_and_b32 s52, s48, 3
    s_lshl_b32 s52, s52, 9
    s_add_u32 s73, s51, s52
    s_mul_i32 s49, s22, 5120
    v_add_u32 v238, s49, v240
    s_lshl_b32 s49, s22, 7
    s_add_u32 s49, s49, 64
    v_add_u32 v1, s49, v241
    v_and_b32 v2, 0x38, v241
    v_subrev_u32 v3, 0, v2
    v_and_b32 v3, 0x3f, v3
    v_sub_u32 v224, v1, v3
    v_subrev_u32 v3, 8, v2
    v_and_b32 v3, 0x3f, v3
    v_sub_u32 v225, v1, v3
    v_subrev_u32 v3, 16, v2
    v_and_b32 v3, 0x3f, v3
    v_sub_u32 v226, v1, v3
    v_subrev_u32 v3, 24, v2
    v_and_b32 v3, 0x3f, v3
    v_sub_u32 v227, v1, v3
    v_subrev_u32 v3, 32, v2
    v_and_b32 v3, 0x3f, v3
    v_sub_u32 v228, v1, v3
    v_subrev_u32 v3, 40, v2
    v_and_b32 v3, 0x3f, v3
    v_sub_u32 v229, v1, v3
    v_subrev_u32 v3, 48, v2
    v_and_b32 v3, 0x3f, v3
    v_sub_u32 v230, v1, v3
    v_subrev_u32 v3, 56, v2
    v_and_b32 v3, 0x3f, v3
    v_sub_u32 v231, v1, v3
    v_and_b32 v1, 15, v0
    v_lshrrev_b32 v2, 4, v0
    v_lshrrev_b32 v3, 1, v1
    v_xor_b32 v2, v2, v3
    v_lshlrev_b32 v1, 7, v1
    v_lshl_add_u32 v8, v2, 4, v1
    s_and_b32 s49, s10, 1
    s_lshl_b32 s49, s49, 6
    v_xor_b32 v8, s49, v8
    v_xor_b32 v9, 64, v8
    v_lshrrev_b32 v1, 2, v0
    v_mul_u32_u24 v1, 480, v1
    v_and_b32 v2, 3, v0
    v_lshl_add_u32 v5, v2, 3, v1
    s_mov_b32 s55, 78848
    s_mov_b32 s56, 60416
    v_add_u32 v4, s55, v5
    v_add_u32 v6, s56, v8
    v_add_u32 v7, s56, v9
    v_mov_b64 v[16:17], 0
    v_mov_b64 v[18:19], 0
    v_mov_b64 v[20:21], 0
    v_mov_b64 v[22:23], 0
    v_mov_b64 v[24:25], 0
    v_mov_b64 v[26:27], 0
    v_mov_b64 v[28:29], 0
    v_mov_b64 v[30:31], 0
    v_mov_b64 v[32:33], 0
    v_mov_b64 v[34:35], 0
    v_mov_b64 v[36:37], 0
    v_mov_b64 v[38:39], 0
    v_mov_b64 v[40:41], 0
    v_mov_b64 v[42:43], 0
    v_mov_b64 v[44:45], 0
    v_mov_b64 v[46:47], 0
    v_mov_b64 v[48:49], 0
    v_mov_b64 v[50:51], 0
    v_mov_b64 v[52:53], 0
    v_mov_b64 v[54:55], 0
    v_mov_b64 v[56:57], 0
    v_mov_b64 v[58:59], 0
    v_mov_b64 v[60:61], 0
    v_mov_b64 v[62:63], 0
    v_mov_b64 v[64:65], 0
    v_mov_b64 v[66:67], 0
    v_mov_b64 v[68:69], 0
    v_mov_b64 v[70:71], 0
    v_mov_b64 v[72:73], 0
    v_mov_b64 v[74:75], 0
    v_mov_b64 v[76:77], 0
    v_mov_b64 v[78:79], 0
    v_mov_b64 v[80:81], 0
    v_mov_b64 v[82:83], 0
    v_mov_b64 v[84:85], 0
    v_mov_b64 v[86:87], 0
    v_mov_b64 v[88:89], 0
    v_mov_b64 v[90:91], 0
    v_mov_b64 v[92:93], 0
    v_mov_b64 v[94:95], 0
    v_mov_b64 v[96:97], 0
    v_mov_b64 v[98:99], 0
    v_mov_b64 v[100:101], 0
    v_mov_b64 v[102:103], 0
    v_mov_b64 v[104:105], 0
    v_mov_b64 v[106:107], 0
    v_mov_b64 v[108:109], 0
    v_mov_b64 v[110:111], 0
    v_mov_b64 v[112:113], 0
    v_mov_b64 v[114:115], 0
    v_mov_b64 v[116:117], 0
    v_mov_b64 v[118:119], 0
    v_mov_b64 v[120:121], 0
    v_mov_b64 v[122:123], 0
    v_mov_b64 v[124:125], 0
    v_mov_b64 v[126:127], 0
    v_mov_b64 v[128:129], 0
    v_mov_b64 v[130:131], 0
    v_mov_b64 v[132:133], 0
    v_mov_b64 v[134:135], 0
    v_mov_b64 v[136:137], 0
    v_mov_b64 v[138:139], 0
    v_mov_b64 v[140:141], 0
    v_mov_b64 v[142:143], 0
    v_mov_b64 v[144:145], 0
    v_mov_b64 v[146:147], 0
    v_mov_b64 v[148:149], 0
    v_mov_b64 v[150:151], 0
    v_mov_b64 v[12:13], 0
    v_mov_b64 v[14:15], 0
    s_mov_b32 exec_lo, 0x00010001
    s_mov_b32 exec_hi, 0x00010001
    v_mov_b32 v12, 0x3f803f80
    v_mov_b32 v13, 0x3f803f80
    v_mov_b32 v14, 0x3f803f80
    v_mov_b32 v15, 0x3f803f80
    s_mov_b64 exec, -1
    s_waitcnt vmcnt(0)
    v_lshlrev_b32 v216, 16, v200
    v_and_b32 v200, 0xffff0000, v200
    v_add_f32 v214, v216, v200
    v_mul_f32 v215, v216, v216
    v_fmac_f32 v215, v200, v200
    v_lshlrev_b32 v216, 16, v201
    v_and_b32 v201, 0xffff0000, v201
    v_add_f32 v214, v214, v216
    v_fmac_f32 v215, v216, v216
    v_add_f32 v214, v214, v201
    v_fmac_f32 v215, v201, v201
    v_lshlrev_b32 v216, 16, v202
    v_and_b32 v202, 0xffff0000, v202
    v_add_f32 v214, v214, v216
    v_fmac_f32 v215, v216, v216
    v_add_f32 v214, v214, v202
    v_fmac_f32 v215, v202, v202
    v_lshlrev_b32 v216, 16, v203
    v_and_b32 v203, 0xffff0000, v203
    v_add_f32 v214, v214, v216
    v_fmac_f32 v215, v216, v216
    v_add_f32 v214, v214, v203
    v_fmac_f32 v215, v203, v203
    v_lshlrev_b32 v216, 16, v204
    v_and_b32 v204, 0xffff0000, v204
    v_add_f32 v214, v214, v216
    v_fmac_f32 v215, v216, v216
    v_add_f32 v214, v214, v204
    v_fmac_f32 v215, v204, v204
    v_lshlrev_b32 v216, 16, v205
    v_and_b32 v205, 0xffff0000, v205
    v_add_f32 v214, v214, v216
    v_fmac_f32 v215, v216, v216
    v_add_f32 v214, v214, v205
    v_fmac_f32 v215, v205, v205
    v_lshlrev_b32 v216, 16, v206
    v_and_b32 v206, 0xffff0000, v206
    v_add_f32 v214, v214, v216
    v_fmac_f32 v215, v216, v216
    v_add_f32 v214, v214, v206
    v_fmac_f32 v215, v206, v206
    v_lshlrev_b32 v216, 16, v207
    v_and_b32 v207, 0xffff0000, v207
    v_add_f32 v214, v214, v216
    v_fmac_f32 v215, v216, v216
    v_add_f32 v214, v214, v207
    v_fmac_f32 v215, v207, v207
    v_lshlrev_b32 v216, 16, v208
    v_and_b32 v208, 0xffff0000, v208
    v_add_f32 v214, v214, v216
    v_fmac_f32 v215, v216, v216
    v_add_f32 v214, v214, v208
    v_fmac_f32 v215, v208, v208
    v_lshlrev_b32 v216, 16, v209
    v_and_b32 v209, 0xffff0000, v209
    v_add_f32 v214, v214, v216
    v_fmac_f32 v215, v216, v216
    v_add_f32 v214, v214, v209
    v_fmac_f32 v215, v209, v209
    s_nop 0
    v_add_f32_dpp v214, v214, v214 quad_perm:[1,0,3,2] row_mask:0xf bank_mask:0xf
    v_add_f32_dpp v215, v215, v215 quad_perm:[1,0,3,2] row_mask:0xf bank_mask:0xf
    s_nop 0
    v_add_f32_dpp v214, v214, v214 quad_perm:[2,3,0,1] row_mask:0xf bank_mask:0xf
    v_add_f32_dpp v215, v215, v215 quad_perm:[2,3,0,1] row_mask:0xf bank_mask:0xf
    s_nop 0
    v_add_f32_dpp v214, v214, v214 row_half_mirror row_mask:0xf bank_mask:0xf
    v_add_f32_dpp v215, v215, v215 row_half_mirror row_mask:0xf bank_mask:0xf
    s_nop 0
    v_add_f32_dpp v214, v214, v214 row_mirror row_mask:0xf bank_mask:0xf
    v_add_f32_dpp v215, v215, v215 row_mirror row_mask:0xf bank_mask:0xf
    v_mov_b32 v216, v214
    v_mov_b32 v217, v215
    s_nop 0
    v_permlane16_swap_b32 v214, v216
    v_permlane16_swap_b32 v215, v217
    v_add_f32 v214, v214, v216
    v_add_f32 v215, v215, v217
    v_mul_f32 v214, 0x3acccccd, v214
    v_mul_f32 v215, 0x3acccccd, v215
    v_fma_f32 v215, -v214, v214, v215
    v_max_f32 v215, 0, v215
    v_cvt_pk_bf16_f32 v215, v215, v215
    v_and_b32 v215, 0xffff0000, v215
    v_add_f32 v215, 0x3727c5ac, v215
    v_cvt_pk_bf16_f32 v215, v215, v215
    v_and_b32 v215, 0xffff0000, v215
    v_sqrt_f32 v215, v215
    s_nop 0
    v_cvt_pk_bf16_f32 v214, v214, v215
    v_lshrrev_b32 v216, 3, v0
    s_lshl_b32 s49, s22, 3
    v_add_u32 v216, s49, v216
    s_mov_b32 exec_lo, 1
    s_mov_b32 exec_hi, 1
    ds_write_b32 v216, v214 offset:2944
    s_mov_b64 exec, -1
    s_waitcnt lgkmcnt(0)
    s_cmp_eq_u32 s22, 1
    s_cbranch_scc1 L_QC1
    s_cmp_eq_u32 s22, 2
    s_cbranch_scc1 L_QC2
    s_cmp_eq_u32 s22, 3
    s_cbranch_scc1 L_QC3
    s_barrier
    ds_read_b128 v[192:195], v6 offset:2048
    ds_read_b128 v[196:199], v6 offset:4096
    ds_read_b128 v[200:203], v6 offset:0
    ds_read_b64_tr_b16 v[152:153], v4 offset:0
    ds_read_b64_tr_b16 v[154:155], v4 offset:7680
    ds_read_b64_tr_b16 v[156:157], v4 offset:32
    ds_read_b64_tr_b16 v[158:159], v4 offset:7712
    ds_read_b64_tr_b16 v[160:161], v4 offset:64
    ds_read_b64_tr_b16 v[162:163], v4 offset:7744
    ds_read_b64_tr_b16 v[164:165], v4 offset:96
    ds_read_b64_tr_b16 v[166:167], v4 offset:7776
    s_mov_b32 s57, 10
.p2align 6
LQC0_loop:
    s_waitcnt lgkmcnt(6)
    v_mfma_f32_16x16x32_bf16 v[16:19], v[152:155], v[192:195], v[16:19]
    ds_read_b64_tr_b16 v[168:169], v4 offset:128
    s_add_u32 s55, s55, 15360
    v_mfma_f32_16x16x32_bf16 v[136:139], v[152:155], v[12:15], v[136:139]
    ds_read_b64_tr_b16 v[170:171], v4 offset:7808
    s_cmp_ge_u32 s55, 155648
    v_mfma_f32_16x16x32_bf16 v[76:79], v[152:155], v[196:199], v[76:79]
    ds_read_b64_tr_b16 v[172:173], v4 offset:160
    s_waitcnt lgkmcnt(7)
    v_mfma_f32_16x16x32_bf16 v[80:83], v[156:159], v[196:199], v[80:83]
    ds_read_b64_tr_b16 v[174:175], v4 offset:7840
    s_cselect_b32 s55, 78848, s55
    v_mfma_f32_16x16x32_bf16 v[20:23], v[156:159], v[192:195], v[20:23]
    ds_read_b64_tr_b16 v[176:177], v4 offset:192
    s_waitcnt lgkmcnt(7)
    v_mfma_f32_16x16x32_bf16 v[24:27], v[160:163], v[192:195], v[24:27]
    ds_read_b64_tr_b16 v[178:179], v4 offset:7872
    v_add_u32 v10, s55, v5
    v_mfma_f32_16x16x32_bf16 v[84:87], v[160:163], v[196:199], v[84:87]
    ds_read_b64_tr_b16 v[180:181], v4 offset:224
    s_waitcnt lgkmcnt(7)
    v_mfma_f32_16x16x32_bf16 v[88:91], v[164:167], v[196:199], v[88:91]
    ds_read_b64_tr_b16 v[182:183], v4 offset:7904
    v_mfma_f32_16x16x32_bf16 v[28:31], v[164:167], v[192:195], v[28:31]
    ds_read_b64_tr_b16 v[184:185], v4 offset:256
    s_waitcnt lgkmcnt(7)
    v_mfma_f32_16x16x32_bf16 v[32:35], v[168:171], v[192:195], v[32:35]
    ds_read_b64_tr_b16 v[186:187], v4 offset:7936
    v_mfma_f32_16x16x32_bf16 v[140:143], v[168:171], v[12:15], v[140:143]
    ds_read_b64_tr_b16 v[188:189], v4 offset:288
    v_mfma_f32_16x16x32_bf16 v[92:95], v[168:171], v[196:199], v[92:95]
    ds_read_b64_tr_b16 v[190:191], v4 offset:7968
    s_waitcnt lgkmcnt(8)
    v_mfma_f32_16x16x32_bf16 v[96:99], v[172:175], v[196:199], v[96:99]
    ds_read_b64_tr_b16 v[152:153], v4 offset:320
    v_mfma_f32_16x16x32_bf16 v[36:39], v[172:175], v[192:195], v[36:39]
    ds_read_b64_tr_b16 v[154:155], v4 offset:8000
    s_waitcnt lgkmcnt(8)
    v_mfma_f32_16x16x32_bf16 v[40:43], v[176:179], v[192:195], v[40:43]
    ds_read_b64_tr_b16 v[156:157], v4 offset:352
    v_mfma_f32_16x16x32_bf16 v[100:103], v[176:179], v[196:199], v[100:103]
    ds_read_b64_tr_b16 v[158:159], v4 offset:8032
    s_waitcnt lgkmcnt(8)
    v_mfma_f32_16x16x32_bf16 v[104:107], v[180:183], v[196:199], v[104:107]
    ds_read_b64_tr_b16 v[160:161], v4 offset:384
    v_mfma_f32_16x16x32_bf16 v[44:47], v[180:183], v[192:195], v[44:47]
    ds_read_b64_tr_b16 v[162:163], v4 offset:8064
    s_waitcnt lgkmcnt(8)
    v_mfma_f32_16x16x32_bf16 v[48:51], v[184:187], v[192:195], v[48:51]
    ds_read_b64_tr_b16 v[164:165], v4 offset:416
    v_mfma_f32_16x16x32_bf16 v[144:147], v[184:187], v[200:203], v[144:147]
    ds_read_b64_tr_b16 v[166:167], v4 offset:8096
    v_mfma_f32_16x16x32_bf16 v[108:111], v[184:187], v[196:199], v[108:111]
    ds_read_b64_tr_b16 v[168:169], v4 offset:448
    s_waitcnt lgkmcnt(9)
    v_mfma_f32_16x16x32_bf16 v[112:115], v[188:191], v[196:199], v[112:115]
    ds_read_b64_tr_b16 v[170:171], v4 offset:8128
    v_mfma_f32_16x16x32_bf16 v[52:55], v[188:191], v[192:195], v[52:55]
    s_waitcnt lgkmcnt(8)
    v_mfma_f32_16x16x32_bf16 v[56:59], v[192:195], v[152:155], v[56:59]
    s_barrier
    ds_read_b128 v[204:207], v7 offset:2048
    v_mfma_f32_16x16x32_bf16 v[116:119], v[196:199], v[152:155], v[116:119]
    ds_read_b128 v[208:211], v7 offset:4096
    s_waitcnt lgkmcnt(8)
    v_mfma_f32_16x16x32_bf16 v[120:123], v[196:199], v[156:159], v[120:123]
    ds_read_b128 v[212:215], v7 offset:0
    v_mfma_f32_16x16x32_bf16 v[60:63], v[192:195], v[156:159], v[60:63]
    ds_read_b64_tr_b16 v[172:173], v10 offset:0
    s_waitcnt lgkmcnt(8)
    v_mfma_f32_16x16x32_bf16 v[64:67], v[192:195], v[160:163], v[64:67]
    ds_read_b64_tr_b16 v[174:175], v10 offset:7680
    v_mfma_f32_16x16x32_bf16 v[148:151], v[200:203], v[160:163], v[148:151]
    ds_read_b64_tr_b16 v[176:177], v10 offset:32
    v_mfma_f32_16x16x32_bf16 v[124:127], v[196:199], v[160:163], v[124:127]
    ds_read_b64_tr_b16 v[178:179], v10 offset:7712
    s_waitcnt lgkmcnt(9)
    v_mfma_f32_16x16x32_bf16 v[128:131], v[196:199], v[164:167], v[128:131]
    ds_read_b64_tr_b16 v[180:181], v10 offset:64
    v_mfma_f32_16x16x32_bf16 v[68:71], v[192:195], v[164:167], v[68:71]
    ds_read_b64_tr_b16 v[182:183], v10 offset:7744
    s_waitcnt lgkmcnt(9)
    v_mfma_f32_16x16x32_bf16 v[72:75], v[192:195], v[168:171], v[72:75]
    ds_read_b64_tr_b16 v[184:185], v10 offset:96
    v_mfma_f32_16x16x32_bf16 v[132:135], v[196:199], v[168:171], v[132:135]
    ds_read_b64_tr_b16 v[186:187], v10 offset:7776
    s_waitcnt lgkmcnt(6)
    v_mfma_f32_16x16x32_bf16 v[16:19], v[172:175], v[204:207], v[16:19]
    ds_read_b64_tr_b16 v[188:189], v10 offset:128
    s_add_u32 s55, s55, 15360
    v_mfma_f32_16x16x32_bf16 v[136:139], v[172:175], v[12:15], v[136:139]
    ds_read_b64_tr_b16 v[190:191], v10 offset:7808
    s_cmp_ge_u32 s55, 155648
    v_mfma_f32_16x16x32_bf16 v[76:79], v[172:175], v[208:211], v[76:79]
    ds_read_b64_tr_b16 v[152:153], v10 offset:160
    s_waitcnt lgkmcnt(7)
    v_mfma_f32_16x16x32_bf16 v[80:83], v[176:179], v[208:211], v[80:83]
    ds_read_b64_tr_b16 v[154:155], v10 offset:7840
    s_cselect_b32 s55, 78848, s55
    v_mfma_f32_16x16x32_bf16 v[20:23], v[176:179], v[204:207], v[20:23]
    ds_read_b64_tr_b16 v[156:157], v10 offset:192
    s_waitcnt lgkmcnt(7)
    v_mfma_f32_16x16x32_bf16 v[24:27], v[180:183], v[204:207], v[24:27]
    ds_read_b64_tr_b16 v[158:159], v10 offset:7872
    v_add_u32 v4, s55, v5
    v_mfma_f32_16x16x32_bf16 v[84:87], v[180:183], v[208:211], v[84:87]
    ds_read_b64_tr_b16 v[160:161], v10 offset:224
    s_waitcnt lgkmcnt(7)
    v_mfma_f32_16x16x32_bf16 v[88:91], v[184:187], v[208:211], v[88:91]
    ds_read_b64_tr_b16 v[162:163], v10 offset:7904
    s_add_u32 s56, s56, 18432
    v_mfma_f32_16x16x32_bf16 v[28:31], v[184:187], v[204:207], v[28:31]
    ds_read_b64_tr_b16 v[164:165], v10 offset:256
    s_waitcnt lgkmcnt(7)
    v_mfma_f32_16x16x32_bf16 v[32:35], v[188:191], v[204:207], v[32:35]
    ds_read_b64_tr_b16 v[166:167], v10 offset:7936
    s_cmp_ge_u32 s56, 78848
    v_mfma_f32_16x16x32_bf16 v[140:143], v[188:191], v[12:15], v[140:143]
    ds_read_b64_tr_b16 v[168:169], v10 offset:288
    s_cselect_b32 s56, 23552, s56
    v_mfma_f32_16x16x32_bf16 v[92:95], v[188:191], v[208:211], v[92:95]
    ds_read_b64_tr_b16 v[170:171], v10 offset:7968
    s_waitcnt lgkmcnt(8)
    v_mfma_f32_16x16x32_bf16 v[96:99], v[152:155], v[208:211], v[96:99]
    ds_read_b64_tr_b16 v[172:173], v10 offset:320
    v_add_u32 v6, s56, v8
    v_mfma_f32_16x16x32_bf16 v[36:39], v[152:155], v[204:207], v[36:39]
    ds_read_b64_tr_b16 v[174:175], v10 offset:8000
    s_waitcnt lgkmcnt(8)
    v_mfma_f32_16x16x32_bf16 v[40:43], v[156:159], v[204:207], v[40:43]
    ds_read_b64_tr_b16 v[176:177], v10 offset:352
    v_add_u32 v7, s56, v9
    v_mfma_f32_16x16x32_bf16 v[100:103], v[156:159], v[208:211], v[100:103]
    ds_read_b64_tr_b16 v[178:179], v10 offset:8032
    s_waitcnt lgkmcnt(8)
    v_mfma_f32_16x16x32_bf16 v[104:107], v[160:163], v[208:211], v[104:107]
    ds_read_b64_tr_b16 v[180:181], v10 offset:384
    s_sub_u32 s57, s57, 1
    v_mfma_f32_16x16x32_bf16 v[44:47], v[160:163], v[204:207], v[44:47]
    ds_read_b64_tr_b16 v[182:183], v10 offset:8064
    s_waitcnt lgkmcnt(8)
    v_mfma_f32_16x16x32_bf16 v[48:51], v[164:167], v[204:207], v[48:51]
    ds_read_b64_tr_b16 v[184:185], v10 offset:416
    s_cmp_lg_u32 s57, 0
    v_mfma_f32_16x16x32_bf16 v[144:147], v[164:167], v[212:215], v[144:147]
    ds_read_b64_tr_b16 v[186:187], v10 offset:8096
    v_mfma_f32_16x16x32_bf16 v[108:111], v[164:167], v[208:211], v[108:111]
    ds_read_b64_tr_b16 v[188:189], v10 offset:448
    s_waitcnt lgkmcnt(9)
    v_mfma_f32_16x16x32_bf16 v[112:115], v[168:171], v[208:211], v[112:115]
    ds_read_b64_tr_b16 v[190:191], v10 offset:8128
    v_mfma_f32_16x16x32_bf16 v[52:55], v[168:171], v[204:207], v[52:55]
    s_waitcnt lgkmcnt(8)
    v_mfma_f32_16x16x32_bf16 v[56:59], v[204:207], v[172:175], v[56:59]
    s_barrier
    ds_read_b128 v[192:195], v6 offset:2048
    v_mfma_f32_16x16x32_bf16 v[116:119], v[208:211], v[172:175], v[116:119]
    ds_read_b128 v[196:199], v6 offset:4096
    s_waitcnt lgkmcnt(8)
    v_mfma_f32_16x16x32_bf16 v[120:123], v[208:211], v[176:179], v[120:123]
    ds_read_b128 v[200:203], v6 offset:0
    v_mfma_f32_16x16x32_bf16 v[60:63], v[204:207], v[176:179], v[60:63]
    ds_read_b64_tr_b16 v[152:153], v4 offset:0
    s_waitcnt lgkmcnt(8)
    v_mfma_f32_16x16x32_bf16 v[64:67], v[204:207], v[180:183], v[64:67]
    ds_read_b64_tr_b16 v[154:155], v4 offset:7680
    v_mfma_f32_16x16x32_bf16 v[148:151], v[212:215], v[180:183], v[148:151]
    ds_read_b64_tr_b16 v[156:157], v4 offset:32
    v_mfma_f32_16x16x32_bf16 v[124:127], v[208:211], v[180:183], v[124:127]
    ds_read_b64_tr_b16 v[158:159], v4 offset:7712
    s_waitcnt lgkmcnt(9)
    v_mfma_f32_16x16x32_bf16 v[128:131], v[208:211], v[184:187], v[128:131]
    ds_read_b64_tr_b16 v[160:161], v4 offset:64
    v_mfma_f32_16x16x32_bf16 v[68:71], v[204:207], v[184:187], v[68:71]
    ds_read_b64_tr_b16 v[162:163], v4 offset:7744
    s_waitcnt lgkmcnt(9)
    v_mfma_f32_16x16x32_bf16 v[72:75], v[204:207], v[188:191], v[72:75]
    ds_read_b64_tr_b16 v[164:165], v4 offset:96
    v_mfma_f32_16x16x32_bf16 v[132:135], v[208:211], v[188:191], v[132:135]
    ds_read_b64_tr_b16 v[166:167], v4 offset:7776
    s_cbranch_scc1 LQC0_loop
    s_mov_b32 exec_lo, 0x00010001
    s_mov_b32 exec_hi, 0x00010001
    ds_write_b128 v242, v[136:139] offset:1920
    ds_write_b128 v242, v[140:143] offset:2176
    ds_write_b128 v242, v[144:147] offset:2432
    s_mov_b64 exec, 0xffff
    ds_write_b32 v241, v148 offset:2688
    s_mov_b64 exec, -1
    s_waitcnt vmcnt(0) lgkmcnt(0)
    ds_read_b32 v6, v241 offset:0
    ds_read_b128 v[200:203], v242 offset:0
    ds_read_b32 v4, v241 offset:128
    ds_read_b32 v5, v241 offset:768
    ds_read_b128 v[12:15], v242 offset:128
    ds_read_b32 v2, v241 offset:64
    ds_read_b32 v3, v241 offset:704
    ds_read_b128 v[8:11], v242 offset:64
    s_barrier
    ds_read_b128 v[152:155], v242 offset:2240
    ds_read_b128 v[156:159], v242 offset:2304
    ds_read_b128 v[160:163], v242 offset:2368
    ds_read_b128 v[164:167], v242 offset:2432
    ds_read_b128 v[168:171], v242 offset:2496
    s_waitcnt lgkmcnt(5)
    ds_read_b32 v172, v241 offset:2560
    ds_read_b32 v173, v241 offset:2624
    ds_read_b32 v174, v241 offset:2688
    ds_read_b32 v175, v241 offset:2752
    ds_read_b32 v176, v241 offset:2816
    s_waitcnt lgkmcnt(9)
    v_pk_fma_f32 v[96:97], v[152:153], v[4:5], v[96:97] op_sel_hi:[1,0,1]
    v_pk_fma_f32 v[98:99], v[154:155], v[4:5], v[98:99] op_sel_hi:[1,0,1]
    v_cvt_pk_bf16_f32 v178, v96, v97
    v_cvt_pk_bf16_f32 v179, v98, v99
    ds_write_b64 v240, v[178:179] offset:8192
    s_waitcnt lgkmcnt(9)
    v_pk_fma_f32 v[100:101], v[156:157], v[4:5], v[100:101] op_sel_hi:[1,0,1]
    v_pk_fma_f32 v[102:103], v[158:159], v[4:5], v[102:103] op_sel_hi:[1,0,1]
    v_cvt_pk_bf16_f32 v180, v100, v101
    v_cvt_pk_bf16_f32 v181, v102, v103
    ds_write_b64 v240, v[180:181] offset:8704
    s_waitcnt lgkmcnt(9)
    v_pk_fma_f32 v[104:105], v[160:161], v[4:5], v[104:105] op_sel_hi:[1,0,1]
    v_pk_fma_f32 v[106:107], v[162:163], v[4:5], v[106:107] op_sel_hi:[1,0,1]
    v_cvt_pk_bf16_f32 v182, v104, v105
    v_cvt_pk_bf16_f32 v183, v106, v107
    ds_write_b64 v240, v[182:183] offset:9216
    s_waitcnt lgkmcnt(9)
    v_pk_fma_f32 v[108:109], v[164:165], v[4:5], v[108:109] op_sel_hi:[1,0,1]
    v_pk_fma_f32 v[110:111], v[166:167], v[4:5], v[110:111] op_sel_hi:[1,0,1]
    v_cvt_pk_bf16_f32 v184, v108, v109
    v_cvt_pk_bf16_f32 v185, v110, v111
    ds_write_b64 v240, v[184:185] offset:9728
    s_waitcnt lgkmcnt(9)
    v_pk_fma_f32 v[112:113], v[168:169], v[4:5], v[112:113] op_sel_hi:[1,0,1]
    v_pk_fma_f32 v[114:115], v[170:171], v[4:5], v[114:115] op_sel_hi:[1,0,1]
    v_cvt_pk_bf16_f32 v186, v112, v113
    v_cvt_pk_bf16_f32 v187, v114, v115
    ds_write_b64 v240, v[186:187] offset:10240
    s_waitcnt lgkmcnt(5)
    ds_read_b128 v[96:99], v242 offset:1920
    ds_read_b128 v[100:103], v242 offset:1984
    ds_read_b128 v[104:107], v242 offset:2048
    ds_read_b128 v[108:111], v242 offset:2112
    ds_read_b128 v[112:115], v242 offset:2176
    v_pk_fma_f32 v[116:117], v[12:13], v[172:173], v[116:117] op_sel:[0,0,0] op_sel_hi:[1,0,1]
    v_pk_fma_f32 v[118:119], v[14:15], v[172:173], v[118:119] op_sel:[0,0,0] op_sel_hi:[1,0,1]
    v_cvt_pk_bf16_f32 v192, v116, v117
    v_cvt_pk_bf16_f32 v193, v118, v119
    ds_write_b64 v240, v[192:193] offset:10752
    v_pk_fma_f32 v[120:121], v[12:13], v[172:173], v[120:121] op_sel:[0,1,0] op_sel_hi:[1,1,1]
    v_pk_fma_f32 v[122:123], v[14:15], v[172:173], v[122:123] op_sel:[0,1,0] op_sel_hi:[1,1,1]
    v_cvt_pk_bf16_f32 v198, v120, v121
    v_cvt_pk_bf16_f32 v199, v122, v123
    ds_write_b64 v240, v[198:199] offset:11264
    v_pk_fma_f32 v[124:125], v[12:13], v[174:175], v[124:125] op_sel:[0,0,0] op_sel_hi:[1,0,1]
    v_pk_fma_f32 v[126:127], v[14:15], v[174:175], v[126:127] op_sel:[0,0,0] op_sel_hi:[1,0,1]
    v_cvt_pk_bf16_f32 v208, v124, v125
    v_cvt_pk_bf16_f32 v209, v126, v127
    ds_write_b64 v240, v[208:209] offset:11776
    v_pk_fma_f32 v[128:129], v[12:13], v[174:175], v[128:129] op_sel:[0,1,0] op_sel_hi:[1,1,1]
    v_pk_fma_f32 v[130:131], v[14:15], v[174:175], v[130:131] op_sel:[0,1,0] op_sel_hi:[1,1,1]
    v_cvt_pk_bf16_f32 v214, v128, v129
    v_cvt_pk_bf16_f32 v215, v130, v131
    ds_write_b64 v240, v[214:215] offset:12288
    v_pk_fma_f32 v[132:133], v[12:13], v[176:177], v[132:133] op_sel:[0,0,0] op_sel_hi:[1,0,1]
    v_pk_fma_f32 v[134:135], v[14:15], v[176:177], v[134:135] op_sel:[0,0,0] op_sel_hi:[1,0,1]
    v_cvt_pk_bf16_f32 v220, v132, v133
    v_cvt_pk_bf16_f32 v221, v134, v135
    ds_write_b64 v240, v[220:221] offset:12800
    s_waitcnt lgkmcnt(8)
    v_pk_fma_f32 v[144:145], v[164:165], v[6:7], v[144:145] op_sel_hi:[1,0,1]
    v_pk_fma_f32 v[146:147], v[166:167], v[6:7], v[146:147] op_sel_hi:[1,0,1]
    v_cvt_pk_bf16_f32 v144, v144, v145
    v_cvt_pk_bf16_f32 v145, v146, v147
    ds_write_b64 v240, v[144:145] offset:4608
    v_pk_fma_f32 v[148:149], v[200:201], v[174:175], v[148:149] op_sel:[0,0,0] op_sel_hi:[1,0,1]
    v_pk_fma_f32 v[150:151], v[202:203], v[174:175], v[150:151] op_sel:[0,0,0] op_sel_hi:[1,0,1]
    v_cvt_pk_bf16_f32 v148, v148, v149
    v_cvt_pk_bf16_f32 v149, v150, v151
    ds_write_b64 v240, v[148:149] offset:6656
LQC_common:
    v_pk_fma_f32 v[36:37], v[152:153], v[2:3], v[36:37] op_sel_hi:[1,0,1]
    v_pk_fma_f32 v[38:39], v[154:155], v[2:3], v[38:39] op_sel_hi:[1,0,1]
    v_cvt_pk_bf16_f32 v116, v36, v37
    v_cvt_pk_bf16_f32 v117, v38, v39
    v_pk_fma_f32 v[40:41], v[156:157], v[2:3], v[40:41] op_sel_hi:[1,0,1]
    v_pk_fma_f32 v[42:43], v[158:159], v[2:3], v[42:43] op_sel_hi:[1,0,1]
    v_cvt_pk_bf16_f32 v118, v40, v41
    v_cvt_pk_bf16_f32 v119, v42, v43
    v_pk_fma_f32 v[44:45], v[160:161], v[2:3], v[44:45] op_sel_hi:[1,0,1]
    v_pk_fma_f32 v[46:47], v[162:163], v[2:3], v[46:47] op_sel_hi:[1,0,1]
    v_cvt_pk_bf16_f32 v120, v44, v45
    v_cvt_pk_bf16_f32 v121, v46, v47
    v_pk_fma_f32 v[48:49], v[164:165], v[2:3], v[48:49] op_sel_hi:[1,0,1]
    v_pk_fma_f32 v[50:51], v[166:167], v[2:3], v[50:51] op_sel_hi:[1,0,1]
    v_cvt_pk_bf16_f32 v122, v48, v49
    v_cvt_pk_bf16_f32 v123, v50, v51
    v_pk_fma_f32 v[52:53], v[168:169], v[2:3], v[52:53] op_sel_hi:[1,0,1]
    v_pk_fma_f32 v[54:55], v[170:171], v[2:3], v[54:55] op_sel_hi:[1,0,1]
    v_cvt_pk_bf16_f32 v124, v52, v53
    v_cvt_pk_bf16_f32 v125, v54, v55
    s_waitcnt lgkmcnt(0)
    ds_read_b32 v136, v224 offset:704
    ds_read_b32 v137, v225 offset:704
    ds_read_b32 v138, v226 offset:704
    ds_read_b32 v139, v227 offset:704
    ds_read_b32 v140, v228 offset:704
    ds_read_b32 v141, v229 offset:704
    ds_read_b32 v142, v230 offset:704
    ds_read_b32 v143, v231 offset:704
    v_pk_fma_f32 v[76:77], v[96:97], v[4:5], v[76:77] op_sel_hi:[1,0,1]
    v_pk_fma_f32 v[78:79], v[98:99], v[4:5], v[78:79] op_sel_hi:[1,0,1]
    v_cvt_pk_bf16_f32 v152, v76, v77
    v_cvt_pk_bf16_f32 v153, v78, v79
    v_pk_fma_f32 v[80:81], v[100:101], v[4:5], v[80:81] op_sel_hi:[1,0,1]
    v_pk_fma_f32 v[82:83], v[102:103], v[4:5], v[82:83] op_sel_hi:[1,0,1]
    v_cvt_pk_bf16_f32 v80, v80, v81
    v_cvt_pk_bf16_f32 v81, v82, v83
    v_cndmask_b32_e64 v156, 0, v80, s[58:59]
    v_cndmask_b32_e64 v154, v80, 0, s[58:59]
    v_cndmask_b32_e64 v157, 0, v81, s[58:59]
    v_cndmask_b32_e64 v155, v81, 0, s[58:59]
    v_pk_fma_f32 v[84:85], v[104:105], v[4:5], v[84:85] op_sel_hi:[1,0,1]
    v_pk_fma_f32 v[86:87], v[106:107], v[4:5], v[86:87] op_sel_hi:[1,0,1]
    v_cvt_pk_bf16_f32 v84, v84, v85
    v_cvt_pk_bf16_f32 v85, v86, v87
    v_cndmask_b32_e64 v160, 0, v84, s[60:61]
    v_cndmask_b32_e64 v158, v84, 0, s[60:61]
    v_cndmask_b32_e64 v161, 0, v85, s[60:61]
    v_cndmask_b32_e64 v159, v85, 0, s[60:61]
    v_pk_fma_f32 v[88:89], v[108:109], v[4:5], v[88:89] op_sel_hi:[1,0,1]
    v_pk_fma_f32 v[90:91], v[110:111], v[4:5], v[90:91] op_sel_hi:[1,0,1]
    v_cvt_pk_bf16_f32 v88, v88, v89
    v_cvt_pk_bf16_f32 v89, v90, v91
    v_cndmask_b32_e64 v164, 0, v88, s[62:63]
    v_cndmask_b32_e64 v162, v88, 0, s[62:63]
    v_cndmask_b32_e64 v165, 0, v89, s[62:63]
    v_cndmask_b32_e64 v163, v89, 0, s[62:63]
    v_pk_fma_f32 v[92:93], v[112:113], v[4:5], v[92:93] op_sel_hi:[1,0,1]
    v_pk_fma_f32 v[94:95], v[114:115], v[4:5], v[94:95] op_sel_hi:[1,0,1]
    v_cvt_pk_bf16_f32 v166, v92, v93
    v_cvt_pk_bf16_f32 v167, v94, v95
    v_mfma_f32_16x16x32_bf16 v[52:55], v[178:181], v[152:155], 0
    v_pk_fma_f32 v[16:17], v[96:97], v[2:3], v[16:17] op_sel_hi:[1,0,1]
    v_pk_fma_f32 v[18:19], v[98:99], v[2:3], v[18:19] op_sel_hi:[1,0,1]
    v_mfma_f32_16x16x32_bf16 v[88:91], v[116:119], v[152:155], 0
    v_cvt_pk_bf16_f32 v36, v16, v17
    v_cvt_pk_bf16_f32 v37, v18, v19
    v_mfma_f32_16x16x32_bf16 v[76:79], v[180:183], v[156:159], 0
    v_pk_fma_f32 v[20:21], v[100:101], v[2:3], v[20:21] op_sel_hi:[1,0,1]
    v_pk_fma_f32 v[22:23], v[102:103], v[2:3], v[22:23] op_sel_hi:[1,0,1]
    v_mfma_f32_16x16x32_bf16 v[92:95], v[118:121], v[156:159], 0
    v_cvt_pk_bf16_f32 v20, v20, v21
    v_cvt_pk_bf16_f32 v21, v22, v23
    v_mfma_f32_16x16x32_bf16 v[80:83], v[182:185], v[160:163], 0
    v_cndmask_b32_e64 v40, 0, v20, s[58:59]
    v_cndmask_b32_e64 v38, v20, 0, s[58:59]
    v_mfma_f32_16x16x32_bf16 v[144:147], v[120:123], v[160:163], 0
    v_cndmask_b32_e64 v41, 0, v21, s[58:59]
    v_cndmask_b32_e64 v39, v21, 0, s[58:59]
    v_mfma_f32_16x16x32_bf16 v[84:87], v[184:187], v[164:167], 0
    v_pk_fma_f32 v[24:25], v[104:105], v[2:3], v[24:25] op_sel_hi:[1,0,1]
    v_pk_fma_f32 v[26:27], v[106:107], v[2:3], v[26:27] op_sel_hi:[1,0,1]
    v_mfma_f32_16x16x32_bf16 v[148:151], v[122:125], v[164:167], 0
    v_cvt_pk_bf16_f32 v24, v24, v25
    v_cvt_pk_bf16_f32 v25, v26, v27
    v_cndmask_b32_e64 v44, 0, v24, s[60:61]
    v_cndmask_b32_e64 v42, v24, 0, s[60:61]
    v_cndmask_b32_e64 v45, 0, v25, s[60:61]
    v_cndmask_b32_e64 v43, v25, 0, s[60:61]
    v_pk_fma_f32 v[28:29], v[108:109], v[2:3], v[28:29] op_sel_hi:[1,0,1]
    v_pk_fma_f32 v[30:31], v[110:111], v[2:3], v[30:31] op_sel_hi:[1,0,1]
    v_cvt_pk_bf16_f32 v28, v28, v29
    v_cvt_pk_bf16_f32 v29, v30, v31
    v_cndmask_b32_e64 v48, 0, v28, s[62:63]
    v_cndmask_b32_e64 v46, v28, 0, s[62:63]
    v_cndmask_b32_e64 v49, 0, v29, s[62:63]
    v_cndmask_b32_e64 v47, v29, 0, s[62:63]
    v_pk_fma_f32 v[32:33], v[112:113], v[2:3], v[32:33] op_sel_hi:[1,0,1]
    v_pk_fma_f32 v[34:35], v[114:115], v[2:3], v[34:35] op_sel_hi:[1,0,1]
    v_cvt_pk_bf16_f32 v50, v32, v33
    v_cvt_pk_bf16_f32 v51, v34, v35
    v_mfma_f32_16x16x32_bf16 v[16:19], v[116:119], v[36:39], 0
    v_pk_fma_f32 v[56:57], v[8:9], v[172:173], v[56:57] op_sel:[0,0,0] op_sel_hi:[1,0,1]
    v_pk_fma_f32 v[58:59], v[10:11], v[172:173], v[58:59] op_sel:[0,0,0] op_sel_hi:[1,0,1]
    v_mfma_f32_16x16x32_bf16 v[20:23], v[118:121], v[40:43], 0
    v_cvt_pk_bf16_f32 v190, v56, v57
    v_cvt_pk_bf16_f32 v191, v58, v59
    v_mfma_f32_16x16x32_bf16 v[24:27], v[120:123], v[44:47], 0
    v_pk_fma_f32 v[60:61], v[8:9], v[172:173], v[60:61] op_sel:[0,1,0] op_sel_hi:[1,1,1]
    v_pk_fma_f32 v[62:63], v[10:11], v[172:173], v[62:63] op_sel:[0,1,0] op_sel_hi:[1,1,1]
    v_mfma_f32_16x16x32_bf16 v[28:31], v[122:125], v[48:51], 0
    v_cvt_pk_bf16_f32 v196, v60, v61
    v_cvt_pk_bf16_f32 v197, v62, v63
    v_pk_fma_f32 v[64:65], v[8:9], v[174:175], v[64:65] op_sel:[0,0,0] op_sel_hi:[1,0,1]
    v_pk_fma_f32 v[66:67], v[10:11], v[174:175], v[66:67] op_sel:[0,0,0] op_sel_hi:[1,0,1]
    v_cvt_pk_bf16_f32 v206, v64, v65
    v_cvt_pk_bf16_f32 v207, v66, v67
    v_pk_fma_f32 v[68:69], v[8:9], v[174:175], v[68:69] op_sel:[0,1,0] op_sel_hi:[1,1,1]
    v_pk_fma_f32 v[70:71], v[10:11], v[174:175], v[70:71] op_sel:[0,1,0] op_sel_hi:[1,1,1]
    v_cvt_pk_bf16_f32 v212, v68, v69
    v_cvt_pk_bf16_f32 v213, v70, v71
    v_pk_fma_f32 v[72:73], v[8:9], v[176:177], v[72:73] op_sel:[0,0,0] op_sel_hi:[1,0,1]
    v_pk_fma_f32 v[74:75], v[10:11], v[176:177], v[74:75] op_sel:[0,0,0] op_sel_hi:[1,0,1]
    v_cvt_pk_bf16_f32 v218, v72, v73
    v_cvt_pk_bf16_f32 v219, v74, v75
    v_mov_b32 v8, s74
    v_mov_b32 v9, s74
    v_mov_b32 v10, s74
    v_mov_b32 v11, s74
    v_mul_f32 v12, 0x3ea52b5c, v3
    v_mul_f32 v13, 0x3ea52b5c, v5
    v_cndmask_b32_e64 v52, v52, v53, s[64:65]
    v_cndmask_b32_e64 v88, v88, v89, s[64:65]
    v_cndmask_b32_e64 v54, v54, v55, s[64:65]
    v_cndmask_b32_e64 v90, v90, v91, s[64:65]
    v_cndmask_b32_e64 v52, v88, v52, s[66:67]
    v_cndmask_b32_e64 v53, v90, v54, s[68:69]
    v_cndmask_b32_e64 v76, v76, v77, s[64:65]
    v_cndmask_b32_e64 v92, v92, v93, s[64:65]
    v_cndmask_b32_e64 v78, v78, v79, s[64:65]
    v_cndmask_b32_e64 v94, v94, v95, s[64:65]
    v_cndmask_b32_e64 v76, v92, v76, s[66:67]
    v_cndmask_b32_e64 v77, v94, v78, s[68:69]
    v_cndmask_b32_e64 v80, v80, v81, s[64:65]
    v_cndmask_b32_e64 v144, v144, v145, s[64:65]
    v_cndmask_b32_e64 v82, v82, v83, s[64:65]
    v_cndmask_b32_e64 v146, v146, v147, s[64:65]
    v_cndmask_b32_e64 v80, v144, v80, s[66:67]
    v_cndmask_b32_e64 v81, v146, v82, s[68:69]
    v_cndmask_b32_e64 v84, v84, v85, s[64:65]
    v_cndmask_b32_e64 v148, v148, v149, s[64:65]
    v_cndmask_b32_e64 v86, v86, v87, s[64:65]
    v_cndmask_b32_e64 v150, v150, v151, s[64:65]
    v_cndmask_b32_e64 v84, v148, v84, s[66:67]
    v_cndmask_b32_e64 v85, v150, v86, s[68:69]
    v_permlane16_swap_b32 v52, v76
    v_permlane16_swap_b32 v80, v84
    v_permlane16_swap_b32 v53, v77
    v_permlane16_swap_b32 v81, v85
    v_permlane32_swap_b32 v52, v80
    v_permlane32_swap_b32 v76, v84
    v_permlane32_swap_b32 v53, v81
    v_permlane32_swap_b32 v77, v85
    s_waitcnt lgkmcnt(0)
    s_barrier
    ds_read_b64 v[126:127], v238 offset:3072
    ds_read_b64 v[128:129], v238 offset:3584
    ds_read_b64 v[130:131], v238 offset:4096
    ds_read_b64 v[132:133], v238 offset:4608
    ds_read_b64 v[134:135], v238 offset:5120
    ds_read_b64 v[188:189], v238 offset:5632
    ds_read_b64 v[194:195], v238 offset:6144
    ds_read_b64 v[204:205], v238 offset:6656
    ds_read_b64 v[210:211], v238 offset:7168
    ds_read_b64 v[216:217], v238 offset:7680
    v_pk_mul_f32 v[52:53], v[52:53], v[136:137]
    v_pk_mul_f32 v[76:77], v[76:77], v[138:139]
    v_pk_mul_f32 v[80:81], v[80:81], v[140:141]
    v_pk_mul_f32 v[84:85], v[84:85], v[142:143]
    v_max3_f32 v88, v52, v53, v76
    v_max3_f32 v89, v77, v80, v81
    v_max3_f32 v88, v88, v84, v85
    v_max_f32 v88, v88, v89
    v_mul_f32_e64 v88, -v88, v13
    v_pk_fma_f32 v[52:53], v[52:53], v[12:13], v[88:89] op_sel:[0,1,0] op_sel_hi:[1,1,0]
    v_pk_fma_f32 v[76:77], v[76:77], v[12:13], v[88:89] op_sel:[0,1,0] op_sel_hi:[1,1,0]
    v_pk_fma_f32 v[80:81], v[80:81], v[12:13], v[88:89] op_sel:[0,1,0] op_sel_hi:[1,1,0]
    v_pk_fma_f32 v[84:85], v[84:85], v[12:13], v[88:89] op_sel:[0,1,0] op_sel_hi:[1,1,0]
    v_exp_f32 v52, v52
    v_exp_f32 v53, v53
    v_exp_f32 v76, v76
    v_exp_f32 v77, v77
    v_exp_f32 v80, v80
    v_exp_f32 v81, v81
    v_exp_f32 v84, v84
    v_exp_f32 v85, v85
    s_waitcnt lgkmcnt(0)
    ds_read_b32 v56, v224 offset:640
    ds_read_b32 v57, v225 offset:640
    ds_read_b32 v58, v226 offset:640
    ds_read_b32 v59, v227 offset:640
    ds_read_b32 v60, v228 offset:640
    ds_read_b32 v61, v229 offset:640
    ds_read_b32 v62, v230 offset:640
    ds_read_b32 v63, v231 offset:640
    v_mfma_f32_16x16x32_bf16 v[32:35], v[126:129], v[36:39], v[8:11]
    v_pk_add_f32 v[92:93], v[52:53], v[76:77]
    v_pk_add_f32 v[94:95], v[80:81], v[84:85]
    v_mfma_f32_16x16x32_bf16 v[96:99], v[128:131], v[40:43], v[8:11]
    v_pk_add_f32 v[92:93], v[92:93], v[94:95]
    v_add_f32 v92, v92, v93
    v_mfma_f32_16x16x32_bf16 v[100:103], v[130:133], v[44:47], v[8:11]
    v_rcp_f32 v92, v92
    v_mfma_f32_16x16x32_bf16 v[104:107], v[132:135], v[48:51], v[8:11]
    v_pk_mul_f32 v[52:53], v[52:53], v[136:137]
    v_pk_mul_f32 v[76:77], v[76:77], v[138:139]
    v_pk_mul_f32 v[80:81], v[80:81], v[140:141]
    v_pk_mul_f32 v[84:85], v[84:85], v[142:143]
    v_pk_mul_f32 v[52:53], v[52:53], v[92:93] op_sel_hi:[1,0]
    v_pk_mul_f32 v[76:77], v[76:77], v[92:93] op_sel_hi:[1,0]
    v_pk_mul_f32 v[80:81], v[80:81], v[92:93] op_sel_hi:[1,0]
    v_pk_mul_f32 v[84:85], v[84:85], v[92:93] op_sel_hi:[1,0]
    v_cvt_pk_bf16_f32 v52, v52, v53
    v_cvt_pk_bf16_f32 v76, v76, v77
    v_cvt_pk_bf16_f32 v80, v80, v81
    v_cvt_pk_bf16_f32 v84, v84, v85
    v_permlane16_swap_b32 v52, v76
    s_nop 0
    v_permlane16_swap_b32 v80, v84
    s_nop 1
    v_permlane32_swap_b32 v52, v80
    v_permlane32_swap_b32 v76, v84
    v_perm_b32 v152, v52, v52, v232
    v_perm_b32 v153, v52, v52, v233
    v_perm_b32 v154, v52, v52, v234
    v_perm_b32 v155, v52, v52, v235
    v_perm_b32 v160, v80, v80, v232
    v_perm_b32 v161, v80, v80, v233
    v_perm_b32 v162, v80, v80, v234
    v_perm_b32 v163, v80, v80, v235
    v_perm_b32 v156, v76, v76, v232
    v_perm_b32 v157, v76, v76, v233
    v_perm_b32 v158, v76, v76, v234
    v_perm_b32 v159, v76, v76, v235
    v_perm_b32 v164, v84, v84, v232
    v_perm_b32 v165, v84, v84, v233
    v_perm_b32 v166, v84, v84, v234
    v_perm_b32 v167, v84, v84, v235
    v_mfma_f32_16x16x32_bf16 v[52:55], v[190:193], v[152:155], 0
    v_cndmask_b32_e64 v16, v16, v17, s[64:65]
    v_cndmask_b32_e64 v32, v32, v33, s[64:65]
    v_mfma_f32_16x16x32_bf16 v[88:91], v[196:199], v[152:155], 0
    v_cndmask_b32_e64 v18, v18, v19, s[64:65]
    v_cndmask_b32_e64 v34, v34, v35, s[64:65]
    v_mfma_f32_16x16x32_bf16 v[80:83], v[206:209], v[160:163], 0
    v_cndmask_b32_e64 v16, v32, v16, s[66:67]
    v_cndmask_b32_e64 v17, v34, v18, s[68:69]
    v_mfma_f32_16x16x32_bf16 v[144:147], v[212:215], v[160:163], 0
    v_cndmask_b32_e64 v20, v20, v21, s[64:65]
    v_cndmask_b32_e64 v96, v96, v97, s[64:65]
    v_mfma_f32_16x16x32_bf16 v[76:79], v[196:199], v[156:159], 0
    v_cndmask_b32_e64 v22, v22, v23, s[64:65]
    v_cndmask_b32_e64 v98, v98, v99, s[64:65]
    v_mfma_f32_16x16x32_bf16 v[92:95], v[206:209], v[156:159], 0
    v_cndmask_b32_e64 v20, v96, v20, s[66:67]
    v_cndmask_b32_e64 v21, v98, v22, s[68:69]
    v_mfma_f32_16x16x32_bf16 v[84:87], v[212:215], v[164:167], 0
    v_cndmask_b32_e64 v24, v24, v25, s[64:65]
    v_cndmask_b32_e64 v100, v100, v101, s[64:65]
    v_mfma_f32_16x16x32_bf16 v[148:151], v[218:221], v[164:167], 0
    v_cndmask_b32_e64 v26, v26, v27, s[64:65]
    v_cndmask_b32_e64 v102, v102, v103, s[64:65]
    v_cndmask_b32_e64 v24, v100, v24, s[66:67]
    v_cndmask_b32_e64 v25, v102, v26, s[68:69]
    v_cndmask_b32_e64 v28, v28, v29, s[64:65]
    v_cndmask_b32_e64 v104, v104, v105, s[64:65]
    v_cndmask_b32_e64 v30, v30, v31, s[64:65]
    v_cndmask_b32_e64 v106, v106, v107, s[64:65]
    v_cndmask_b32_e64 v28, v104, v28, s[66:67]
    v_cndmask_b32_e64 v29, v106, v30, s[68:69]
    v_permlane16_swap_b32 v16, v20
    v_permlane16_swap_b32 v24, v28
    v_permlane16_swap_b32 v17, v21
    v_permlane16_swap_b32 v25, v29
    v_permlane32_swap_b32 v16, v24
    v_permlane32_swap_b32 v20, v28
    v_permlane32_swap_b32 v17, v25
    v_permlane32_swap_b32 v21, v29
    s_waitcnt lgkmcnt(0)
    v_pk_mul_f32 v[16:17], v[16:17], v[56:57]
    v_pk_mul_f32 v[20:21], v[20:21], v[58:59]
    v_pk_mul_f32 v[24:25], v[24:25], v[60:61]
    v_pk_mul_f32 v[28:29], v[28:29], v[62:63]
    v_max3_f32 v32, v16, v17, v20
    v_max3_f32 v33, v21, v24, v25
    v_max3_f32 v32, v32, v28, v29
    v_max_f32 v32, v32, v33
    v_mul_f32_e64 v32, -v32, v12
    v_pk_fma_f32 v[16:17], v[16:17], v[12:13], v[32:33] op_sel:[0,0,0] op_sel_hi:[1,0,0]
    v_pk_fma_f32 v[20:21], v[20:21], v[12:13], v[32:33] op_sel:[0,0,0] op_sel_hi:[1,0,0]
    v_pk_fma_f32 v[24:25], v[24:25], v[12:13], v[32:33] op_sel:[0,0,0] op_sel_hi:[1,0,0]
    v_pk_fma_f32 v[28:29], v[28:29], v[12:13], v[32:33] op_sel:[0,0,0] op_sel_hi:[1,0,0]
    v_exp_f32 v16, v16
    v_exp_f32 v17, v17
    v_exp_f32 v20, v20
    v_exp_f32 v21, v21
    v_exp_f32 v24, v24
    v_exp_f32 v25, v25
    v_exp_f32 v28, v28
    v_exp_f32 v29, v29
    v_pk_add_f32 v[96:97], v[16:17], v[20:21]
    v_pk_add_f32 v[98:99], v[24:25], v[28:29]
    v_pk_add_f32 v[96:97], v[96:97], v[98:99]
    v_add_f32 v96, v96, v97
    v_rcp_f32 v96, v96
    v_pk_mul_f32 v[16:17], v[16:17], v[56:57]
    v_pk_mul_f32 v[20:21], v[20:21], v[58:59]
    v_pk_mul_f32 v[24:25], v[24:25], v[60:61]
    v_pk_mul_f32 v[28:29], v[28:29], v[62:63]
    v_pk_mul_f32 v[16:17], v[16:17], v[96:97] op_sel_hi:[1,0]
    v_pk_mul_f32 v[20:21], v[20:21], v[96:97] op_sel_hi:[1,0]
    v_pk_mul_f32 v[24:25], v[24:25], v[96:97] op_sel_hi:[1,0]
    v_pk_mul_f32 v[28:29], v[28:29], v[96:97] op_sel_hi:[1,0]
    v_cvt_pk_bf16_f32 v16, v16, v17
    v_cvt_pk_bf16_f32 v20, v20, v21
    v_cvt_pk_bf16_f32 v24, v24, v25
    v_cvt_pk_bf16_f32 v28, v28, v29
    v_permlane16_swap_b32 v16, v20
    s_nop 0
    v_permlane16_swap_b32 v24, v28
    s_nop 1
    v_permlane32_swap_b32 v16, v24
    v_permlane32_swap_b32 v20, v28
    v_perm_b32 v36, v16, v16, v232
    v_perm_b32 v37, v16, v16, v233
    v_perm_b32 v38, v16, v16, v234
    v_perm_b32 v39, v16, v16, v235
    v_perm_b32 v44, v24, v24, v232
    v_perm_b32 v45, v24, v24, v233
    v_perm_b32 v46, v24, v24, v234
    v_perm_b32 v47, v24, v24, v235
    v_perm_b32 v40, v20, v20, v232
    v_perm_b32 v41, v20, v20, v233
    v_perm_b32 v42, v20, v20, v234
    v_perm_b32 v43, v20, v20, v235
    v_perm_b32 v48, v28, v28, v232
    v_perm_b32 v49, v28, v28, v233
    v_perm_b32 v50, v28, v28, v234
    v_perm_b32 v51, v28, v28, v235
    v_mfma_f32_16x16x32_bf16 v[16:19], v[188:191], v[36:39], 0
    v_cvt_pk_bf16_f32 v178, v52, v53
    v_cvt_pk_bf16_f32 v179, v54, v55
    v_mfma_f32_16x16x32_bf16 v[32:35], v[194:197], v[36:39], 0
    v_cvt_pk_bf16_f32 v180, v76, v77
    v_cvt_pk_bf16_f32 v181, v78, v79
    v_mfma_f32_16x16x32_bf16 v[24:27], v[204:207], v[44:47], 0
    v_cvt_pk_bf16_f32 v182, v80, v81
    v_cvt_pk_bf16_f32 v183, v82, v83
    v_mfma_f32_16x16x32_bf16 v[100:103], v[210:213], v[44:47], 0
    v_cvt_pk_bf16_f32 v184, v84, v85
    v_cvt_pk_bf16_f32 v185, v86, v87
    v_mfma_f32_16x16x32_bf16 v[20:23], v[194:197], v[40:43], 0
    v_cvt_pk_bf16_f32 v66, v148, v149
    v_cvt_pk_bf16_f32 v67, v150, v151
    v_mfma_f32_16x16x32_bf16 v[96:99], v[204:207], v[40:43], 0
    v_mfma_f32_16x16x32_bf16 v[28:31], v[210:213], v[48:51], 0
    v_mfma_f32_16x16x32_bf16 v[104:107], v[216:219], v[48:51], 0
    s_not_b64 exec, s[62:63]
    v_cvt_pk_bf16_f32 v184, v144, v145
    v_cvt_pk_bf16_f32 v185, v146, v147
    s_not_b64 exec, s[60:61]
    v_cvt_pk_bf16_f32 v182, v92, v93
    v_cvt_pk_bf16_f32 v183, v94, v95
    s_not_b64 exec, s[58:59]
    v_cvt_pk_bf16_f32 v180, v88, v89
    v_cvt_pk_bf16_f32 v181, v90, v91
    s_mov_b64 exec, -1
    buffer_store_dwordx4 v[178:181], v251, s[36:39], s72 offen offset:2048 sc1
    buffer_store_dwordx4 v[182:185], v251, s[36:39], s72 offen offset:3072 sc1
    v_cvt_pk_bf16_f32 v116, v16, v17
    v_cvt_pk_bf16_f32 v117, v18, v19
    v_cvt_pk_bf16_f32 v118, v20, v21
    v_cvt_pk_bf16_f32 v119, v22, v23
    v_cvt_pk_bf16_f32 v120, v24, v25
    v_cvt_pk_bf16_f32 v121, v26, v27
    v_cvt_pk_bf16_f32 v122, v28, v29
    v_cvt_pk_bf16_f32 v123, v30, v31
    v_cvt_pk_bf16_f32 v64, v104, v105
    v_cvt_pk_bf16_f32 v65, v106, v107
    s_not_b64 exec, s[62:63]
    v_cvt_pk_bf16_f32 v122, v100, v101
    v_cvt_pk_bf16_f32 v123, v102, v103
    s_not_b64 exec, s[60:61]
    v_cvt_pk_bf16_f32 v120, v96, v97
    v_cvt_pk_bf16_f32 v121, v98, v99
    s_not_b64 exec, s[58:59]
    v_cvt_pk_bf16_f32 v118, v32, v33
    v_cvt_pk_bf16_f32 v119, v34, v35
    s_mov_b64 exec, -1
    buffer_store_dwordx4 v[116:119], v251, s[36:39], s72 offen offset:0 sc1
    buffer_store_dwordx4 v[120:123], v251, s[36:39], s72 offen offset:1024 sc1
    v_permlane32_swap_b32 v64, v66
    v_permlane32_swap_b32 v65, v67
    buffer_store_dwordx4 v[64:67], v239, s[36:39], s73 offen sc1
    s_mov_b32 s56, 0xffff0000
    s_barrier
    buffer_load_dwordx4 v[104:107], v251, s[28:31], s12 offen offset:0 sc1
    buffer_load_dwordx4 v[108:111], v251, s[28:31], s12 offen offset:2048 sc1
    s_add_u32 s12, s12, 2097152
    buffer_load_dwordx4 v[112:115], v251, s[28:31], s13 offen offset:0 sc1
    buffer_load_dwordx4 v[116:119], v251, s[28:31], s13 offen offset:2048 sc1
    s_add_u32 s13, s13, 2097152
    buffer_load_dwordx4 v[120:123], v251, s[28:31], s14 offen offset:0 sc1
    buffer_load_dwordx4 v[124:127], v251, s[28:31], s14 offen offset:2048 sc1
    s_add_u32 s14, s14, 2097152
    buffer_load_dwordx4 v[128:131], v251, s[28:31], s15 offen offset:0 sc1
    buffer_load_dwordx4 v[132:135], v251, s[28:31], s15 offen offset:2048 sc1
    s_add_u32 s15, s15, 2097152
    buffer_load_dwordx4 v[136:139], v251, s[28:31], s16 offen offset:0 sc1
    buffer_load_dwordx4 v[140:143], v251, s[28:31], s16 offen offset:2048 sc1
    s_add_u32 s16, s16, 2097152
    ds_read_b64 v[200:201], v249 offset:0
    ds_read_b64 v[202:203], v248 offset:0
    ds_read_b64 v[204:205], v249 offset:2048
    ds_read_b64 v[206:207], v248 offset:2048
    v_mov_b32 v40, 0
    v_mov_b32 v41, 0
    v_mov_b32 v42, 0
    v_mov_b32 v43, 0
    v_mov_b32 v44, 0
    v_mov_b32 v45, 0
    v_mov_b32 v46, 0
    v_mov_b32 v47, 0
    v_mov_b32 v48, 0
    v_mov_b32 v49, 0
    v_mov_b32 v50, 0
    v_mov_b32 v51, 0
    v_mov_b32 v52, 0
    v_mov_b32 v53, 0
    v_mov_b32 v54, 0
    v_mov_b32 v55, 0
    s_waitcnt lgkmcnt(0)
    v_lshlrev_b32 v24, 16, v200
    v_and_b32 v25, 0xffff0000, v200
    v_lshlrev_b32 v26, 16, v201
    v_and_b32 v27, 0xffff0000, v201
    v_lshlrev_b32 v32, 16, v202
    v_and_b32 v33, 0xffff0000, v202
    v_lshlrev_b32 v34, 16, v203
    v_and_b32 v35, 0xffff0000, v203
    v_lshlrev_b32 v28, 16, v204
    v_and_b32 v29, 0xffff0000, v204
    v_lshlrev_b32 v30, 16, v205
    v_and_b32 v31, 0xffff0000, v205
    v_lshlrev_b32 v36, 16, v206
    v_and_b32 v37, 0xffff0000, v206
    v_lshlrev_b32 v38, 16, v207
    v_and_b32 v39, 0xffff0000, v207
    s_waitcnt vmcnt(10)
    v_mov_b32 v12, 1
    v_mov_b32 v13, 0
    s_mov_b64 exec, 1
    ds_add_rtn_u32 v14, v13, v12 offset:3016
    s_mov_b64 exec, -1
    ds_read_b32 v16, v13 offset:3040
    ds_read_b32 v17, v13 offset:3040
    s_waitcnt lgkmcnt(0)
    v_readfirstlane_b32 s49, v14
    s_nop 0
    s_cmp_lg_u32 s49, 3
    s_cbranch_scc1 L2QC_fr
    s_mov_b64 exec, 0xffff
    buffer_store_dwordx2 v[16:17], v240, s[36:39], s9 offen offset:0 sc1
    s_mov_b64 exec, -1
L2QC_fr:
    ds_read_b64_tr_b16 v[72:73], v255 offset:0
    ds_read_b64_tr_b16 v[74:75], v255 offset:2048
    ds_read_b64_tr_b16 v[76:77], v254 offset:0
    ds_read_b64_tr_b16 v[78:79], v254 offset:2048
    ds_read_b64_tr_b16 v[80:81], v253 offset:0
    ds_read_b64_tr_b16 v[82:83], v253 offset:2048
    ds_read_b64_tr_b16 v[84:85], v252 offset:0
    ds_read_b64_tr_b16 v[86:87], v252 offset:2048
    s_mov_b32 s57, 4
.p2align 6
L2QC_loop:
    s_waitcnt vmcnt(8) lgkmcnt(4)
    v_mfma_f32_16x16x32_bf16 v[24:27], v[72:75], v[104:107], v[24:27]
    ds_read_b64_tr_b16 v[88:89], v255 offset:8192
    buffer_load_dwordx4 v[144:147], v251, s[28:31], s17 offen offset:0 sc1
    buffer_load_dwordx4 v[148:151], v251, s[28:31], s17 offen offset:2048 sc1
    v_mfma_f32_16x16x32_bf16 v[28:31], v[72:75], v[108:111], v[28:31]
    ds_read_b64_tr_b16 v[90:91], v255 offset:10240
    s_add_u32 s17, s17, 2097152
    v_mfma_f32_16x16x32_bf16 v[36:39], v[76:79], v[108:111], v[36:39]
    ds_read_b64_tr_b16 v[92:93], v254 offset:8192
    s_cmp_eq_u32 s57, 1
    v_mfma_f32_16x16x32_bf16 v[32:35], v[76:79], v[104:107], v[32:35]
    ds_read_b64_tr_b16 v[94:95], v254 offset:10240
    s_cselect_b32 s12, s4, s12
    s_waitcnt lgkmcnt(4)
    v_mfma_f32_16x16x32_bf16 v[40:43], v[80:83], v[104:107], v[40:43]
    ds_read_b64_tr_b16 v[96:97], v253 offset:8192
    s_cselect_b32 s13, s5, s13
    v_mfma_f32_16x16x32_bf16 v[44:47], v[80:83], v[108:111], v[44:47]
    ds_read_b64_tr_b16 v[98:99], v253 offset:10240
    s_cselect_b32 s14, s30, s14
    v_mfma_f32_16x16x32_bf16 v[52:55], v[84:87], v[108:111], v[52:55]
    ds_read_b64_tr_b16 v[100:101], v252 offset:8192
    s_cselect_b32 s15, s30, s15
    v_mfma_f32_16x16x32_bf16 v[48:51], v[84:87], v[104:107], v[48:51]
    ds_read_b64_tr_b16 v[102:103], v252 offset:10240
    s_cselect_b32 s16, s30, s16
    s_waitcnt vmcnt(8) lgkmcnt(4)
    v_mfma_f32_16x16x32_bf16 v[24:27], v[88:91], v[112:115], v[24:27]
    ds_read_b64_tr_b16 v[72:73], v255 offset:16384
    buffer_load_dwordx4 v[152:155], v251, s[28:31], s18 offen offset:0 sc1
    v_mfma_f32_16x16x32_bf16 v[28:31], v[88:91], v[116:119], v[28:31]
    ds_read_b64_tr_b16 v[74:75], v255 offset:18432
    buffer_load_dwordx4 v[156:159], v251, s[28:31], s18 offen offset:2048 sc1
    v_mfma_f32_16x16x32_bf16 v[36:39], v[92:95], v[116:119], v[36:39]
    ds_read_b64_tr_b16 v[76:77], v254 offset:16384
    s_add_u32 s18, s18, 2097152
    v_mfma_f32_16x16x32_bf16 v[32:35], v[92:95], v[112:115], v[32:35]
    ds_read_b64_tr_b16 v[78:79], v254 offset:18432
    s_waitcnt lgkmcnt(4)
    v_mfma_f32_16x16x32_bf16 v[40:43], v[96:99], v[112:115], v[40:43]
    ds_read_b64_tr_b16 v[80:81], v253 offset:16384
    v_mfma_f32_16x16x32_bf16 v[44:47], v[96:99], v[116:119], v[44:47]
    ds_read_b64_tr_b16 v[82:83], v253 offset:18432
    v_mfma_f32_16x16x32_bf16 v[52:55], v[100:103], v[116:119], v[52:55]
    ds_read_b64_tr_b16 v[84:85], v252 offset:16384
    v_mfma_f32_16x16x32_bf16 v[48:51], v[100:103], v[112:115], v[48:51]
    ds_read_b64_tr_b16 v[86:87], v252 offset:18432
    s_waitcnt vmcnt(8) lgkmcnt(4)
    v_mfma_f32_16x16x32_bf16 v[24:27], v[72:75], v[120:123], v[24:27]
    ds_read_b64_tr_b16 v[88:89], v255 offset:24576
    buffer_load_dwordx4 v[160:163], v251, s[28:31], s19 offen offset:0 sc1
    v_mfma_f32_16x16x32_bf16 v[28:31], v[72:75], v[124:127], v[28:31]
    ds_read_b64_tr_b16 v[90:91], v255 offset:26624
    buffer_load_dwordx4 v[164:167], v251, s[28:31], s19 offen offset:2048 sc1
    v_mfma_f32_16x16x32_bf16 v[36:39], v[76:79], v[124:127], v[36:39]
    ds_read_b64_tr_b16 v[92:93], v254 offset:24576
    s_add_u32 s19, s19, 2097152
    v_mfma_f32_16x16x32_bf16 v[32:35], v[76:79], v[120:123], v[32:35]
    ds_read_b64_tr_b16 v[94:95], v254 offset:26624
    s_waitcnt lgkmcnt(4)
    v_mfma_f32_16x16x32_bf16 v[40:43], v[80:83], v[120:123], v[40:43]
    ds_read_b64_tr_b16 v[96:97], v253 offset:24576
    v_mfma_f32_16x16x32_bf16 v[44:47], v[80:83], v[124:127], v[44:47]
    ds_read_b64_tr_b16 v[98:99], v253 offset:26624
    v_mfma_f32_16x16x32_bf16 v[52:55], v[84:87], v[124:127], v[52:55]
    ds_read_b64_tr_b16 v[100:101], v252 offset:24576
    v_mfma_f32_16x16x32_bf16 v[48:51], v[84:87], v[120:123], v[48:51]
    ds_read_b64_tr_b16 v[102:103], v252 offset:26624
    s_waitcnt vmcnt(8) lgkmcnt(4)
    v_mfma_f32_16x16x32_bf16 v[24:27], v[88:91], v[128:131], v[24:27]
    s_barrier
    ds_read_b64_tr_b16 v[72:73], v255 offset:32768
    v_mfma_f32_16x16x32_bf16 v[28:31], v[88:91], v[132:135], v[28:31]
    ds_read_b64_tr_b16 v[74:75], v255 offset:34816
    buffer_load_dwordx4 v[104:107], v251, s[28:31], s12 offen offset:0 sc1
    v_mfma_f32_16x16x32_bf16 v[36:39], v[92:95], v[132:135], v[36:39]
    ds_read_b64_tr_b16 v[76:77], v254 offset:32768
    buffer_load_dwordx4 v[108:111], v251, s[28:31], s12 offen offset:2048 sc1
    v_mfma_f32_16x16x32_bf16 v[32:35], v[92:95], v[128:131], v[32:35]
    ds_read_b64_tr_b16 v[78:79], v254 offset:34816
    s_waitcnt lgkmcnt(4)
    v_mfma_f32_16x16x32_bf16 v[40:43], v[96:99], v[128:131], v[40:43]
    ds_read_b64_tr_b16 v[80:81], v253 offset:32768
    s_add_u32 s12, s12, 2097152
    v_mfma_f32_16x16x32_bf16 v[44:47], v[96:99], v[132:135], v[44:47]
    ds_read_b64_tr_b16 v[82:83], v253 offset:34816
    v_mfma_f32_16x16x32_bf16 v[52:55], v[100:103], v[132:135], v[52:55]
    ds_read_b64_tr_b16 v[84:85], v252 offset:32768
    v_mfma_f32_16x16x32_bf16 v[48:51], v[100:103], v[128:131], v[48:51]
    ds_read_b64_tr_b16 v[86:87], v252 offset:34816
    s_waitcnt vmcnt(8) lgkmcnt(4)
    v_mfma_f32_16x16x32_bf16 v[24:27], v[72:75], v[136:139], v[24:27]
    ds_read_b64_tr_b16 v[88:89], v255 offset:40960
    buffer_load_dwordx4 v[112:115], v251, s[28:31], s13 offen offset:0 sc1
    v_mfma_f32_16x16x32_bf16 v[28:31], v[72:75], v[140:143], v[28:31]
    ds_read_b64_tr_b16 v[90:91], v255 offset:43008
    buffer_load_dwordx4 v[116:119], v251, s[28:31], s13 offen offset:2048 sc1
    v_mfma_f32_16x16x32_bf16 v[36:39], v[76:79], v[140:143], v[36:39]
    ds_read_b64_tr_b16 v[92:93], v254 offset:40960
    s_add_u32 s13, s13, 2097152
    v_mfma_f32_16x16x32_bf16 v[32:35], v[76:79], v[136:139], v[32:35]
    ds_read_b64_tr_b16 v[94:95], v254 offset:43008
    s_waitcnt lgkmcnt(4)
    v_mfma_f32_16x16x32_bf16 v[40:43], v[80:83], v[136:139], v[40:43]
    ds_read_b64_tr_b16 v[96:97], v253 offset:40960
    v_mfma_f32_16x16x32_bf16 v[44:47], v[80:83], v[140:143], v[44:47]
    ds_read_b64_tr_b16 v[98:99], v253 offset:43008
    v_mfma_f32_16x16x32_bf16 v[52:55], v[84:87], v[140:143], v[52:55]
    ds_read_b64_tr_b16 v[100:101], v252 offset:40960
    v_mfma_f32_16x16x32_bf16 v[48:51], v[84:87], v[136:139], v[48:51]
    ds_read_b64_tr_b16 v[102:103], v252 offset:43008
    s_waitcnt vmcnt(8) lgkmcnt(4)
    v_mfma_f32_16x16x32_bf16 v[24:27], v[88:91], v[144:147], v[24:27]
    ds_read_b64_tr_b16 v[72:73], v255 offset:49152
    buffer_load_dwordx4 v[120:123], v251, s[28:31], s14 offen offset:0 sc1
    v_mfma_f32_16x16x32_bf16 v[28:31], v[88:91], v[148:151], v[28:31]
    ds_read_b64_tr_b16 v[74:75], v255 offset:51200
    buffer_load_dwordx4 v[124:127], v251, s[28:31], s14 offen offset:2048 sc1
    v_mfma_f32_16x16x32_bf16 v[36:39], v[92:95], v[148:151], v[36:39]
    ds_read_b64_tr_b16 v[76:77], v254 offset:49152
    s_add_u32 s14, s14, 2097152
    v_mfma_f32_16x16x32_bf16 v[32:35], v[92:95], v[144:147], v[32:35]
    ds_read_b64_tr_b16 v[78:79], v254 offset:51200
    s_waitcnt lgkmcnt(4)
    v_mfma_f32_16x16x32_bf16 v[40:43], v[96:99], v[144:147], v[40:43]
    ds_read_b64_tr_b16 v[80:81], v253 offset:49152
    s_sub_u32 s56, 0, s56
    v_mfma_f32_16x16x32_bf16 v[44:47], v[96:99], v[148:151], v[44:47]
    ds_read_b64_tr_b16 v[82:83], v253 offset:51200
    v_mfma_f32_16x16x32_bf16 v[52:55], v[100:103], v[148:151], v[52:55]
    ds_read_b64_tr_b16 v[84:85], v252 offset:49152
    v_mfma_f32_16x16x32_bf16 v[48:51], v[100:103], v[144:147], v[48:51]
    ds_read_b64_tr_b16 v[86:87], v252 offset:51200
    s_waitcnt vmcnt(8) lgkmcnt(4)
    v_mfma_f32_16x16x32_bf16 v[24:27], v[72:75], v[152:155], v[24:27]
    ds_read_b64_tr_b16 v[88:89], v255 offset:57344
    buffer_load_dwordx4 v[128:131], v251, s[28:31], s15 offen offset:0 sc1
    v_mfma_f32_16x16x32_bf16 v[28:31], v[72:75], v[156:159], v[28:31]
    ds_read_b64_tr_b16 v[90:91], v255 offset:59392
    buffer_load_dwordx4 v[132:135], v251, s[28:31], s15 offen offset:2048 sc1
    v_mfma_f32_16x16x32_bf16 v[36:39], v[76:79], v[156:159], v[36:39]
    ds_read_b64_tr_b16 v[92:93], v254 offset:57344
    s_add_u32 s15, s15, 2097152
    v_mfma_f32_16x16x32_bf16 v[32:35], v[76:79], v[152:155], v[32:35]
    ds_read_b64_tr_b16 v[94:95], v254 offset:59392
    s_waitcnt lgkmcnt(4)
    v_mfma_f32_16x16x32_bf16 v[40:43], v[80:83], v[152:155], v[40:43]
    ds_read_b64_tr_b16 v[96:97], v253 offset:57344
    v_mfma_f32_16x16x32_bf16 v[44:47], v[80:83], v[156:159], v[44:47]
    ds_read_b64_tr_b16 v[98:99], v253 offset:59392
    v_mfma_f32_16x16x32_bf16 v[52:55], v[84:87], v[156:159], v[52:55]
    ds_read_b64_tr_b16 v[100:101], v252 offset:57344
    v_mfma_f32_16x16x32_bf16 v[48:51], v[84:87], v[152:155], v[48:51]
    ds_read_b64_tr_b16 v[102:103], v252 offset:59392
    s_waitcnt vmcnt(8) lgkmcnt(4)
    v_mfma_f32_16x16x32_bf16 v[24:27], v[88:91], v[160:163], v[24:27]
    s_barrier
    v_add_u32 v255, s56, v255
    ds_read_b64_tr_b16 v[72:73], v255 offset:0
    v_mfma_f32_16x16x32_bf16 v[28:31], v[88:91], v[164:167], v[28:31]
    ds_read_b64_tr_b16 v[74:75], v255 offset:2048
    buffer_load_dwordx4 v[136:139], v251, s[28:31], s16 offen offset:0 sc1
    v_mfma_f32_16x16x32_bf16 v[36:39], v[92:95], v[164:167], v[36:39]
    v_add_u32 v254, s56, v254
    ds_read_b64_tr_b16 v[76:77], v254 offset:0
    buffer_load_dwordx4 v[140:143], v251, s[28:31], s16 offen offset:2048 sc1
    v_mfma_f32_16x16x32_bf16 v[32:35], v[92:95], v[160:163], v[32:35]
    ds_read_b64_tr_b16 v[78:79], v254 offset:2048
    s_add_u32 s16, s16, 2097152
    s_waitcnt lgkmcnt(4)
    v_mfma_f32_16x16x32_bf16 v[40:43], v[96:99], v[160:163], v[40:43]
    v_add_u32 v253, s56, v253
    ds_read_b64_tr_b16 v[80:81], v253 offset:0
    s_sub_u32 s57, s57, 1
    v_mfma_f32_16x16x32_bf16 v[44:47], v[96:99], v[164:167], v[44:47]
    ds_read_b64_tr_b16 v[82:83], v253 offset:2048
    s_cmp_lg_u32 s57, 0
    v_mfma_f32_16x16x32_bf16 v[52:55], v[100:103], v[164:167], v[52:55]
    v_add_u32 v252, s56, v252
    ds_read_b64_tr_b16 v[84:85], v252 offset:0
    v_mfma_f32_16x16x32_bf16 v[48:51], v[100:103], v[160:163], v[48:51]
    ds_read_b64_tr_b16 v[86:87], v252 offset:2048
    s_cbranch_scc1 L2QC_loop
    s_waitcnt vmcnt(8) lgkmcnt(4)
    v_mfma_f32_16x16x32_bf16 v[24:27], v[72:75], v[104:107], v[24:27]
    ds_read_b64_tr_b16 v[88:89], v255 offset:8192
    v_mfma_f32_16x16x32_bf16 v[28:31], v[72:75], v[108:111], v[28:31]
    ds_read_b64_tr_b16 v[90:91], v255 offset:10240
    v_mfma_f32_16x16x32_bf16 v[36:39], v[76:79], v[108:111], v[36:39]
    ds_read_b64_tr_b16 v[92:93], v254 offset:8192
    v_mfma_f32_16x16x32_bf16 v[32:35], v[76:79], v[104:107], v[32:35]
    ds_read_b64_tr_b16 v[94:95], v254 offset:10240
    s_waitcnt lgkmcnt(4)
    v_mfma_f32_16x16x32_bf16 v[40:43], v[80:83], v[104:107], v[40:43]
    ds_read_b64_tr_b16 v[96:97], v253 offset:8192
    v_mfma_f32_16x16x32_bf16 v[44:47], v[80:83], v[108:111], v[44:47]
    ds_read_b64_tr_b16 v[98:99], v253 offset:10240
    v_mfma_f32_16x16x32_bf16 v[52:55], v[84:87], v[108:111], v[52:55]
    ds_read_b64_tr_b16 v[100:101], v252 offset:8192
    v_mfma_f32_16x16x32_bf16 v[48:51], v[84:87], v[104:107], v[48:51]
    ds_read_b64_tr_b16 v[102:103], v252 offset:10240
    s_waitcnt vmcnt(6) lgkmcnt(0)
    v_mfma_f32_16x16x32_bf16 v[40:43], v[96:99], v[112:115], v[40:43]
    v_mfma_f32_16x16x32_bf16 v[44:47], v[96:99], v[116:119], v[44:47]
    v_mfma_f32_16x16x32_bf16 v[48:51], v[100:103], v[112:115], v[48:51]
    v_mfma_f32_16x16x32_bf16 v[52:55], v[100:103], v[116:119], v[52:55]
    v_mfma_f32_16x16x32_bf16 v[24:27], v[88:91], v[112:115], v[24:27]
    s_nop 3
    ds_write_b128 v246, v[40:43] offset:0
    v_mfma_f32_16x16x32_bf16 v[28:31], v[88:91], v[116:119], v[28:31]
    ds_write_b128 v246, v[44:47] offset:1024
    v_mfma_f32_16x16x32_bf16 v[32:35], v[92:95], v[112:115], v[32:35]
    ds_write_b128 v246, v[48:51] offset:2048
    v_mfma_f32_16x16x32_bf16 v[36:39], v[92:95], v[116:119], v[36:39]
    ds_write_b128 v246, v[52:55] offset:3072
    s_waitcnt lgkmcnt(0)
    s_barrier
    ds_read_b128 v[72:75], v245 offset:0
    ds_read_b128 v[80:83], v245 offset:2048
    ds_read_b128 v[76:79], v245 offset:1024
    ds_read_b128 v[84:87], v245 offset:3072
    s_waitcnt lgkmcnt(3)
    v_pk_add_f32 v[24:25], v[24:25], v[72:73]
    v_pk_add_f32 v[26:27], v[26:27], v[74:75]
    v_cvt_pk_bf16_f32 v200, v24, v25
    v_cvt_pk_bf16_f32 v201, v26, v27
    ds_write_b64 v244, v[200:201] offset:32768
    s_waitcnt lgkmcnt(3)
    v_pk_add_f32 v[32:33], v[32:33], v[80:81]
    v_pk_add_f32 v[34:35], v[34:35], v[82:83]
    v_cvt_pk_bf16_f32 v202, v32, v33
    v_cvt_pk_bf16_f32 v203, v34, v35
    ds_write_b64 v244, v[202:203] offset:32800
    ds_read_b128 v[212:215], v243 offset:32768
    s_waitcnt lgkmcnt(4)
    v_pk_add_f32 v[28:29], v[28:29], v[76:77]
    v_pk_add_f32 v[30:31], v[30:31], v[78:79]
    v_cvt_pk_bf16_f32 v204, v28, v29
    v_cvt_pk_bf16_f32 v205, v30, v31
    ds_write_b64 v244, v[204:205] offset:34048
    s_waitcnt lgkmcnt(4)
    v_pk_add_f32 v[36:37], v[36:37], v[84:85]
    v_pk_add_f32 v[38:39], v[38:39], v[86:87]
    v_cvt_pk_bf16_f32 v206, v36, v37
    v_cvt_pk_bf16_f32 v207, v38, v39
    ds_write_b64 v244, v[206:207] offset:34080
    ds_read_b128 v[216:219], v243 offset:34048
    s_waitcnt lgkmcnt(3)
    buffer_store_dwordx4 v[212:215], v247, s[44:47], s6 offen
    s_waitcnt lgkmcnt(0)
    buffer_store_dwordx4 v[216:219], v247, s[44:47], s7 offen
    s_endpgm
L_QC1:
    s_barrier
    ds_read_b128 v[192:195], v6 offset:6144
    ds_read_b128 v[196:199], v6 offset:8192
    ds_read_b128 v[200:203], v6 offset:0
    ds_read_b64_tr_b16 v[152:153], v4 offset:0
    ds_read_b64_tr_b16 v[154:155], v4 offset:7680
    ds_read_b64_tr_b16 v[156:157], v4 offset:32
    ds_read_b64_tr_b16 v[158:159], v4 offset:7712
    ds_read_b64_tr_b16 v[160:161], v4 offset:64
    ds_read_b64_tr_b16 v[162:163], v4 offset:7744
    ds_read_b64_tr_b16 v[164:165], v4 offset:96
    ds_read_b64_tr_b16 v[166:167], v4 offset:7776
    s_mov_b32 s57, 10
.p2align 6
LQC1_loop:
    s_waitcnt lgkmcnt(6)
    v_mfma_f32_16x16x32_bf16 v[16:19], v[152:155], v[192:195], v[16:19]
    ds_read_b64_tr_b16 v[168:169], v4 offset:128
    s_add_u32 s55, s55, 15360
    v_mfma_f32_16x16x32_bf16 v[76:79], v[152:155], v[196:199], v[76:79]
    ds_read_b64_tr_b16 v[170:171], v4 offset:7808
    s_waitcnt lgkmcnt(6)
    v_mfma_f32_16x16x32_bf16 v[80:83], v[156:159], v[196:199], v[80:83]
    ds_read_b64_tr_b16 v[172:173], v4 offset:160
    s_cmp_ge_u32 s55, 155648
    v_mfma_f32_16x16x32_bf16 v[136:139], v[156:159], v[12:15], v[136:139]
    ds_read_b64_tr_b16 v[174:175], v4 offset:7840
    s_cselect_b32 s55, 78848, s55
    v_mfma_f32_16x16x32_bf16 v[20:23], v[156:159], v[192:195], v[20:23]
    ds_read_b64_tr_b16 v[176:177], v4 offset:192
    s_waitcnt lgkmcnt(7)
    v_mfma_f32_16x16x32_bf16 v[24:27], v[160:163], v[192:195], v[24:27]
    ds_read_b64_tr_b16 v[178:179], v4 offset:7872
    v_add_u32 v10, s55, v5
    v_mfma_f32_16x16x32_bf16 v[84:87], v[160:163], v[196:199], v[84:87]
    ds_read_b64_tr_b16 v[180:181], v4 offset:224
    s_waitcnt lgkmcnt(7)
    v_mfma_f32_16x16x32_bf16 v[88:91], v[164:167], v[196:199], v[88:91]
    ds_read_b64_tr_b16 v[182:183], v4 offset:7904
    v_mfma_f32_16x16x32_bf16 v[28:31], v[164:167], v[192:195], v[28:31]
    ds_read_b64_tr_b16 v[184:185], v4 offset:256
    s_waitcnt lgkmcnt(7)
    v_mfma_f32_16x16x32_bf16 v[32:35], v[168:171], v[192:195], v[32:35]
    ds_read_b64_tr_b16 v[186:187], v4 offset:7936
    v_mfma_f32_16x16x32_bf16 v[92:95], v[168:171], v[196:199], v[92:95]
    ds_read_b64_tr_b16 v[188:189], v4 offset:288
    s_waitcnt lgkmcnt(7)
    v_mfma_f32_16x16x32_bf16 v[96:99], v[172:175], v[196:199], v[96:99]
    ds_read_b64_tr_b16 v[190:191], v4 offset:7968
    v_mfma_f32_16x16x32_bf16 v[140:143], v[172:175], v[200:203], v[140:143]
    ds_read_b64_tr_b16 v[152:153], v4 offset:320
    v_mfma_f32_16x16x32_bf16 v[36:39], v[172:175], v[192:195], v[36:39]
    ds_read_b64_tr_b16 v[154:155], v4 offset:8000
    s_waitcnt lgkmcnt(8)
    v_mfma_f32_16x16x32_bf16 v[40:43], v[176:179], v[192:195], v[40:43]
    ds_read_b64_tr_b16 v[156:157], v4 offset:352
    v_mfma_f32_16x16x32_bf16 v[100:103], v[176:179], v[196:199], v[100:103]
    ds_read_b64_tr_b16 v[158:159], v4 offset:8032
    s_waitcnt lgkmcnt(8)
    v_mfma_f32_16x16x32_bf16 v[104:107], v[180:183], v[196:199], v[104:107]
    ds_read_b64_tr_b16 v[160:161], v4 offset:384
    v_mfma_f32_16x16x32_bf16 v[44:47], v[180:183], v[192:195], v[44:47]
    ds_read_b64_tr_b16 v[162:163], v4 offset:8064
    s_waitcnt lgkmcnt(8)
    v_mfma_f32_16x16x32_bf16 v[48:51], v[184:187], v[192:195], v[48:51]
    ds_read_b64_tr_b16 v[164:165], v4 offset:416
    v_mfma_f32_16x16x32_bf16 v[108:111], v[184:187], v[196:199], v[108:111]
    ds_read_b64_tr_b16 v[166:167], v4 offset:8096
    s_waitcnt lgkmcnt(8)
    v_mfma_f32_16x16x32_bf16 v[112:115], v[188:191], v[196:199], v[112:115]
    ds_read_b64_tr_b16 v[168:169], v4 offset:448
    v_mfma_f32_16x16x32_bf16 v[144:147], v[188:191], v[200:203], v[144:147]
    ds_read_b64_tr_b16 v[170:171], v4 offset:8128
    v_mfma_f32_16x16x32_bf16 v[52:55], v[188:191], v[192:195], v[52:55]
    s_waitcnt lgkmcnt(8)
    v_mfma_f32_16x16x32_bf16 v[56:59], v[192:195], v[152:155], v[56:59]
    s_barrier
    ds_read_b128 v[204:207], v7 offset:6144
    v_mfma_f32_16x16x32_bf16 v[116:119], v[196:199], v[152:155], v[116:119]
    ds_read_b128 v[208:211], v7 offset:8192
    s_waitcnt lgkmcnt(8)
    v_mfma_f32_16x16x32_bf16 v[120:123], v[196:199], v[156:159], v[120:123]
    ds_read_b128 v[212:215], v7 offset:0
    v_mfma_f32_16x16x32_bf16 v[60:63], v[192:195], v[156:159], v[60:63]
    ds_read_b64_tr_b16 v[172:173], v10 offset:0
    s_waitcnt lgkmcnt(8)
    v_mfma_f32_16x16x32_bf16 v[64:67], v[192:195], v[160:163], v[64:67]
    ds_read_b64_tr_b16 v[174:175], v10 offset:7680
    v_mfma_f32_16x16x32_bf16 v[124:127], v[196:199], v[160:163], v[124:127]
    ds_read_b64_tr_b16 v[176:177], v10 offset:32
    s_waitcnt lgkmcnt(8)
    v_mfma_f32_16x16x32_bf16 v[128:131], v[196:199], v[164:167], v[128:131]
    ds_read_b64_tr_b16 v[178:179], v10 offset:7712
    v_mfma_f32_16x16x32_bf16 v[148:151], v[200:203], v[164:167], v[148:151]
    ds_read_b64_tr_b16 v[180:181], v10 offset:64
    v_mfma_f32_16x16x32_bf16 v[68:71], v[192:195], v[164:167], v[68:71]
    ds_read_b64_tr_b16 v[182:183], v10 offset:7744
    s_waitcnt lgkmcnt(9)
    v_mfma_f32_16x16x32_bf16 v[72:75], v[192:195], v[168:171], v[72:75]
    ds_read_b64_tr_b16 v[184:185], v10 offset:96
    v_mfma_f32_16x16x32_bf16 v[132:135], v[196:199], v[168:171], v[132:135]
    ds_read_b64_tr_b16 v[186:187], v10 offset:7776
    s_waitcnt lgkmcnt(6)
    v_mfma_f32_16x16x32_bf16 v[16:19], v[172:175], v[204:207], v[16:19]
    ds_read_b64_tr_b16 v[188:189], v10 offset:128
    s_add_u32 s55, s55, 15360
    v_mfma_f32_16x16x32_bf16 v[76:79], v[172:175], v[208:211], v[76:79]
    ds_read_b64_tr_b16 v[190:191], v10 offset:7808
    s_waitcnt lgkmcnt(6)
    v_mfma_f32_16x16x32_bf16 v[80:83], v[176:179], v[208:211], v[80:83]
    ds_read_b64_tr_b16 v[152:153], v10 offset:160
    s_cmp_ge_u32 s55, 155648
    v_mfma_f32_16x16x32_bf16 v[136:139], v[176:179], v[12:15], v[136:139]
    ds_read_b64_tr_b16 v[154:155], v10 offset:7840
    s_cselect_b32 s55, 78848, s55
    v_mfma_f32_16x16x32_bf16 v[20:23], v[176:179], v[204:207], v[20:23]
    ds_read_b64_tr_b16 v[156:157], v10 offset:192
    s_waitcnt lgkmcnt(7)
    v_mfma_f32_16x16x32_bf16 v[24:27], v[180:183], v[204:207], v[24:27]
    ds_read_b64_tr_b16 v[158:159], v10 offset:7872
    v_add_u32 v4, s55, v5
    v_mfma_f32_16x16x32_bf16 v[84:87], v[180:183], v[208:211], v[84:87]
    ds_read_b64_tr_b16 v[160:161], v10 offset:224
    s_waitcnt lgkmcnt(7)
    v_mfma_f32_16x16x32_bf16 v[88:91], v[184:187], v[208:211], v[88:91]
    ds_read_b64_tr_b16 v[162:163], v10 offset:7904
    s_add_u32 s56, s56, 18432
    v_mfma_f32_16x16x32_bf16 v[28:31], v[184:187], v[204:207], v[28:31]
    ds_read_b64_tr_b16 v[164:165], v10 offset:256
    s_waitcnt lgkmcnt(7)
    v_mfma_f32_16x16x32_bf16 v[32:35], v[188:191], v[204:207], v[32:35]
    ds_read_b64_tr_b16 v[166:167], v10 offset:7936
    s_cmp_ge_u32 s56, 78848
    v_mfma_f32_16x16x32_bf16 v[92:95], v[188:191], v[208:211], v[92:95]
    ds_read_b64_tr_b16 v[168:169], v10 offset:288
    s_waitcnt lgkmcnt(7)
    v_mfma_f32_16x16x32_bf16 v[96:99], v[152:155], v[208:211], v[96:99]
    ds_read_b64_tr_b16 v[170:171], v10 offset:7968
    s_cselect_b32 s56, 23552, s56
    v_mfma_f32_16x16x32_bf16 v[140:143], v[152:155], v[212:215], v[140:143]
    ds_read_b64_tr_b16 v[172:173], v10 offset:320
    v_add_u32 v6, s56, v8
    v_mfma_f32_16x16x32_bf16 v[36:39], v[152:155], v[204:207], v[36:39]
    ds_read_b64_tr_b16 v[174:175], v10 offset:8000
    s_waitcnt lgkmcnt(8)
    v_mfma_f32_16x16x32_bf16 v[40:43], v[156:159], v[204:207], v[40:43]
    ds_read_b64_tr_b16 v[176:177], v10 offset:352
    v_add_u32 v7, s56, v9
    v_mfma_f32_16x16x32_bf16 v[100:103], v[156:159], v[208:211], v[100:103]
    ds_read_b64_tr_b16 v[178:179], v10 offset:8032
    s_waitcnt lgkmcnt(8)
    v_mfma_f32_16x16x32_bf16 v[104:107], v[160:163], v[208:211], v[104:107]
    ds_read_b64_tr_b16 v[180:181], v10 offset:384
    s_sub_u32 s57, s57, 1
    v_mfma_f32_16x16x32_bf16 v[44:47], v[160:163], v[204:207], v[44:47]
    ds_read_b64_tr_b16 v[182:183], v10 offset:8064
    s_waitcnt lgkmcnt(8)
    v_mfma_f32_16x16x32_bf16 v[48:51], v[164:167], v[204:207], v[48:51]
    ds_read_b64_tr_b16 v[184:185], v10 offset:416
    s_cmp_lg_u32 s57, 0
    v_mfma_f32_16x16x32_bf16 v[108:111], v[164:167], v[208:211], v[108:111]
    ds_read_b64_tr_b16 v[186:187], v10 offset:8096
    s_waitcnt lgkmcnt(8)
    v_mfma_f32_16x16x32_bf16 v[112:115], v[168:171], v[208:211], v[112:115]
    ds_read_b64_tr_b16 v[188:189], v10 offset:448
    v_mfma_f32_16x16x32_bf16 v[144:147], v[168:171], v[212:215], v[144:147]
    ds_read_b64_tr_b16 v[190:191], v10 offset:8128
    v_mfma_f32_16x16x32_bf16 v[52:55], v[168:171], v[204:207], v[52:55]
    s_waitcnt lgkmcnt(8)
    v_mfma_f32_16x16x32_bf16 v[56:59], v[204:207], v[172:175], v[56:59]
    s_barrier
    ds_read_b128 v[192:195], v6 offset:6144
    v_mfma_f32_16x16x32_bf16 v[116:119], v[208:211], v[172:175], v[116:119]
    ds_read_b128 v[196:199], v6 offset:8192
    s_waitcnt lgkmcnt(8)
    v_mfma_f32_16x16x32_bf16 v[120:123], v[208:211], v[176:179], v[120:123]
    ds_read_b128 v[200:203], v6 offset:0
    v_mfma_f32_16x16x32_bf16 v[60:63], v[204:207], v[176:179], v[60:63]
    ds_read_b64_tr_b16 v[152:153], v4 offset:0
    s_waitcnt lgkmcnt(8)
    v_mfma_f32_16x16x32_bf16 v[64:67], v[204:207], v[180:183], v[64:67]
    ds_read_b64_tr_b16 v[154:155], v4 offset:7680
    v_mfma_f32_16x16x32_bf16 v[124:127], v[208:211], v[180:183], v[124:127]
    ds_read_b64_tr_b16 v[156:157], v4 offset:32
    s_waitcnt lgkmcnt(8)
    v_mfma_f32_16x16x32_bf16 v[128:131], v[208:211], v[184:187], v[128:131]
    ds_read_b64_tr_b16 v[158:159], v4 offset:7712
    v_mfma_f32_16x16x32_bf16 v[148:151], v[212:215], v[184:187], v[148:151]
    ds_read_b64_tr_b16 v[160:161], v4 offset:64
    v_mfma_f32_16x16x32_bf16 v[68:71], v[204:207], v[184:187], v[68:71]
    ds_read_b64_tr_b16 v[162:163], v4 offset:7744
    s_waitcnt lgkmcnt(9)
    v_mfma_f32_16x16x32_bf16 v[72:75], v[204:207], v[188:191], v[72:75]
    ds_read_b64_tr_b16 v[164:165], v4 offset:96
    v_mfma_f32_16x16x32_bf16 v[132:135], v[208:211], v[188:191], v[132:135]
    ds_read_b64_tr_b16 v[166:167], v4 offset:7776
    s_cbranch_scc1 LQC1_loop
    s_mov_b32 exec_lo, 0x00010001
    s_mov_b32 exec_hi, 0x00010001
    ds_write_b128 v242, v[136:139] offset:1984
    ds_write_b128 v242, v[140:143] offset:2240
    ds_write_b128 v242, v[144:147] offset:2496
    s_mov_b64 exec, 0xffff
    ds_write_b32 v241, v148 offset:2752
    s_mov_b64 exec, -1
    s_waitcnt vmcnt(0) lgkmcnt(0)
    ds_read_b32 v6, v241 offset:0
    ds_read_b128 v[200:203], v242 offset:0
    ds_read_b32 v4, v241 offset:256
    ds_read_b32 v5, v241 offset:896
    ds_read_b128 v[12:15], v242 offset:256
    ds_read_b32 v2, v241 offset:192
    ds_read_b32 v3, v241 offset:832
    ds_read_b128 v[8:11], v242 offset:192
    s_barrier
    ds_read_b128 v[152:155], v242 offset:2240
    ds_read_b128 v[156:159], v242 offset:2304
    ds_read_b128 v[160:163], v242 offset:2368
    ds_read_b128 v[164:167], v242 offset:2432
    ds_read_b128 v[168:171], v242 offset:2496
    s_waitcnt lgkmcnt(5)
    ds_read_b32 v172, v241 offset:2560
    ds_read_b32 v173, v241 offset:2624
    ds_read_b32 v174, v241 offset:2688
    ds_read_b32 v175, v241 offset:2752
    ds_read_b32 v176, v241 offset:2816
    s_waitcnt lgkmcnt(9)
    v_pk_fma_f32 v[96:97], v[152:153], v[4:5], v[96:97] op_sel_hi:[1,0,1]
    v_pk_fma_f32 v[98:99], v[154:155], v[4:5], v[98:99] op_sel_hi:[1,0,1]
    v_cvt_pk_bf16_f32 v178, v96, v97
    v_cvt_pk_bf16_f32 v179, v98, v99
    ds_write_b64 v240, v[178:179] offset:13312
    s_waitcnt lgkmcnt(9)
    v_pk_fma_f32 v[100:101], v[156:157], v[4:5], v[100:101] op_sel_hi:[1,0,1]
    v_pk_fma_f32 v[102:103], v[158:159], v[4:5], v[102:103] op_sel_hi:[1,0,1]
    v_cvt_pk_bf16_f32 v180, v100, v101
    v_cvt_pk_bf16_f32 v181, v102, v103
    ds_write_b64 v240, v[180:181] offset:13824
    s_waitcnt lgkmcnt(9)
    v_pk_fma_f32 v[104:105], v[160:161], v[4:5], v[104:105] op_sel_hi:[1,0,1]
    v_pk_fma_f32 v[106:107], v[162:163], v[4:5], v[106:107] op_sel_hi:[1,0,1]
    v_cvt_pk_bf16_f32 v182, v104, v105
    v_cvt_pk_bf16_f32 v183, v106, v107
    ds_write_b64 v240, v[182:183] offset:14336
    s_waitcnt lgkmcnt(9)
    v_pk_fma_f32 v[108:109], v[164:165], v[4:5], v[108:109] op_sel_hi:[1,0,1]
    v_pk_fma_f32 v[110:111], v[166:167], v[4:5], v[110:111] op_sel_hi:[1,0,1]
    v_cvt_pk_bf16_f32 v184, v108, v109
    v_cvt_pk_bf16_f32 v185, v110, v111
    ds_write_b64 v240, v[184:185] offset:14848
    s_waitcnt lgkmcnt(9)
    v_pk_fma_f32 v[112:113], v[168:169], v[4:5], v[112:113] op_sel_hi:[1,0,1]
    v_pk_fma_f32 v[114:115], v[170:171], v[4:5], v[114:115] op_sel_hi:[1,0,1]
    v_cvt_pk_bf16_f32 v186, v112, v113
    v_cvt_pk_bf16_f32 v187, v114, v115
    ds_write_b64 v240, v[186:187] offset:15360
    s_waitcnt lgkmcnt(5)
    ds_read_b128 v[96:99], v242 offset:1920
    ds_read_b128 v[100:103], v242 offset:1984
    ds_read_b128 v[104:107], v242 offset:2048
    ds_read_b128 v[108:111], v242 offset:2112
    ds_read_b128 v[112:115], v242 offset:2176
    v_pk_fma_f32 v[116:117], v[12:13], v[172:173], v[116:117] op_sel:[0,0,0] op_sel_hi:[1,0,1]
    v_pk_fma_f32 v[118:119], v[14:15], v[172:173], v[118:119] op_sel:[0,0,0] op_sel_hi:[1,0,1]
    v_cvt_pk_bf16_f32 v192, v116, v117
    v_cvt_pk_bf16_f32 v193, v118, v119
    ds_write_b64 v240, v[192:193] offset:15872
    v_pk_fma_f32 v[120:121], v[12:13], v[172:173], v[120:121] op_sel:[0,1,0] op_sel_hi:[1,1,1]
    v_pk_fma_f32 v[122:123], v[14:15], v[172:173], v[122:123] op_sel:[0,1,0] op_sel_hi:[1,1,1]
    v_cvt_pk_bf16_f32 v198, v120, v121
    v_cvt_pk_bf16_f32 v199, v122, v123
    ds_write_b64 v240, v[198:199] offset:16384
    v_pk_fma_f32 v[124:125], v[12:13], v[174:175], v[124:125] op_sel:[0,0,0] op_sel_hi:[1,0,1]
    v_pk_fma_f32 v[126:127], v[14:15], v[174:175], v[126:127] op_sel:[0,0,0] op_sel_hi:[1,0,1]
    v_cvt_pk_bf16_f32 v208, v124, v125
    v_cvt_pk_bf16_f32 v209, v126, v127
    ds_write_b64 v240, v[208:209] offset:16896
    v_pk_fma_f32 v[128:129], v[12:13], v[174:175], v[128:129] op_sel:[0,1,0] op_sel_hi:[1,1,1]
    v_pk_fma_f32 v[130:131], v[14:15], v[174:175], v[130:131] op_sel:[0,1,0] op_sel_hi:[1,1,1]
    v_cvt_pk_bf16_f32 v214, v128, v129
    v_cvt_pk_bf16_f32 v215, v130, v131
    ds_write_b64 v240, v[214:215] offset:17408
    v_pk_fma_f32 v[132:133], v[12:13], v[176:177], v[132:133] op_sel:[0,0,0] op_sel_hi:[1,0,1]
    v_pk_fma_f32 v[134:135], v[14:15], v[176:177], v[134:135] op_sel:[0,0,0] op_sel_hi:[1,0,1]
    v_cvt_pk_bf16_f32 v220, v132, v133
    v_cvt_pk_bf16_f32 v221, v134, v135
    ds_write_b64 v240, v[220:221] offset:17920
    s_waitcnt lgkmcnt(8)
    v_pk_fma_f32 v[140:141], v[152:153], v[6:7], v[140:141] op_sel_hi:[1,0,1]
    v_pk_fma_f32 v[142:143], v[154:155], v[6:7], v[142:143] op_sel_hi:[1,0,1]
    v_cvt_pk_bf16_f32 v140, v140, v141
    v_cvt_pk_bf16_f32 v141, v142, v143
    ds_write_b64 v240, v[140:141] offset:3072
    v_pk_fma_f32 v[144:145], v[168:169], v[6:7], v[144:145] op_sel_hi:[1,0,1]
    v_pk_fma_f32 v[146:147], v[170:171], v[6:7], v[146:147] op_sel_hi:[1,0,1]
    v_cvt_pk_bf16_f32 v144, v144, v145
    v_cvt_pk_bf16_f32 v145, v146, v147
    ds_write_b64 v240, v[144:145] offset:5120
    v_pk_fma_f32 v[148:149], v[200:201], v[174:175], v[148:149] op_sel:[0,1,0] op_sel_hi:[1,1,1]
    v_pk_fma_f32 v[150:151], v[202:203], v[174:175], v[150:151] op_sel:[0,1,0] op_sel_hi:[1,1,1]
    v_cvt_pk_bf16_f32 v148, v148, v149
    v_cvt_pk_bf16_f32 v149, v150, v151
    ds_write_b64 v240, v[148:149] offset:7168
    s_branch LQC_common
L_QC2:
    s_barrier
    ds_read_b128 v[192:195], v6 offset:10240
    ds_read_b128 v[196:199], v6 offset:12288
    ds_read_b128 v[200:203], v6 offset:0
    ds_read_b64_tr_b16 v[152:153], v4 offset:0
    ds_read_b64_tr_b16 v[154:155], v4 offset:7680
    ds_read_b64_tr_b16 v[156:157], v4 offset:32
    ds_read_b64_tr_b16 v[158:159], v4 offset:7712
    ds_read_b64_tr_b16 v[160:161], v4 offset:64
    ds_read_b64_tr_b16 v[162:163], v4 offset:7744
    ds_read_b64_tr_b16 v[164:165], v4 offset:96
    ds_read_b64_tr_b16 v[166:167], v4 offset:7776
    s_mov_b32 s57, 10
.p2align 6
LQC2_loop:
    s_waitcnt lgkmcnt(6)
    v_mfma_f32_16x16x32_bf16 v[16:19], v[152:155], v[192:195], v[16:19]
    ds_read_b64_tr_b16 v[168:169], v4 offset:128
    s_add_u32 s55, s55, 15360
    v_mfma_f32_16x16x32_bf16 v[76:79], v[152:155], v[196:199], v[76:79]
    ds_read_b64_tr_b16 v[170:171], v4 offset:7808
    s_waitcnt lgkmcnt(6)
    v_mfma_f32_16x16x32_bf16 v[80:83], v[156:159], v[196:199], v[80:83]
    ds_read_b64_tr_b16 v[172:173], v4 offset:160
    s_cmp_ge_u32 s55, 155648
    v_mfma_f32_16x16x32_bf16 v[20:23], v[156:159], v[192:195], v[20:23]
    ds_read_b64_tr_b16 v[174:175], v4 offset:7840
    s_waitcnt lgkmcnt(6)
    v_mfma_f32_16x16x32_bf16 v[24:27], v[160:163], v[192:195], v[24:27]
    ds_read_b64_tr_b16 v[176:177], v4 offset:192
    s_cselect_b32 s55, 78848, s55
    v_mfma_f32_16x16x32_bf16 v[136:139], v[160:163], v[12:15], v[136:139]
    ds_read_b64_tr_b16 v[178:179], v4 offset:7872
    v_add_u32 v10, s55, v5
    v_mfma_f32_16x16x32_bf16 v[84:87], v[160:163], v[196:199], v[84:87]
    ds_read_b64_tr_b16 v[180:181], v4 offset:224
    s_waitcnt lgkmcnt(7)
    v_mfma_f32_16x16x32_bf16 v[88:91], v[164:167], v[196:199], v[88:91]
    ds_read_b64_tr_b16 v[182:183], v4 offset:7904
    v_mfma_f32_16x16x32_bf16 v[28:31], v[164:167], v[192:195], v[28:31]
    ds_read_b64_tr_b16 v[184:185], v4 offset:256
    s_waitcnt lgkmcnt(7)
    v_mfma_f32_16x16x32_bf16 v[32:35], v[168:171], v[192:195], v[32:35]
    ds_read_b64_tr_b16 v[186:187], v4 offset:7936
    v_mfma_f32_16x16x32_bf16 v[92:95], v[168:171], v[196:199], v[92:95]
    ds_read_b64_tr_b16 v[188:189], v4 offset:288
    s_waitcnt lgkmcnt(7)
    v_mfma_f32_16x16x32_bf16 v[96:99], v[172:175], v[196:199], v[96:99]
    ds_read_b64_tr_b16 v[190:191], v4 offset:7968
    v_mfma_f32_16x16x32_bf16 v[36:39], v[172:175], v[192:195], v[36:39]
    ds_read_b64_tr_b16 v[152:153], v4 offset:320
    s_waitcnt lgkmcnt(7)
    v_mfma_f32_16x16x32_bf16 v[40:43], v[176:179], v[192:195], v[40:43]
    ds_read_b64_tr_b16 v[154:155], v4 offset:8000
    v_mfma_f32_16x16x32_bf16 v[140:143], v[176:179], v[200:203], v[140:143]
    ds_read_b64_tr_b16 v[156:157], v4 offset:352
    v_mfma_f32_16x16x32_bf16 v[100:103], v[176:179], v[196:199], v[100:103]
    ds_read_b64_tr_b16 v[158:159], v4 offset:8032
    s_waitcnt lgkmcnt(8)
    v_mfma_f32_16x16x32_bf16 v[104:107], v[180:183], v[196:199], v[104:107]
    ds_read_b64_tr_b16 v[160:161], v4 offset:384
    v_mfma_f32_16x16x32_bf16 v[44:47], v[180:183], v[192:195], v[44:47]
    ds_read_b64_tr_b16 v[162:163], v4 offset:8064
    s_waitcnt lgkmcnt(8)
    v_mfma_f32_16x16x32_bf16 v[48:51], v[184:187], v[192:195], v[48:51]
    ds_read_b64_tr_b16 v[164:165], v4 offset:416
    v_mfma_f32_16x16x32_bf16 v[108:111], v[184:187], v[196:199], v[108:111]
    ds_read_b64_tr_b16 v[166:167], v4 offset:8096
    s_waitcnt lgkmcnt(8)
    v_mfma_f32_16x16x32_bf16 v[112:115], v[188:191], v[196:199], v[112:115]
    ds_read_b64_tr_b16 v[168:169], v4 offset:448
    v_mfma_f32_16x16x32_bf16 v[52:55], v[188:191], v[192:195], v[52:55]
    ds_read_b64_tr_b16 v[170:171], v4 offset:8128
    s_waitcnt lgkmcnt(8)
    v_mfma_f32_16x16x32_bf16 v[56:59], v[192:195], v[152:155], v[56:59]
    v_mfma_f32_16x16x32_bf16 v[144:147], v[200:203], v[152:155], v[144:147]
    s_barrier
    ds_read_b128 v[204:207], v7 offset:10240
    v_mfma_f32_16x16x32_bf16 v[116:119], v[196:199], v[152:155], v[116:119]
    ds_read_b128 v[208:211], v7 offset:12288
    s_waitcnt lgkmcnt(8)
    v_mfma_f32_16x16x32_bf16 v[120:123], v[196:199], v[156:159], v[120:123]
    ds_read_b128 v[212:215], v7 offset:0
    v_mfma_f32_16x16x32_bf16 v[60:63], v[192:195], v[156:159], v[60:63]
    ds_read_b64_tr_b16 v[172:173], v10 offset:0
    s_waitcnt lgkmcnt(8)
    v_mfma_f32_16x16x32_bf16 v[64:67], v[192:195], v[160:163], v[64:67]
    ds_read_b64_tr_b16 v[174:175], v10 offset:7680
    v_mfma_f32_16x16x32_bf16 v[124:127], v[196:199], v[160:163], v[124:127]
    ds_read_b64_tr_b16 v[176:177], v10 offset:32
    s_waitcnt lgkmcnt(8)
    v_mfma_f32_16x16x32_bf16 v[128:131], v[196:199], v[164:167], v[128:131]
    ds_read_b64_tr_b16 v[178:179], v10 offset:7712
    v_mfma_f32_16x16x32_bf16 v[68:71], v[192:195], v[164:167], v[68:71]
    ds_read_b64_tr_b16 v[180:181], v10 offset:64
    s_waitcnt lgkmcnt(8)
    v_mfma_f32_16x16x32_bf16 v[72:75], v[192:195], v[168:171], v[72:75]
    ds_read_b64_tr_b16 v[182:183], v10 offset:7744
    v_mfma_f32_16x16x32_bf16 v[148:151], v[200:203], v[168:171], v[148:151]
    ds_read_b64_tr_b16 v[184:185], v10 offset:96
    v_mfma_f32_16x16x32_bf16 v[132:135], v[196:199], v[168:171], v[132:135]
    ds_read_b64_tr_b16 v[186:187], v10 offset:7776
    s_waitcnt lgkmcnt(6)
    v_mfma_f32_16x16x32_bf16 v[16:19], v[172:175], v[204:207], v[16:19]
    ds_read_b64_tr_b16 v[188:189], v10 offset:128
    s_add_u32 s55, s55, 15360
    v_mfma_f32_16x16x32_bf16 v[76:79], v[172:175], v[208:211], v[76:79]
    ds_read_b64_tr_b16 v[190:191], v10 offset:7808
    s_waitcnt lgkmcnt(6)
    v_mfma_f32_16x16x32_bf16 v[80:83], v[176:179], v[208:211], v[80:83]
    ds_read_b64_tr_b16 v[152:153], v10 offset:160
    s_cmp_ge_u32 s55, 155648
    v_mfma_f32_16x16x32_bf16 v[20:23], v[176:179], v[204:207], v[20:23]
    ds_read_b64_tr_b16 v[154:155], v10 offset:7840
    s_waitcnt lgkmcnt(6)
    v_mfma_f32_16x16x32_bf16 v[24:27], v[180:183], v[204:207], v[24:27]
    ds_read_b64_tr_b16 v[156:157], v10 offset:192
    s_cselect_b32 s55, 78848, s55
    v_mfma_f32_16x16x32_bf16 v[136:139], v[180:183], v[12:15], v[136:139]
    ds_read_b64_tr_b16 v[158:159], v10 offset:7872
    v_add_u32 v4, s55, v5
    v_mfma_f32_16x16x32_bf16 v[84:87], v[180:183], v[208:211], v[84:87]
    ds_read_b64_tr_b16 v[160:161], v10 offset:224
    s_waitcnt lgkmcnt(7)
    v_mfma_f32_16x16x32_bf16 v[88:91], v[184:187], v[208:211], v[88:91]
    ds_read_b64_tr_b16 v[162:163], v10 offset:7904
    s_add_u32 s56, s56, 18432
    v_mfma_f32_16x16x32_bf16 v[28:31], v[184:187], v[204:207], v[28:31]
    ds_read_b64_tr_b16 v[164:165], v10 offset:256
    s_waitcnt lgkmcnt(7)
    v_mfma_f32_16x16x32_bf16 v[32:35], v[188:191], v[204:207], v[32:35]
    ds_read_b64_tr_b16 v[166:167], v10 offset:7936
    s_cmp_ge_u32 s56, 78848
    v_mfma_f32_16x16x32_bf16 v[92:95], v[188:191], v[208:211], v[92:95]
    ds_read_b64_tr_b16 v[168:169], v10 offset:288
    s_waitcnt lgkmcnt(7)
    v_mfma_f32_16x16x32_bf16 v[96:99], v[152:155], v[208:211], v[96:99]
    ds_read_b64_tr_b16 v[170:171], v10 offset:7968
    s_cselect_b32 s56, 23552, s56
    v_mfma_f32_16x16x32_bf16 v[36:39], v[152:155], v[204:207], v[36:39]
    ds_read_b64_tr_b16 v[172:173], v10 offset:320
    s_waitcnt lgkmcnt(7)
    v_mfma_f32_16x16x32_bf16 v[40:43], v[156:159], v[204:207], v[40:43]
    ds_read_b64_tr_b16 v[174:175], v10 offset:8000
    v_add_u32 v6, s56, v8
    v_mfma_f32_16x16x32_bf16 v[140:143], v[156:159], v[212:215], v[140:143]
    ds_read_b64_tr_b16 v[176:177], v10 offset:352
    v_add_u32 v7, s56, v9
    v_mfma_f32_16x16x32_bf16 v[100:103], v[156:159], v[208:211], v[100:103]
    ds_read_b64_tr_b16 v[178:179], v10 offset:8032
    s_waitcnt lgkmcnt(8)
    v_mfma_f32_16x16x32_bf16 v[104:107], v[160:163], v[208:211], v[104:107]
    ds_read_b64_tr_b16 v[180:181], v10 offset:384
    s_sub_u32 s57, s57, 1
    v_mfma_f32_16x16x32_bf16 v[44:47], v[160:163], v[204:207], v[44:47]
    ds_read_b64_tr_b16 v[182:183], v10 offset:8064
    s_waitcnt lgkmcnt(8)
    v_mfma_f32_16x16x32_bf16 v[48:51], v[164:167], v[204:207], v[48:51]
    ds_read_b64_tr_b16 v[184:185], v10 offset:416
    s_cmp_lg_u32 s57, 0
    v_mfma_f32_16x16x32_bf16 v[108:111], v[164:167], v[208:211], v[108:111]
    ds_read_b64_tr_b16 v[186:187], v10 offset:8096
    s_waitcnt lgkmcnt(8)
    v_mfma_f32_16x16x32_bf16 v[112:115], v[168:171], v[208:211], v[112:115]
    ds_read_b64_tr_b16 v[188:189], v10 offset:448
    v_mfma_f32_16x16x32_bf16 v[52:55], v[168:171], v[204:207], v[52:55]
    ds_read_b64_tr_b16 v[190:191], v10 offset:8128
    s_waitcnt lgkmcnt(8)
    v_mfma_f32_16x16x32_bf16 v[56:59], v[204:207], v[172:175], v[56:59]
    v_mfma_f32_16x16x32_bf16 v[144:147], v[212:215], v[172:175], v[144:147]
    s_barrier
    ds_read_b128 v[192:195], v6 offset:10240
    v_mfma_f32_16x16x32_bf16 v[116:119], v[208:211], v[172:175], v[116:119]
    ds_read_b128 v[196:199], v6 offset:12288
    s_waitcnt lgkmcnt(8)
    v_mfma_f32_16x16x32_bf16 v[120:123], v[208:211], v[176:179], v[120:123]
    ds_read_b128 v[200:203], v6 offset:0
    v_mfma_f32_16x16x32_bf16 v[60:63], v[204:207], v[176:179], v[60:63]
    ds_read_b64_tr_b16 v[152:153], v4 offset:0
    s_waitcnt lgkmcnt(8)
    v_mfma_f32_16x16x32_bf16 v[64:67], v[204:207], v[180:183], v[64:67]
    ds_read_b64_tr_b16 v[154:155], v4 offset:7680
    v_mfma_f32_16x16x32_bf16 v[124:127], v[208:211], v[180:183], v[124:127]
    ds_read_b64_tr_b16 v[156:157], v4 offset:32
    s_waitcnt lgkmcnt(8)
    v_mfma_f32_16x16x32_bf16 v[128:131], v[208:211], v[184:187], v[128:131]
    ds_read_b64_tr_b16 v[158:159], v4 offset:7712
    v_mfma_f32_16x16x32_bf16 v[68:71], v[204:207], v[184:187], v[68:71]
    ds_read_b64_tr_b16 v[160:161], v4 offset:64
    s_waitcnt lgkmcnt(8)
    v_mfma_f32_16x16x32_bf16 v[72:75], v[204:207], v[188:191], v[72:75]
    ds_read_b64_tr_b16 v[162:163], v4 offset:7744
    v_mfma_f32_16x16x32_bf16 v[148:151], v[212:215], v[188:191], v[148:151]
    ds_read_b64_tr_b16 v[164:165], v4 offset:96
    v_mfma_f32_16x16x32_bf16 v[132:135], v[208:211], v[188:191], v[132:135]
    ds_read_b64_tr_b16 v[166:167], v4 offset:7776
    s_cbranch_scc1 LQC2_loop
    s_mov_b32 exec_lo, 0x00010001
    s_mov_b32 exec_hi, 0x00010001
    ds_write_b128 v242, v[136:139] offset:2048
    ds_write_b128 v242, v[140:143] offset:2304
    s_mov_b64 exec, 0xffff
    ds_write_b32 v241, v144 offset:2560
    ds_write_b32 v241, v148 offset:2816
    s_mov_b64 exec, -1
    s_waitcnt vmcnt(0) lgkmcnt(0)
    ds_read_b32 v6, v241 offset:0
    ds_read_b128 v[200:203], v242 offset:0
    ds_read_b32 v4, v241 offset:384
    ds_read_b32 v5, v241 offset:1024
    ds_read_b128 v[12:15], v242 offset:384
    ds_read_b32 v2, v241 offset:320
    ds_read_b32 v3, v241 offset:960
    ds_read_b128 v[8:11], v242 offset:320
    s_barrier
    ds_read_b128 v[152:155], v242 offset:2240
    ds_read_b128 v[156:159], v242 offset:2304
    ds_read_b128 v[160:163], v242 offset:2368
    ds_read_b128 v[164:167], v242 offset:2432
    ds_read_b128 v[168:171], v242 offset:2496
    s_waitcnt lgkmcnt(5)
    ds_read_b32 v172, v241 offset:2560
    ds_read_b32 v173, v241 offset:2624
    ds_read_b32 v174, v241 offset:2688
    ds_read_b32 v175, v241 offset:2752
    ds_read_b32 v176, v241 offset:2816
    s_waitcnt lgkmcnt(9)
    v_pk_fma_f32 v[96:97], v[152:153], v[4:5], v[96:97] op_sel_hi:[1,0,1]
    v_pk_fma_f32 v[98:99], v[154:155], v[4:5], v[98:99] op_sel_hi:[1,0,1]
    v_cvt_pk_bf16_f32 v178, v96, v97
    v_cvt_pk_bf16_f32 v179, v98, v99
    ds_write_b64 v240, v[178:179] offset:18432
    s_waitcnt lgkmcnt(9)
    v_pk_fma_f32 v[100:101], v[156:157], v[4:5], v[100:101] op_sel_hi:[1,0,1]
    v_pk_fma_f32 v[102:103], v[158:159], v[4:5], v[102:103] op_sel_hi:[1,0,1]
    v_cvt_pk_bf16_f32 v180, v100, v101
    v_cvt_pk_bf16_f32 v181, v102, v103
    ds_write_b64 v240, v[180:181] offset:18944
    s_waitcnt lgkmcnt(9)
    v_pk_fma_f32 v[104:105], v[160:161], v[4:5], v[104:105] op_sel_hi:[1,0,1]
    v_pk_fma_f32 v[106:107], v[162:163], v[4:5], v[106:107] op_sel_hi:[1,0,1]
    v_cvt_pk_bf16_f32 v182, v104, v105
    v_cvt_pk_bf16_f32 v183, v106, v107
    ds_write_b64 v240, v[182:183] offset:19456
    s_waitcnt lgkmcnt(9)
    v_pk_fma_f32 v[108:109], v[164:165], v[4:5], v[108:109] op_sel_hi:[1,0,1]
    v_pk_fma_f32 v[110:111], v[166:167], v[4:5], v[110:111] op_sel_hi:[1,0,1]
    v_cvt_pk_bf16_f32 v184, v108, v109
    v_cvt_pk_bf16_f32 v185, v110, v111
    ds_write_b64 v240, v[184:185] offset:19968
    s_waitcnt lgkmcnt(9)
    v_pk_fma_f32 v[112:113], v[168:169], v[4:5], v[112:113] op_sel_hi:[1,0,1]
    v_pk_fma_f32 v[114:115], v[170:171], v[4:5], v[114:115] op_sel_hi:[1,0,1]
    v_cvt_pk_bf16_f32 v186, v112, v113
    v_cvt_pk_bf16_f32 v187, v114, v115
    ds_write_b64 v240, v[186:187] offset:20480
    s_waitcnt lgkmcnt(5)
    ds_read_b128 v[96:99], v242 offset:1920
    ds_read_b128 v[100:103], v242 offset:1984
    ds_read_b128 v[104:107], v242 offset:2048
    ds_read_b128 v[108:111], v242 offset:2112
    ds_read_b128 v[112:115], v242 offset:2176
    v_pk_fma_f32 v[116:117], v[12:13], v[172:173], v[116:117] op_sel:[0,0,0] op_sel_hi:[1,0,1]
    v_pk_fma_f32 v[118:119], v[14:15], v[172:173], v[118:119] op_sel:[0,0,0] op_sel_hi:[1,0,1]
    v_cvt_pk_bf16_f32 v192, v116, v117
    v_cvt_pk_bf16_f32 v193, v118, v119
    ds_write_b64 v240, v[192:193] offset:20992
    v_pk_fma_f32 v[120:121], v[12:13], v[172:173], v[120:121] op_sel:[0,1,0] op_sel_hi:[1,1,1]
    v_pk_fma_f32 v[122:123], v[14:15], v[172:173], v[122:123] op_sel:[0,1,0] op_sel_hi:[1,1,1]
    v_cvt_pk_bf16_f32 v198, v120, v121
    v_cvt_pk_bf16_f32 v199, v122, v123
    ds_write_b64 v240, v[198:199] offset:21504
    v_pk_fma_f32 v[124:125], v[12:13], v[174:175], v[124:125] op_sel:[0,0,0] op_sel_hi:[1,0,1]
    v_pk_fma_f32 v[126:127], v[14:15], v[174:175], v[126:127] op_sel:[0,0,0] op_sel_hi:[1,0,1]
    v_cvt_pk_bf16_f32 v208, v124, v125
    v_cvt_pk_bf16_f32 v209, v126, v127
    ds_write_b64 v240, v[208:209] offset:22016
    v_pk_fma_f32 v[128:129], v[12:13], v[174:175], v[128:129] op_sel:[0,1,0] op_sel_hi:[1,1,1]
    v_pk_fma_f32 v[130:131], v[14:15], v[174:175], v[130:131] op_sel:[0,1,0] op_sel_hi:[1,1,1]
    v_cvt_pk_bf16_f32 v214, v128, v129
    v_cvt_pk_bf16_f32 v215, v130, v131
    ds_write_b64 v240, v[214:215] offset:22528
    v_pk_fma_f32 v[132:133], v[12:13], v[176:177], v[132:133] op_sel:[0,0,0] op_sel_hi:[1,0,1]
    v_pk_fma_f32 v[134:135], v[14:15], v[176:177], v[134:135] op_sel:[0,0,0] op_sel_hi:[1,0,1]
    v_cvt_pk_bf16_f32 v220, v132, v133
    v_cvt_pk_bf16_f32 v221, v134, v135
    ds_write_b64 v240, v[220:221] offset:23040
    s_waitcnt lgkmcnt(8)
    v_pk_fma_f32 v[140:141], v[156:157], v[6:7], v[140:141] op_sel_hi:[1,0,1]
    v_pk_fma_f32 v[142:143], v[158:159], v[6:7], v[142:143] op_sel_hi:[1,0,1]
    v_cvt_pk_bf16_f32 v140, v140, v141
    v_cvt_pk_bf16_f32 v141, v142, v143
    ds_write_b64 v240, v[140:141] offset:3584
    v_pk_fma_f32 v[144:145], v[200:201], v[172:173], v[144:145] op_sel:[0,0,0] op_sel_hi:[1,0,1]
    v_pk_fma_f32 v[146:147], v[202:203], v[172:173], v[146:147] op_sel:[0,0,0] op_sel_hi:[1,0,1]
    v_cvt_pk_bf16_f32 v144, v144, v145
    v_cvt_pk_bf16_f32 v145, v146, v147
    ds_write_b64 v240, v[144:145] offset:5632
    v_pk_fma_f32 v[148:149], v[200:201], v[176:177], v[148:149] op_sel:[0,0,0] op_sel_hi:[1,0,1]
    v_pk_fma_f32 v[150:151], v[202:203], v[176:177], v[150:151] op_sel:[0,0,0] op_sel_hi:[1,0,1]
    v_cvt_pk_bf16_f32 v148, v148, v149
    v_cvt_pk_bf16_f32 v149, v150, v151
    ds_write_b64 v240, v[148:149] offset:7680
    s_branch LQC_common
L_QC3:
    s_barrier
    ds_read_b128 v[192:195], v6 offset:14336
    ds_read_b128 v[196:199], v6 offset:16384
    ds_read_b128 v[200:203], v6 offset:0
    ds_read_b64_tr_b16 v[152:153], v4 offset:0
    ds_read_b64_tr_b16 v[154:155], v4 offset:7680
    ds_read_b64_tr_b16 v[156:157], v4 offset:32
    ds_read_b64_tr_b16 v[158:159], v4 offset:7712
    ds_read_b64_tr_b16 v[160:161], v4 offset:64
    ds_read_b64_tr_b16 v[162:163], v4 offset:7744
    ds_read_b64_tr_b16 v[164:165], v4 offset:96
    ds_read_b64_tr_b16 v[166:167], v4 offset:7776
    s_mov_b32 s57, 10
.p2align 6
LQC3_loop:
    s_waitcnt lgkmcnt(6)
    v_mfma_f32_16x16x32_bf16 v[16:19], v[152:155], v[192:195], v[16:19]
    ds_read_b64_tr_b16 v[168:169], v4 offset:128
    s_add_u32 s55, s55, 15360
    v_mfma_f32_16x16x32_bf16 v[76:79], v[152:155], v[196:199], v[76:79]
    ds_read_b64_tr_b16 v[170:171], v4 offset:7808
    s_waitcnt lgkmcnt(6)
    v_mfma_f32_16x16x32_bf16 v[80:83], v[156:159], v[196:199], v[80:83]
    ds_read_b64_tr_b16 v[172:173], v4 offset:160
    s_cmp_ge_u32 s55, 155648
    v_mfma_f32_16x16x32_bf16 v[20:23], v[156:159], v[192:195], v[20:23]
    ds_read_b64_tr_b16 v[174:175], v4 offset:7840
    s_waitcnt lgkmcnt(6)
    v_mfma_f32_16x16x32_bf16 v[24:27], v[160:163], v[192:195], v[24:27]
    ds_read_b64_tr_b16 v[176:177], v4 offset:192
    s_cselect_b32 s55, 78848, s55
    v_mfma_f32_16x16x32_bf16 v[84:87], v[160:163], v[196:199], v[84:87]
    ds_read_b64_tr_b16 v[178:179], v4 offset:7872
    s_waitcnt lgkmcnt(6)
    v_mfma_f32_16x16x32_bf16 v[88:91], v[164:167], v[196:199], v[88:91]
    ds_read_b64_tr_b16 v[180:181], v4 offset:224
    v_add_u32 v10, s55, v5
    v_mfma_f32_16x16x32_bf16 v[136:139], v[164:167], v[12:15], v[136:139]
    ds_read_b64_tr_b16 v[182:183], v4 offset:7904
    v_mfma_f32_16x16x32_bf16 v[28:31], v[164:167], v[192:195], v[28:31]
    ds_read_b64_tr_b16 v[184:185], v4 offset:256
    s_waitcnt lgkmcnt(7)
    v_mfma_f32_16x16x32_bf16 v[32:35], v[168:171], v[192:195], v[32:35]
    ds_read_b64_tr_b16 v[186:187], v4 offset:7936
    v_mfma_f32_16x16x32_bf16 v[92:95], v[168:171], v[196:199], v[92:95]
    ds_read_b64_tr_b16 v[188:189], v4 offset:288
    s_waitcnt lgkmcnt(7)
    v_mfma_f32_16x16x32_bf16 v[96:99], v[172:175], v[196:199], v[96:99]
    ds_read_b64_tr_b16 v[190:191], v4 offset:7968
    v_mfma_f32_16x16x32_bf16 v[36:39], v[172:175], v[192:195], v[36:39]
    ds_read_b64_tr_b16 v[152:153], v4 offset:320
    s_waitcnt lgkmcnt(7)
    v_mfma_f32_16x16x32_bf16 v[40:43], v[176:179], v[192:195], v[40:43]
    ds_read_b64_tr_b16 v[154:155], v4 offset:8000
    v_mfma_f32_16x16x32_bf16 v[100:103], v[176:179], v[196:199], v[100:103]
    ds_read_b64_tr_b16 v[156:157], v4 offset:352
    s_waitcnt lgkmcnt(7)
    v_mfma_f32_16x16x32_bf16 v[104:107], v[180:183], v[196:199], v[104:107]
    ds_read_b64_tr_b16 v[158:159], v4 offset:8032
    v_mfma_f32_16x16x32_bf16 v[140:143], v[180:183], v[200:203], v[140:143]
    ds_read_b64_tr_b16 v[160:161], v4 offset:384
    v_mfma_f32_16x16x32_bf16 v[44:47], v[180:183], v[192:195], v[44:47]
    ds_read_b64_tr_b16 v[162:163], v4 offset:8064
    s_waitcnt lgkmcnt(8)
    v_mfma_f32_16x16x32_bf16 v[48:51], v[184:187], v[192:195], v[48:51]
    ds_read_b64_tr_b16 v[164:165], v4 offset:416
    v_mfma_f32_16x16x32_bf16 v[108:111], v[184:187], v[196:199], v[108:111]
    ds_read_b64_tr_b16 v[166:167], v4 offset:8096
    s_waitcnt lgkmcnt(8)
    v_mfma_f32_16x16x32_bf16 v[112:115], v[188:191], v[196:199], v[112:115]
    ds_read_b64_tr_b16 v[168:169], v4 offset:448
    v_mfma_f32_16x16x32_bf16 v[52:55], v[188:191], v[192:195], v[52:55]
    ds_read_b64_tr_b16 v[170:171], v4 offset:8128
    s_waitcnt lgkmcnt(8)
    v_mfma_f32_16x16x32_bf16 v[56:59], v[192:195], v[152:155], v[56:59]
    s_barrier
    ds_read_b128 v[204:207], v7 offset:14336
    v_mfma_f32_16x16x32_bf16 v[116:119], v[196:199], v[152:155], v[116:119]
    ds_read_b128 v[208:211], v7 offset:16384
    s_waitcnt lgkmcnt(8)
    v_mfma_f32_16x16x32_bf16 v[120:123], v[196:199], v[156:159], v[120:123]
    ds_read_b128 v[212:215], v7 offset:0
    v_mfma_f32_16x16x32_bf16 v[144:147], v[200:203], v[156:159], v[144:147]
    ds_read_b64_tr_b16 v[172:173], v10 offset:0
    v_mfma_f32_16x16x32_bf16 v[60:63], v[192:195], v[156:159], v[60:63]
    ds_read_b64_tr_b16 v[174:175], v10 offset:7680
    s_waitcnt lgkmcnt(9)
    v_mfma_f32_16x16x32_bf16 v[64:67], v[192:195], v[160:163], v[64:67]
    ds_read_b64_tr_b16 v[176:177], v10 offset:32
    v_mfma_f32_16x16x32_bf16 v[124:127], v[196:199], v[160:163], v[124:127]
    ds_read_b64_tr_b16 v[178:179], v10 offset:7712
    s_waitcnt lgkmcnt(9)
    v_mfma_f32_16x16x32_bf16 v[128:131], v[196:199], v[164:167], v[128:131]
    ds_read_b64_tr_b16 v[180:181], v10 offset:64
    v_mfma_f32_16x16x32_bf16 v[68:71], v[192:195], v[164:167], v[68:71]
    ds_read_b64_tr_b16 v[182:183], v10 offset:7744
    s_waitcnt lgkmcnt(9)
    v_mfma_f32_16x16x32_bf16 v[72:75], v[192:195], v[168:171], v[72:75]
    ds_read_b64_tr_b16 v[184:185], v10 offset:96
    v_mfma_f32_16x16x32_bf16 v[132:135], v[196:199], v[168:171], v[132:135]
    ds_read_b64_tr_b16 v[186:187], v10 offset:7776
    s_waitcnt lgkmcnt(6)
    v_mfma_f32_16x16x32_bf16 v[16:19], v[172:175], v[204:207], v[16:19]
    ds_read_b64_tr_b16 v[188:189], v10 offset:128
    s_add_u32 s55, s55, 15360
    v_mfma_f32_16x16x32_bf16 v[76:79], v[172:175], v[208:211], v[76:79]
    ds_read_b64_tr_b16 v[190:191], v10 offset:7808
    s_waitcnt lgkmcnt(6)
    v_mfma_f32_16x16x32_bf16 v[80:83], v[176:179], v[208:211], v[80:83]
    ds_read_b64_tr_b16 v[152:153], v10 offset:160
    s_cmp_ge_u32 s55, 155648
    v_mfma_f32_16x16x32_bf16 v[20:23], v[176:179], v[204:207], v[20:23]
    ds_read_b64_tr_b16 v[154:155], v10 offset:7840
    s_waitcnt lgkmcnt(6)
    v_mfma_f32_16x16x32_bf16 v[24:27], v[180:183], v[204:207], v[24:27]
    ds_read_b64_tr_b16 v[156:157], v10 offset:192
    s_cselect_b32 s55, 78848, s55
    v_mfma_f32_16x16x32_bf16 v[84:87], v[180:183], v[208:211], v[84:87]
    ds_read_b64_tr_b16 v[158:159], v10 offset:7872
    s_waitcnt lgkmcnt(6)
    v_mfma_f32_16x16x32_bf16 v[88:91], v[184:187], v[208:211], v[88:91]
    ds_read_b64_tr_b16 v[160:161], v10 offset:224
    v_add_u32 v4, s55, v5
    v_mfma_f32_16x16x32_bf16 v[136:139], v[184:187], v[12:15], v[136:139]
    ds_read_b64_tr_b16 v[162:163], v10 offset:7904
    s_add_u32 s56, s56, 18432
    v_mfma_f32_16x16x32_bf16 v[28:31], v[184:187], v[204:207], v[28:31]
    ds_read_b64_tr_b16 v[164:165], v10 offset:256
    s_waitcnt lgkmcnt(7)
    v_mfma_f32_16x16x32_bf16 v[32:35], v[188:191], v[204:207], v[32:35]
    ds_read_b64_tr_b16 v[166:167], v10 offset:7936
    s_cmp_ge_u32 s56, 78848
    v_mfma_f32_16x16x32_bf16 v[92:95], v[188:191], v[208:211], v[92:95]
    ds_read_b64_tr_b16 v[168:169], v10 offset:288
    s_waitcnt lgkmcnt(7)
    v_mfma_f32_16x16x32_bf16 v[96:99], v[152:155], v[208:211], v[96:99]
    ds_read_b64_tr_b16 v[170:171], v10 offset:7968
    s_cselect_b32 s56, 23552, s56
    v_mfma_f32_16x16x32_bf16 v[36:39], v[152:155], v[204:207], v[36:39]
    ds_read_b64_tr_b16 v[172:173], v10 offset:320
    s_waitcnt lgkmcnt(7)
    v_mfma_f32_16x16x32_bf16 v[40:43], v[156:159], v[204:207], v[40:43]
    ds_read_b64_tr_b16 v[174:175], v10 offset:8000
    v_add_u32 v6, s56, v8
    v_mfma_f32_16x16x32_bf16 v[100:103], v[156:159], v[208:211], v[100:103]
    ds_read_b64_tr_b16 v[176:177], v10 offset:352
    s_waitcnt lgkmcnt(7)
    v_mfma_f32_16x16x32_bf16 v[104:107], v[160:163], v[208:211], v[104:107]
    ds_read_b64_tr_b16 v[178:179], v10 offset:8032
    v_add_u32 v7, s56, v9
    v_mfma_f32_16x16x32_bf16 v[140:143], v[160:163], v[212:215], v[140:143]
    ds_read_b64_tr_b16 v[180:181], v10 offset:384
    s_sub_u32 s57, s57, 1
    v_mfma_f32_16x16x32_bf16 v[44:47], v[160:163], v[204:207], v[44:47]
    ds_read_b64_tr_b16 v[182:183], v10 offset:8064
    s_waitcnt lgkmcnt(8)
    v_mfma_f32_16x16x32_bf16 v[48:51], v[164:167], v[204:207], v[48:51]
    ds_read_b64_tr_b16 v[184:185], v10 offset:416
    s_cmp_lg_u32 s57, 0
    v_mfma_f32_16x16x32_bf16 v[108:111], v[164:167], v[208:211], v[108:111]
    ds_read_b64_tr_b16 v[186:187], v10 offset:8096
    s_waitcnt lgkmcnt(8)
    v_mfma_f32_16x16x32_bf16 v[112:115], v[168:171], v[208:211], v[112:115]
    ds_read_b64_tr_b16 v[188:189], v10 offset:448
    v_mfma_f32_16x16x32_bf16 v[52:55], v[168:171], v[204:207], v[52:55]
    ds_read_b64_tr_b16 v[190:191], v10 offset:8128
    s_waitcnt lgkmcnt(8)
    v_mfma_f32_16x16x32_bf16 v[56:59], v[204:207], v[172:175], v[56:59]
    s_barrier
    ds_read_b128 v[192:195], v6 offset:14336
    v_mfma_f32_16x16x32_bf16 v[116:119], v[208:211], v[172:175], v[116:119]
    ds_read_b128 v[196:199], v6 offset:16384
    s_waitcnt lgkmcnt(8)
    v_mfma_f32_16x16x32_bf16 v[120:123], v[208:211], v[176:179], v[120:123]
    ds_read_b128 v[200:203], v6 offset:0
    v_mfma_f32_16x16x32_bf16 v[144:147], v[212:215], v[176:179], v[144:147]
    ds_read_b64_tr_b16 v[152:153], v4 offset:0
    v_mfma_f32_16x16x32_bf16 v[60:63], v[204:207], v[176:179], v[60:63]
    ds_read_b64_tr_b16 v[154:155], v4 offset:7680
    s_waitcnt lgkmcnt(9)
    v_mfma_f32_16x16x32_bf16 v[64:67], v[204:207], v[180:183], v[64:67]
    ds_read_b64_tr_b16 v[156:157], v4 offset:32
    v_mfma_f32_16x16x32_bf16 v[124:127], v[208:211], v[180:183], v[124:127]
    ds_read_b64_tr_b16 v[158:159], v4 offset:7712
    s_waitcnt lgkmcnt(9)
    v_mfma_f32_16x16x32_bf16 v[128:131], v[208:211], v[184:187], v[128:131]
    ds_read_b64_tr_b16 v[160:161], v4 offset:64
    v_mfma_f32_16x16x32_bf16 v[68:71], v[204:207], v[184:187], v[68:71]
    ds_read_b64_tr_b16 v[162:163], v4 offset:7744
    s_waitcnt lgkmcnt(9)
    v_mfma_f32_16x16x32_bf16 v[72:75], v[204:207], v[188:191], v[72:75]
    ds_read_b64_tr_b16 v[164:165], v4 offset:96
    v_mfma_f32_16x16x32_bf16 v[132:135], v[208:211], v[188:191], v[132:135]
    ds_read_b64_tr_b16 v[166:167], v4 offset:7776
    s_cbranch_scc1 LQC3_loop
    s_mov_b32 exec_lo, 0x00010001
    s_mov_b32 exec_hi, 0x00010001
    ds_write_b128 v242, v[136:139] offset:2112
    ds_write_b128 v242, v[140:143] offset:2368
    s_mov_b64 exec, 0xffff
    ds_write_b32 v241, v144 offset:2624
    s_mov_b64 exec, -1
    s_waitcnt vmcnt(0) lgkmcnt(0)
    ds_read_b32 v6, v241 offset:0
    ds_read_b128 v[200:203], v242 offset:0
    ds_read_b32 v4, v241 offset:512
    ds_read_b32 v5, v241 offset:1152
    ds_read_b128 v[12:15], v242 offset:512
    ds_read_b32 v2, v241 offset:448
    ds_read_b32 v3, v241 offset:1088
    ds_read_b128 v[8:11], v242 offset:448
    s_barrier
    ds_read_b128 v[152:155], v242 offset:2240
    ds_read_b128 v[156:159], v242 offset:2304
    ds_read_b128 v[160:163], v242 offset:2368
    ds_read_b128 v[164:167], v242 offset:2432
    ds_read_b128 v[168:171], v242 offset:2496
    s_waitcnt lgkmcnt(5)
    ds_read_b32 v172, v241 offset:2560
    ds_read_b32 v173, v241 offset:2624
    ds_read_b32 v174, v241 offset:2688
    ds_read_b32 v175, v241 offset:2752
    ds_read_b32 v176, v241 offset:2816
    s_waitcnt lgkmcnt(9)
    v_pk_fma_f32 v[96:97], v[152:153], v[4:5], v[96:97] op_sel_hi:[1,0,1]
    v_pk_fma_f32 v[98:99], v[154:155], v[4:5], v[98:99] op_sel_hi:[1,0,1]
    v_cvt_pk_bf16_f32 v178, v96, v97
    v_cvt_pk_bf16_f32 v179, v98, v99
    s_waitcnt lgkmcnt(8)
    v_pk_fma_f32 v[100:101], v[156:157], v[4:5], v[100:101] op_sel_hi:[1,0,1]
    v_pk_fma_f32 v[102:103], v[158:159], v[4:5], v[102:103] op_sel_hi:[1,0,1]
    v_cvt_pk_bf16_f32 v180, v100, v101
    v_cvt_pk_bf16_f32 v181, v102, v103
    s_waitcnt lgkmcnt(7)
    v_pk_fma_f32 v[104:105], v[160:161], v[4:5], v[104:105] op_sel_hi:[1,0,1]
    v_pk_fma_f32 v[106:107], v[162:163], v[4:5], v[106:107] op_sel_hi:[1,0,1]
    v_cvt_pk_bf16_f32 v182, v104, v105
    v_cvt_pk_bf16_f32 v183, v106, v107
    s_waitcnt lgkmcnt(6)
    v_pk_fma_f32 v[108:109], v[164:165], v[4:5], v[108:109] op_sel_hi:[1,0,1]
    v_pk_fma_f32 v[110:111], v[166:167], v[4:5], v[110:111] op_sel_hi:[1,0,1]
    v_cvt_pk_bf16_f32 v184, v108, v109
    v_cvt_pk_bf16_f32 v185, v110, v111
    s_waitcnt lgkmcnt(5)
    v_pk_fma_f32 v[112:113], v[168:169], v[4:5], v[112:113] op_sel_hi:[1,0,1]
    v_pk_fma_f32 v[114:115], v[170:171], v[4:5], v[114:115] op_sel_hi:[1,0,1]
    v_cvt_pk_bf16_f32 v186, v112, v113
    v_cvt_pk_bf16_f32 v187, v114, v115
    s_waitcnt lgkmcnt(0)
    ds_read_b128 v[96:99], v242 offset:1920
    ds_read_b128 v[100:103], v242 offset:1984
    ds_read_b128 v[104:107], v242 offset:2048
    ds_read_b128 v[108:111], v242 offset:2112
    ds_read_b128 v[112:115], v242 offset:2176
    v_pk_fma_f32 v[116:117], v[12:13], v[172:173], v[116:117] op_sel:[0,0,0] op_sel_hi:[1,0,1]
    v_pk_fma_f32 v[118:119], v[14:15], v[172:173], v[118:119] op_sel:[0,0,0] op_sel_hi:[1,0,1]
    v_cvt_pk_bf16_f32 v192, v116, v117
    v_cvt_pk_bf16_f32 v193, v118, v119
    v_pk_fma_f32 v[120:121], v[12:13], v[172:173], v[120:121] op_sel:[0,1,0] op_sel_hi:[1,1,1]
    v_pk_fma_f32 v[122:123], v[14:15], v[172:173], v[122:123] op_sel:[0,1,0] op_sel_hi:[1,1,1]
    v_cvt_pk_bf16_f32 v198, v120, v121
    v_cvt_pk_bf16_f32 v199, v122, v123
    v_pk_fma_f32 v[124:125], v[12:13], v[174:175], v[124:125] op_sel:[0,0,0] op_sel_hi:[1,0,1]
    v_pk_fma_f32 v[126:127], v[14:15], v[174:175], v[126:127] op_sel:[0,0,0] op_sel_hi:[1,0,1]
    v_cvt_pk_bf16_f32 v208, v124, v125
    v_cvt_pk_bf16_f32 v209, v126, v127
    v_pk_fma_f32 v[128:129], v[12:13], v[174:175], v[128:129] op_sel:[0,1,0] op_sel_hi:[1,1,1]
    v_pk_fma_f32 v[130:131], v[14:15], v[174:175], v[130:131] op_sel:[0,1,0] op_sel_hi:[1,1,1]
    v_cvt_pk_bf16_f32 v214, v128, v129
    v_cvt_pk_bf16_f32 v215, v130, v131
    v_pk_fma_f32 v[132:133], v[12:13], v[176:177], v[132:133] op_sel:[0,0,0] op_sel_hi:[1,0,1]
    v_pk_fma_f32 v[134:135], v[14:15], v[176:177], v[134:135] op_sel:[0,0,0] op_sel_hi:[1,0,1]
    v_cvt_pk_bf16_f32 v220, v132, v133
    v_cvt_pk_bf16_f32 v221, v134, v135
    s_waitcnt lgkmcnt(8)
    v_pk_fma_f32 v[140:141], v[160:161], v[6:7], v[140:141] op_sel_hi:[1,0,1]
    v_pk_fma_f32 v[142:143], v[162:163], v[6:7], v[142:143] op_sel_hi:[1,0,1]
    v_cvt_pk_bf16_f32 v140, v140, v141
    v_cvt_pk_bf16_f32 v141, v142, v143
    ds_write_b64 v240, v[140:141] offset:4096
    v_pk_fma_f32 v[144:145], v[200:201], v[172:173], v[144:145] op_sel:[0,1,0] op_sel_hi:[1,1,1]
    v_pk_fma_f32 v[146:147], v[202:203], v[172:173], v[146:147] op_sel:[0,1,0] op_sel_hi:[1,1,1]
    v_cvt_pk_bf16_f32 v144, v144, v145
    v_cvt_pk_bf16_f32 v145, v146, v147
    ds_write_b64 v240, v[144:145] offset:6144
    s_branch LQC_common
LFL_W:
    s_mul_i32 s51, s68, 256
    s_mov_b32 s50, 2731
    s_mul_i32 s55, s48, 384
    s_mul_i32 s59, s68, 4096
    s_and_b32 s56, s10, 3
    s_mul_i32 s49, s10, 98304
    s_add_u32 m0, s59, 72704
    s_add_u32 s49, s49, s55
    v_add_u32 v4, s51, v0
    v_mul_u32_u24 v5, s50, v4
    v_lshrrev_b32 v5, 16, v5
    v_mul_u32_u24 v8, 24, v5
    v_sub_u32 v6, v4, v8
    v_and_b32 v7, 12, v5
    v_add_u32 v7, v7, v5
    v_lshrrev_b32 v8, 4, v5
    v_mad_i32_i24 v7, v8, -12, v7
    v_mul_u32_u24 v7, 3072, v7
    v_and_b32 v8, 6, v5
    v_xor_b32 v6, v6, v8
    v_lshl_add_u32 v10, v6, 4, v7
    s_waitcnt lgkmcnt(0)
    s_mov_b32 s28, s12
    s_mov_b32 s29, s13
    s_mov_b32 s30, 1966080
    s_mov_b32 s31, 0x20000
    buffer_load_dwordx4 v10, s[28:31], s49 offen offset:0 lds
    v_add_u32 v4, 64, v4
    v_mul_u32_u24 v5, s50, v4
    v_lshrrev_b32 v5, 16, v5
    v_mul_u32_u24 v8, 24, v5
    v_sub_u32 v6, v4, v8
    v_and_b32 v7, 12, v5
    v_add_u32 v7, v7, v5
    v_lshrrev_b32 v8, 4, v5
    v_mad_i32_i24 v7, v8, -12, v7
    v_mul_u32_u24 v7, 3072, v7
    v_and_b32 v8, 6, v5
    v_xor_b32 v6, v6, v8
    v_lshl_add_u32 v11, v6, 4, v7
    v_subrev_u32 v11, 1024, v11
    buffer_load_dwordx4 v11, s[28:31], s49 offen offset:1024 lds
    v_add_u32 v4, 64, v4
    v_mul_u32_u24 v5, s50, v4
    v_lshrrev_b32 v5, 16, v5
    v_mul_u32_u24 v8, 24, v5
    v_sub_u32 v6, v4, v8
    v_and_b32 v7, 12, v5
    v_add_u32 v7, v7, v5
    v_lshrrev_b32 v8, 4, v5
    v_mad_i32_i24 v7, v8, -12, v7
    v_mul_u32_u24 v7, 3072, v7
    v_and_b32 v8, 6, v5
    v_xor_b32 v6, v6, v8
    v_lshl_add_u32 v12, v6, 4, v7
    v_subrev_u32 v12, 2048, v12
    buffer_load_dwordx4 v12, s[28:31], s49 offen offset:2048 lds
    v_add_u32 v4, 64, v4
    v_mul_u32_u24 v5, s50, v4
    v_lshrrev_b32 v5, 16, v5
    v_mul_u32_u24 v8, 24, v5
    v_sub_u32 v6, v4, v8
    v_and_b32 v7, 12, v5
    v_add_u32 v7, v7, v5
    v_lshrrev_b32 v8, 4, v5
    v_mad_i32_i24 v7, v8, -12, v7
    v_mul_u32_u24 v7, 3072, v7
    v_and_b32 v8, 6, v5
    v_xor_b32 v6, v6, v8
    v_lshl_add_u32 v13, v6, 4, v7
    v_subrev_u32 v13, 3072, v13
    buffer_load_dwordx4 v13, s[28:31], s49 offen offset:3072 lds
    s_xor_b32 s49, s10, 1
    s_mul_i32 s49, s49, 98304
    s_add_u32 m0, s59, 84992
    s_add_u32 s49, s49, s55
    buffer_load_dwordx4 v10, s[28:31], s49 offen offset:0 lds
    buffer_load_dwordx4 v11, s[28:31], s49 offen offset:1024 lds
    buffer_load_dwordx4 v12, s[28:31], s49 offen offset:2048 lds
    buffer_load_dwordx4 v13, s[28:31], s49 offen offset:3072 lds
    s_mov_b64 s[60:61], s[6:7]
    v_lshlrev_b32 v2, 1, v2
    v_xor_b32 v2, v2, v3
    v_lshl_add_u32 v26, v2, 4, v1
    v_add_u32 v27, 9216, v26
    v_lshlrev_b32 v20, 4, v0
    v_lshlrev_b32 v21, 2, v0
    v_mov_b32 v28, 0
    v_mov_b32 v24, 0
    s_mov_b32 s58, 0
    s_mov_b32 s36, s20
    s_mov_b32 s37, s21
    s_mov_b32 s38, 11640832
    s_mov_b32 s39, 0x20000
    s_mov_b32 s40, s14
    s_mov_b32 s41, s15
    s_mov_b32 s42, 1966080
    s_mov_b32 s43, 0x20000
    s_mov_b32 s32, s8
    s_mov_b32 s33, s9
    s_mov_b32 s34, 819200
    s_mov_b32 s35, 0x20000
    s_mov_b32 s72, s18
    s_mov_b32 s73, s19
    s_mov_b32 s74, 256
    s_mov_b32 s75, 0x20000
    s_sub_u32 s49, s53, 16
    s_lshr_b32 s50, s49, 2
    s_and_b32 s51, s49, 3
    s_sub_u32 s52, s49, 6
    s_lshr_b32 s52, s52, 1
    s_and_b32 s70, s49, 1
    s_cmp_lt_u32 s49, 12
    s_cselect_b32 s71, s50, s52
    s_cselect_b32 s70, s51, s70
    s_mul_i32 s70, s70, 6
    s_and_b32 s50, s53, 3
    s_and_b32 s51, s53, 1
    s_lshl_b32 s51, s51, 1
    s_cmp_lt_u32 s53, 28
    s_cselect_b32 s50, s50, s51
    s_lshl_b32 s50, s50, 1
    s_mul_i32 s11, s71, 3
    s_add_u32 s11, s11, s50
    s_lshr_b32 s49, s54, 1
    s_lshl_b32 s49, s49, 5
    s_add_u32 s70, s70, s49
    s_and_b32 s49, s54, 1
    s_mul_i32 s49, s49, 5
    s_add_u32 s71, s71, s49
    s_and_b32 s11, s11, 0
    s_lshl_b32 s50, s71, 7
    s_lshr_b32 s51, s68, 1
    s_mul_i32 s49, s51, 122880
    s_and_b32 s52, s68, 1
    s_mul_i32 s52, s52, 20480
    s_add_u32 s64, s50, s49
    s_add_u32 s64, s64, s52
    s_mul_i32 s49, s68, 20480
    s_add_u32 s65, s50, s49
    s_mul_i32 s51, s51, 204800
    s_lshr_b32 s52, s52, 1
    s_add_u32 s51, s51, s52
    s_add_u32 s66, s50, s51
    s_add_u32 s66, s66, 81920
    s_lshl_b32 s69, s68, 11
    v_add_u32 v29, s69, v20
    v_add_u32 v29, 23552, v29
    v_add_u32 v30, 0x10000, v29
    s_mov_b32 s24, s4
    s_mov_b32 s25, s5
    s_mov_b32 s26, 2621440
    s_mov_b32 s27, 0x20000
    s_xor_b32 s49, s11, 0
    s_mul_i32 s50, s49, 245760
    s_add_u32 s12, s50, s64
    s_mul_i32 s50, s49, 102400
    s_add_u32 s4, s50, s65
    s_xor_b32 s49, s11, 1
    s_mul_i32 s50, s49, 245760
    s_add_u32 s13, s50, s64
    s_mul_i32 s50, s49, 102400
    s_add_u32 s5, s50, s65
    s_xor_b32 s49, s11, 2
    s_mul_i32 s50, s49, 245760
    s_add_u32 s14, s50, s64
    s_mul_i32 s50, s49, 102400
    s_add_u32 s6, s50, s65
    s_xor_b32 s49, s11, 3
    s_mul_i32 s50, s49, 245760
    s_add_u32 s15, s50, s64
    s_mul_i32 s50, s49, 102400
    s_add_u32 s7, s50, s65
    s_xor_b32 s49, s11, 4
    s_mul_i32 s50, s49, 245760
    s_add_u32 s16, s50, s64
    s_mul_i32 s50, s49, 102400
    s_add_u32 s44, s50, s65
    s_xor_b32 s49, s11, 5
    s_mul_i32 s50, s49, 245760
    s_add_u32 s17, s50, s64
    s_mul_i32 s50, s49, 102400
    s_add_u32 s45, s50, s65
    s_xor_b32 s49, s11, 6
    s_mul_i32 s50, s49, 245760
    s_add_u32 s18, s50, s64
    s_mul_i32 s50, s49, 102400
    s_add_u32 s46, s50, s65
    s_xor_b32 s49, s11, 7
    s_mul_i32 s50, s49, 245760
    s_add_u32 s19, s50, s64
    s_mul_i32 s50, s49, 102400
    s_add_u32 s47, s50, s65
    s_and_b32 s49, s53, 3
    s_and_b32 s50, s53, 1
    s_lshl_b32 s50, s50, 1
    s_cmp_lt_u32 s53, 28
    s_cselect_b32 s49, s49, s50
    s_lshr_b32 s50, s11, 2
    s_xor_b32 s65, s49, s50
    s_mov_b32 s72, s60
    s_mov_b32 s73, s61
    s_mov_b32 s74, 2457600
    s_mov_b32 s75, 0x20000
    s_mul_i32 s62, s48, 15360
    s_mul_i32 s49, s68, 5120
    s_add_u32 s62, s62, s49
    s_add_u32 s62, s62, 9183232
    s_and_b32 s49, s23, 7
    s_add_u32 s49, s49, 12
    s_mul_i32 s50, s49, 122880
    s_add_u32 s60, s62, s50
    s_mul_i32 s63, s49, 122880
    s_mul_i32 s50, s48, 160
    s_add_u32 s63, s63, s50
    s_cmp_lt_u32 s23, 8
    s_cselect_b32 s9, 0x7ff00000, s60
    s_cselect_b32 s8, 0x7ff00000, s63
    s_cselect_b32 s60, s60, 0x7ff00000
    s_cselect_b32 s63, s63, 0x7ff00000
    s_mul_i32 s51, s68, 320
    s_mov_b32 s50, 2185
    v_add_u32 v4, s51, v0
    v_mul_u32_u24 v5, s50, v4
    v_lshrrev_b32 v5, 16, v5
    v_mul_u32_u24 v8, 30, v5
    v_sub_u32 v6, v4, v8
    v_and_b32 v7, 12, v5
    v_add_u32 v7, v7, v5
    v_lshrrev_b32 v8, 4, v5
    v_mad_i32_i24 v7, v8, -12, v7
    v_mul_u32_u24 v7, 3840, v7
    v_mul_u32_u24 v8, 205, v6
    v_lshrrev_b32 v8, 11, v8
    v_mul_u32_u24 v8, 1120, v8
    v_add_u32 v7, v7, v8
    v_lshl_add_u32 v32, v6, 4, v7
    v_add_u32 v4, 64, v4
    v_mul_u32_u24 v5, s50, v4
    v_lshrrev_b32 v5, 16, v5
    v_mul_u32_u24 v8, 30, v5
    v_sub_u32 v6, v4, v8
    v_and_b32 v7, 12, v5
    v_add_u32 v7, v7, v5
    v_lshrrev_b32 v8, 4, v5
    v_mad_i32_i24 v7, v8, -12, v7
    v_mul_u32_u24 v7, 3840, v7
    v_mul_u32_u24 v8, 205, v6
    v_lshrrev_b32 v8, 11, v8
    v_mul_u32_u24 v8, 1120, v8
    v_add_u32 v7, v7, v8
    v_lshl_add_u32 v33, v6, 4, v7
    v_add_u32 v4, 64, v4
    v_mul_u32_u24 v5, s50, v4
    v_lshrrev_b32 v5, 16, v5
    v_mul_u32_u24 v8, 30, v5
    v_sub_u32 v6, v4, v8
    v_and_b32 v7, 12, v5
    v_add_u32 v7, v7, v5
    v_lshrrev_b32 v8, 4, v5
    v_mad_i32_i24 v7, v8, -12, v7
    v_mul_u32_u24 v7, 3840, v7
    v_mul_u32_u24 v8, 205, v6
    v_lshrrev_b32 v8, 11, v8
    v_mul_u32_u24 v8, 1120, v8
    v_add_u32 v7, v7, v8
    v_lshl_add_u32 v34, v6, 4, v7
    v_add_u32 v4, 64, v4
    v_mul_u32_u24 v5, s50, v4
    v_lshrrev_b32 v5, 16, v5
    v_mul_u32_u24 v8, 30, v5
    v_sub_u32 v6, v4, v8
    v_and_b32 v7, 12, v5
    v_add_u32 v7, v7, v5
    v_lshrrev_b32 v8, 4, v5
    v_mad_i32_i24 v7, v8, -12, v7
    v_mul_u32_u24 v7, 3840, v7
    v_mul_u32_u24 v8, 205, v6
    v_lshrrev_b32 v8, 11, v8
    v_mul_u32_u24 v8, 1120, v8
    v_add_u32 v7, v7, v8
    v_lshl_add_u32 v35, v6, 4, v7
    v_add_u32 v4, 64, v4
    v_mul_u32_u24 v5, s50, v4
    v_lshrrev_b32 v5, 16, v5
    v_mul_u32_u24 v8, 30, v5
    v_sub_u32 v6, v4, v8
    v_and_b32 v7, 12, v5
    v_add_u32 v7, v7, v5
    v_lshrrev_b32 v8, 4, v5
    v_mad_i32_i24 v7, v8, -12, v7
    v_mul_u32_u24 v7, 3840, v7
    v_mul_u32_u24 v8, 205, v6
    v_lshrrev_b32 v8, 11, v8
    v_mul_u32_u24 v8, 1120, v8
    v_add_u32 v7, v7, v8
    v_lshl_add_u32 v36, v6, 4, v7
    buffer_load_dwordx4 v[40:43], v32, s[72:75], s63 offen
    buffer_load_dwordx4 v[44:47], v33, s[72:75], s63 offen
    buffer_load_dwordx4 v[48:51], v34, s[72:75], s63 offen
    buffer_load_dwordx4 v[52:55], v35, s[72:75], s8 offen
    buffer_load_dwordx4 v[56:59], v36, s[72:75], s8 offen
    s_waitcnt vmcnt(9)
    s_barrier
    s_xor_b32 s49, s10, 2
    s_mul_i32 s49, s49, 98304
    s_add_u32 m0, s59, 97280
    s_add_u32 s49, s49, s55
    buffer_load_dwordx4 v10, s[28:31], s49 offen offset:0 lds
    buffer_load_dwordx4 v11, s[28:31], s49 offen offset:1024 lds
    buffer_load_dwordx4 v12, s[28:31], s49 offen offset:2048 lds
    buffer_load_dwordx4 v13, s[28:31], s49 offen offset:3072 lds
    s_xor_b32 s49, s10, 3
    s_mul_i32 s49, s49, 98304
    s_add_u32 m0, s59, 109568
    s_add_u32 s49, s49, s55
    buffer_load_dwordx4 v10, s[28:31], s49 offen offset:0 lds
    buffer_load_dwordx4 v11, s[28:31], s49 offen offset:1024 lds
    buffer_load_dwordx4 v12, s[28:31], s49 offen offset:2048 lds
    buffer_load_dwordx4 v13, s[28:31], s49 offen offset:3072 lds
    s_waitcnt vmcnt(8)
    s_barrier
    buffer_store_dwordx4 v[40:43], v20, s[36:39], s60 offen offset:0 sc1
    buffer_store_dwordx4 v[44:47], v20, s[36:39], s60 offen offset:1024 sc1
    buffer_store_dwordx4 v[48:51], v20, s[36:39], s60 offen offset:2048 sc1
    buffer_store_dwordx4 v[52:55], v20, s[36:39], s9 offen offset:3072 sc1
    s_add_u32 s9, s9, 4096
    buffer_store_dwordx4 v[56:59], v20, s[36:39], s9 offen sc1
    s_xor_b32 s49, s10, 4
    s_mul_i32 s49, s49, 98304
    s_add_u32 m0, s59, 121856
    s_add_u32 s49, s49, s55
    buffer_load_dwordx4 v10, s[28:31], s49 offen offset:0 lds
    buffer_load_dwordx4 v11, s[28:31], s49 offen offset:1024 lds
    buffer_load_dwordx4 v12, s[28:31], s49 offen offset:2048 lds
    buffer_load_dwordx4 v13, s[28:31], s49 offen offset:3072 lds
    s_waitcnt vmcnt(13)
    s_barrier
    s_xor_b32 s49, s10, 5
    s_mul_i32 s49, s49, 98304
    s_add_u32 m0, s59, 72704
    s_add_u32 s49, s49, s55
    buffer_load_dwordx4 v10, s[28:31], s49 offen offset:0 lds
    buffer_load_dwordx4 v11, s[28:31], s49 offen offset:1024 lds
    buffer_load_dwordx4 v12, s[28:31], s49 offen offset:2048 lds
    buffer_load_dwordx4 v13, s[28:31], s49 offen offset:3072 lds
    s_waitcnt vmcnt(8)
    s_barrier
    s_xor_b32 s49, s10, 6
    s_mul_i32 s49, s49, 98304
    s_add_u32 m0, s59, 84992
    s_add_u32 s49, s49, s55
    buffer_load_dwordx4 v10, s[28:31], s49 offen offset:0 lds
    buffer_load_dwordx4 v11, s[28:31], s49 offen offset:1024 lds
    buffer_load_dwordx4 v12, s[28:31], s49 offen offset:2048 lds
    buffer_load_dwordx4 v13, s[28:31], s49 offen offset:3072 lds
    s_waitcnt vmcnt(8)
    s_barrier
    s_xor_b32 s49, s10, 7
    s_mul_i32 s49, s49, 98304
    s_add_u32 m0, s59, 97280
    s_add_u32 s49, s49, s55
    buffer_load_dwordx4 v10, s[28:31], s49 offen offset:0 lds
    buffer_load_dwordx4 v11, s[28:31], s49 offen offset:1024 lds
    buffer_load_dwordx4 v12, s[28:31], s49 offen offset:2048 lds
    buffer_load_dwordx4 v13, s[28:31], s49 offen offset:3072 lds
    s_waitcnt vmcnt(8)
    s_barrier
    s_xor_b32 s49, s10, 8
    s_mul_i32 s49, s49, 98304
    s_add_u32 m0, s59, 109568
    s_add_u32 s49, s49, s55
    buffer_load_dwordx4 v10, s[28:31], s49 offen offset:0 lds
    buffer_load_dwordx4 v11, s[28:31], s49 offen offset:1024 lds
    buffer_load_dwordx4 v12, s[28:31], s49 offen offset:2048 lds
    buffer_load_dwordx4 v13, s[28:31], s49 offen offset:3072 lds
    s_waitcnt vmcnt(8)
    s_barrier
    s_xor_b32 s49, s10, 9
    s_mul_i32 s49, s49, 98304
    s_add_u32 m0, s59, 121856
    s_add_u32 s49, s49, s55
    buffer_load_dwordx4 v10, s[28:31], s49 offen offset:0 lds
    buffer_load_dwordx4 v11, s[28:31], s49 offen offset:1024 lds
    buffer_load_dwordx4 v12, s[28:31], s49 offen offset:2048 lds
    buffer_load_dwordx4 v13, s[28:31], s49 offen offset:3072 lds
    s_waitcnt vmcnt(8)
    s_barrier
    s_xor_b32 s49, s10, 10
    s_mul_i32 s49, s49, 98304
    s_add_u32 m0, s59, 72704
    s_add_u32 s49, s49, s55
    buffer_load_dwordx4 v10, s[28:31], s49 offen offset:0 lds
    buffer_load_dwordx4 v11, s[28:31], s49 offen offset:1024 lds
    buffer_load_dwordx4 v12, s[28:31], s49 offen offset:2048 lds
    buffer_load_dwordx4 v13, s[28:31], s49 offen offset:3072 lds
    s_waitcnt vmcnt(8)
    s_barrier
    s_xor_b32 s49, s10, 11
    s_mul_i32 s49, s49, 98304
    s_add_u32 m0, s59, 84992
    s_add_u32 s49, s49, s55
    buffer_load_dwordx4 v10, s[28:31], s49 offen offset:0 lds
    buffer_load_dwordx4 v11, s[28:31], s49 offen offset:1024 lds
    buffer_load_dwordx4 v12, s[28:31], s49 offen offset:2048 lds
    buffer_load_dwordx4 v13, s[28:31], s49 offen offset:3072 lds
    s_waitcnt vmcnt(8)
    s_barrier
    s_xor_b32 s49, s10, 12
    s_mul_i32 s49, s49, 98304
    s_add_u32 m0, s59, 97280
    s_add_u32 s49, s49, s55
    buffer_load_dwordx4 v10, s[28:31], s49 offen offset:0 lds
    buffer_load_dwordx4 v11, s[28:31], s49 offen offset:1024 lds
    buffer_load_dwordx4 v12, s[28:31], s49 offen offset:2048 lds
    buffer_load_dwordx4 v13, s[28:31], s49 offen offset:3072 lds
    s_waitcnt vmcnt(8)
    s_barrier
    s_xor_b32 s49, s10, 13
    s_mul_i32 s49, s49, 98304
    s_add_u32 m0, s59, 109568
    s_add_u32 s49, s49, s55
    buffer_load_dwordx4 v10, s[28:31], s49 offen offset:0 lds
    buffer_load_dwordx4 v11, s[28:31], s49 offen offset:1024 lds
    buffer_load_dwordx4 v12, s[28:31], s49 offen offset:2048 lds
    buffer_load_dwordx4 v13, s[28:31], s49 offen offset:3072 lds
    s_waitcnt vmcnt(8)
    s_barrier
    s_xor_b32 s49, s10, 14
    s_mul_i32 s49, s49, 98304
    s_add_u32 m0, s59, 121856
    s_add_u32 s49, s49, s55
    buffer_load_dwordx4 v10, s[28:31], s49 offen offset:0 lds
    buffer_load_dwordx4 v11, s[28:31], s49 offen offset:1024 lds
    buffer_load_dwordx4 v12, s[28:31], s49 offen offset:2048 lds
    buffer_load_dwordx4 v13, s[28:31], s49 offen offset:3072 lds
    s_waitcnt vmcnt(8)
    s_barrier
    s_xor_b32 s49, s10, 15
    s_mul_i32 s49, s49, 98304
    s_add_u32 m0, s59, 72704
    s_add_u32 s49, s49, s55
    buffer_load_dwordx4 v10, s[28:31], s49 offen offset:0 lds
    buffer_load_dwordx4 v11, s[28:31], s49 offen offset:1024 lds
    buffer_load_dwordx4 v12, s[28:31], s49 offen offset:2048 lds
    buffer_load_dwordx4 v13, s[28:31], s49 offen offset:3072 lds
    s_waitcnt vmcnt(8)
    s_barrier
    s_xor_b32 s49, s56, 16
    s_mul_i32 s49, s49, 98304
    s_add_u32 m0, s59, 84992
    s_add_u32 s49, s49, s55
    buffer_load_dwordx4 v10, s[28:31], s49 offen offset:0 lds
    buffer_load_dwordx4 v11, s[28:31], s49 offen offset:1024 lds
    buffer_load_dwordx4 v12, s[28:31], s49 offen offset:2048 lds
    buffer_load_dwordx4 v13, s[28:31], s49 offen offset:3072 lds
    s_waitcnt vmcnt(8)
    s_barrier
    s_xor_b32 s49, s56, 17
    s_mul_i32 s49, s49, 98304
    s_add_u32 m0, s59, 97280
    s_add_u32 s49, s49, s55
    buffer_load_dwordx4 v10, s[28:31], s49 offen offset:0 lds
    buffer_load_dwordx4 v11, s[28:31], s49 offen offset:1024 lds
    buffer_load_dwordx4 v12, s[28:31], s49 offen offset:2048 lds
    buffer_load_dwordx4 v13, s[28:31], s49 offen offset:3072 lds
    s_waitcnt vmcnt(8)
    s_barrier
    s_xor_b32 s49, s56, 18
    s_mul_i32 s49, s49, 98304
    s_add_u32 m0, s59, 109568
    s_add_u32 s49, s49, s55
    buffer_load_dwordx4 v10, s[28:31], s49 offen offset:0 lds
    buffer_load_dwordx4 v11, s[28:31], s49 offen offset:1024 lds
    buffer_load_dwordx4 v12, s[28:31], s49 offen offset:2048 lds
    buffer_load_dwordx4 v13, s[28:31], s49 offen offset:3072 lds
    s_waitcnt vmcnt(8)
    s_barrier
    s_xor_b32 s49, s56, 19
    s_mul_i32 s49, s49, 98304
    s_add_u32 m0, s59, 121856
    s_add_u32 s49, s49, s55
    buffer_load_dwordx4 v10, s[28:31], s49 offen offset:0 lds
    buffer_load_dwordx4 v11, s[28:31], s49 offen offset:1024 lds
    buffer_load_dwordx4 v12, s[28:31], s49 offen offset:2048 lds
    buffer_load_dwordx4 v13, s[28:31], s49 offen offset:3072 lds
    s_add_u32 s49, s12, 81920
    buffer_load_dwordx4 v[64:67], v26, s[40:43], s49 offen
    buffer_load_dwordx4 v[68:71], v27, s[40:43], s49 offen offset:1024
    s_add_u32 s49, s13, 81920
    buffer_load_dwordx4 v[72:75], v26, s[40:43], s49 offen
    buffer_load_dwordx4 v[76:79], v27, s[40:43], s49 offen offset:1024
    s_waitcnt vmcnt(12)
    s_barrier
    s_add_u32 s49, s15, 81920
    buffer_load_dwordx4 v[80:83], v26, s[40:43], s49 offen
    buffer_load_dwordx4 v[84:87], v27, s[40:43], s49 offen offset:1024
    s_add_u32 s49, s16, 81920
    buffer_load_dwordx4 v[88:91], v26, s[40:43], s49 offen
    buffer_load_dwordx4 v[92:95], v27, s[40:43], s49 offen offset:1024
    s_add_u32 s49, s17, 81920
    buffer_load_dwordx4 v[96:99], v26, s[40:43], s49 offen
    buffer_load_dwordx4 v[100:103], v27, s[40:43], s49 offen offset:1024
    s_waitcnt vmcnt(14)
    s_barrier
    s_add_u32 s49, s19, 81920
    buffer_load_dwordx4 v[104:107], v26, s[40:43], s49 offen
    buffer_load_dwordx4 v[108:111], v27, s[40:43], s49 offen offset:1024
    buffer_load_dwordx4 v[112:115], v26, s[32:35], s4 offen
    buffer_load_dwordx4 v[116:119], v27, s[32:35], s4 offen offset:1024
    buffer_load_dwordx4 v[120:123], v26, s[32:35], s5 offen
    buffer_load_dwordx4 v[124:127], v27, s[32:35], s5 offen offset:1024
    s_waitcnt vmcnt(16)
    s_barrier
    buffer_load_dwordx4 v[128:131], v26, s[32:35], s7 offen
    buffer_load_dwordx4 v[132:135], v27, s[32:35], s7 offen offset:1024
    buffer_load_dwordx4 v[136:139], v26, s[32:35], s44 offen
    buffer_load_dwordx4 v[140:143], v27, s[32:35], s44 offen offset:1024
    buffer_load_dwordx4 v[144:147], v26, s[32:35], s45 offen
    buffer_load_dwordx4 v[148:151], v27, s[32:35], s45 offen offset:1024
    s_barrier
    buffer_load_dwordx4 v[152:155], v26, s[32:35], s47 offen
    buffer_load_dwordx4 v[156:159], v27, s[32:35], s47 offen offset:1024
    s_add_u32 s49, s66, 0
    buffer_load_dwordx4 v[160:163], v26, s[32:35], s49 offen
    s_add_u32 s49, s49, 92160
    buffer_load_dwordx4 v[164:167], v27, s[32:35], s49 offen offset:1024
LFL_tail:
    s_mov_b32 s57, 8921088
    s_mov_b32 s62, 0
    s_mov_b32 s63, -1
    s_add_u32 s51, s70, s68
    s_mul_i32 s51, s51, 20480
    s_lshl_b32 s52, s71, 7
    s_add_u32 s51, s51, s52
    s_barrier
    s_add_u32 m0, s69, 3072
    s_nop 0
    buffer_load_dwordx4 v26, s[24:27], s51 offen lds
    buffer_load_dwordx4 v27, s[24:27], s51 offen offset:1024 lds
    s_cmp_ge_u32 s68, 2
    s_cbranch_scc1 LFL_x2
    s_add_u32 s51, s51, 81920
    s_add_u32 m0, s69, 11264
    s_nop 0
    buffer_load_dwordx4 v26, s[24:27], s51 offen lds
    buffer_load_dwordx4 v27, s[24:27], s51 offen offset:1024 lds
LFL_x2:
    s_add_u32 m0, s69, 23552
    s_nop 0
    buffer_load_dwordx4 v26, s[40:43], s12 offen lds
    buffer_load_dwordx4 v27, s[40:43], s12 offen offset:1024 lds
    s_add_u32 m0, s69, 31744
    s_nop 0
    buffer_load_dwordx4 v26, s[40:43], s13 offen lds
    buffer_load_dwordx4 v27, s[40:43], s13 offen offset:1024 lds
    s_add_u32 m0, s69, 39936
    s_nop 0
    buffer_load_dwordx4 v26, s[40:43], s14 offen lds
    buffer_load_dwordx4 v27, s[40:43], s14 offen offset:1024 lds
    s_add_u32 m0, s69, 48128
    s_nop 0
    buffer_load_dwordx4 v26, s[40:43], s15 offen lds
    buffer_load_dwordx4 v27, s[40:43], s15 offen offset:1024 lds
    s_waitcnt vmcnt(6)
    s_add_u32 m0, s69, 56320
    s_nop 0
    buffer_load_dwordx4 v26, s[40:43], s16 offen lds
    buffer_load_dwordx4 v27, s[40:43], s16 offen offset:1024 lds
    s_waitcnt vmcnt(6)
    s_add_u32 m0, s69, 64512
    s_nop 0
    buffer_load_dwordx4 v26, s[40:43], s17 offen lds
    buffer_load_dwordx4 v27, s[40:43], s17 offen offset:1024 lds
    s_waitcnt vmcnt(6)
    s_add_u32 m0, s69, 72704
    s_nop 0
    buffer_load_dwordx4 v26, s[40:43], s18 offen lds
    buffer_load_dwordx4 v27, s[40:43], s18 offen offset:1024 lds
    s_waitcnt vmcnt(3)
    s_add_u32 m0, s69, 80896
    s_nop 0
    buffer_load_dwordx4 v26, s[40:43], s19 offen lds
    buffer_load_dwordx4 v27, s[40:43], s19 offen offset:1024 lds
    s_waitcnt vmcnt(3)
    s_add_u32 m0, s69, 89088
    s_add_u32 s49, s12, 40960
    buffer_load_dwordx4 v26, s[40:43], s49 offen lds
    buffer_load_dwordx4 v27, s[40:43], s49 offen offset:1024 lds
    s_waitcnt vmcnt(3)
    s_add_u32 m0, s69, 97280
    s_add_u32 s49, s13, 40960
    buffer_load_dwordx4 v26, s[40:43], s49 offen lds
    buffer_load_dwordx4 v27, s[40:43], s49 offen offset:1024 lds
    s_waitcnt vmcnt(3)
    s_add_u32 m0, s69, 105472
    s_add_u32 s49, s14, 40960
    buffer_load_dwordx4 v26, s[40:43], s49 offen lds
    buffer_load_dwordx4 v27, s[40:43], s49 offen offset:1024 lds
    s_waitcnt vmcnt(3)
    s_add_u32 m0, s69, 113664
    s_add_u32 s49, s15, 40960
    buffer_load_dwordx4 v26, s[40:43], s49 offen lds
    buffer_load_dwordx4 v27, s[40:43], s49 offen offset:1024 lds
    s_waitcnt vmcnt(3)
    s_add_u32 m0, s69, 121856
    s_add_u32 s49, s16, 40960
    buffer_load_dwordx4 v26, s[40:43], s49 offen lds
    buffer_load_dwordx4 v27, s[40:43], s49 offen offset:1024 lds
    s_waitcnt vmcnt(3)
    s_add_u32 m0, s69, 130048
    s_add_u32 s49, s17, 40960
    buffer_load_dwordx4 v26, s[40:43], s49 offen lds
    buffer_load_dwordx4 v27, s[40:43], s49 offen offset:1024 lds
    s_waitcnt vmcnt(3)
    s_add_u32 m0, s69, 138240
    s_add_u32 s49, s18, 40960
    buffer_load_dwordx4 v26, s[40:43], s49 offen lds
    buffer_load_dwordx4 v27, s[40:43], s49 offen offset:1024 lds
    s_waitcnt vmcnt(3)
    s_add_u32 m0, s69, 146432
    s_add_u32 s49, s19, 40960
    buffer_load_dwordx4 v26, s[40:43], s49 offen lds
    buffer_load_dwordx4 v27, s[40:43], s49 offen offset:1024 lds
    s_waitcnt vmcnt(3)
    s_add_u32 s49, s66, 409600
    buffer_load_dwordx4 v[168:171], v26, s[32:35], s49 offen
    s_add_u32 s49, s49, 92160
    buffer_load_dwordx4 v[172:175], v27, s[32:35], s49 offen offset:1024
    s_waitcnt vmcnt(3)
    s_cmp_lg_u32 s68, 3
    s_cbranch_scc1 LFL_hx
    v_mov_b32 v1, 0
    s_mov_b32 s67, 262144
LFL_h:
    ds_read_b32 v2, v1 offset:3016
    s_waitcnt lgkmcnt(0)
    v_readfirstlane_b32 s49, v2
    s_nop 0
    s_cmp_ge_u32 s49, 4
    s_cbranch_scc1 LFL_hx
    s_sleep 2
    s_sub_u32 s67, s67, 1
    s_cmp_lg_u32 s67, 0
    s_cbranch_scc1 LFL_h
LFL_hx:
    s_cmp_lg_u32 s68, 3
    s_cbranch_scc1 LFL_pi0
    s_and_b32 s49, s63, 0xffff
    s_cbranch_scc0 LFL_pi0
    s_mov_b32 exec_hi, s49
    s_mov_b32 exec_lo, 0
    buffer_load_dword v24, v28, s[36:39], s57 offen sc1
    s_mov_b64 exec, -1
LFL_pi0:
    s_cmp_lg_u32 s68, 3
    s_cbranch_scc1 LFL_ok0
    s_and_b32 s49, s63, 0xffff
    s_cbranch_scc0 LFL_ok0
    s_mov_b32 s67, 262144
    s_waitcnt vmcnt(0)
LFL_sp0:
    v_cmp_ne_u32 vcc, s58, v24
    s_nop 0
    s_and_b64 s[62:63], s[62:63], vcc
    s_and_b32 s49, s63, 0xffff
    s_cbranch_scc0 LFL_ok0
    s_sleep 2
    s_mov_b32 exec_hi, s49
    s_mov_b32 exec_lo, 0
    buffer_load_dword v24, v28, s[36:39], s57 offen sc1
    s_mov_b64 exec, -1
    s_sub_u32 s67, s67, 1
    s_cmp_lg_u32 s67, 0
    s_waitcnt vmcnt(0)
    s_cbranch_scc1 LFL_sp0
LFL_ok0:
    s_waitcnt vmcnt(0) lgkmcnt(0)
    s_barrier
    s_cmp_lg_u32 s68, 3
    s_cbranch_scc1 LFL_pi1
    s_and_b32 s49, s63, 0xffff
    s_cbranch_scc0 LFL_pi1
    s_mov_b32 exec_hi, s49
    s_mov_b32 exec_lo, 0
    buffer_load_dword v24, v28, s[36:39], s57 offen sc1
    s_mov_b64 exec, -1
LFL_pi1:
    s_cmp_lg_u32 s68, 3
    s_cbranch_scc1 LFL_ok1
    s_and_b32 s49, s63, 0xffff
    s_cbranch_scc0 LFL_ok1
    s_mov_b32 s67, 262144
    s_waitcnt vmcnt(0)
LFL_sp1:
    v_cmp_ne_u32 vcc, s58, v24
    s_nop 0
    s_and_b64 s[62:63], s[62:63], vcc
    s_and_b32 s49, s63, 0xffff
    s_cbranch_scc0 LFL_ok1
    s_sleep 2
    s_mov_b32 exec_hi, s49
    s_mov_b32 exec_lo, 0
    buffer_load_dword v24, v28, s[36:39], s57 offen sc1
    s_mov_b64 exec, -1
    s_sub_u32 s67, s67, 1
    s_cmp_lg_u32 s67, 0
    s_waitcnt vmcnt(0)
    s_cbranch_scc1 LFL_sp1
LFL_ok1:
    s_waitcnt vmcnt(0)
    s_barrier
    s_add_u32 m0, s69, 39936
    s_add_u32 s49, s14, 81920
    buffer_load_dwordx4 v26, s[40:43], s49 offen lds
    buffer_load_dwordx4 v27, s[40:43], s49 offen offset:1024 lds
    ds_write_b128 v29, v[64:67] offset:0
    ds_write_b128 v29, v[68:71] offset:1024
    ds_write_b128 v29, v[72:75] offset:8192
    ds_write_b128 v29, v[76:79] offset:9216
    s_waitcnt lgkmcnt(0)
    s_barrier
    s_cmp_lg_u32 s68, 3
    s_cbranch_scc1 LFL_pi2
    s_and_b32 s49, s63, 0xffff
    s_cbranch_scc0 LFL_pi2
    s_mov_b32 exec_hi, s49
    s_mov_b32 exec_lo, 0
    buffer_load_dword v24, v28, s[36:39], s57 offen sc1
    s_mov_b64 exec, -1
LFL_pi2:
    s_add_u32 m0, s69, 72704
    s_add_u32 s49, s18, 81920
    buffer_load_dwordx4 v26, s[40:43], s49 offen lds
    buffer_load_dwordx4 v27, s[40:43], s49 offen offset:1024 lds
    ds_write_b128 v29, v[80:83] offset:24576
    ds_write_b128 v29, v[84:87] offset:25600
    ds_write_b128 v29, v[88:91] offset:32768
    ds_write_b128 v29, v[92:95] offset:33792
    ds_write_b128 v29, v[96:99] offset:40960
    ds_write_b128 v29, v[100:103] offset:41984
    s_cmp_lg_u32 s68, 3
    s_cbranch_scc1 LFL_ok2
    s_and_b32 s49, s63, 0xffff
    s_cbranch_scc0 LFL_ok2
    s_mov_b32 s67, 262144
    s_waitcnt vmcnt(2)
LFL_sp2:
    v_cmp_ne_u32 vcc, s58, v24
    s_nop 0
    s_and_b64 s[62:63], s[62:63], vcc
    s_and_b32 s49, s63, 0xffff
    s_cbranch_scc0 LFL_ok2
    s_sleep 2
    s_mov_b32 exec_hi, s49
    s_mov_b32 exec_lo, 0
    buffer_load_dword v24, v28, s[36:39], s57 offen sc1
    s_mov_b64 exec, -1
    s_sub_u32 s67, s67, 1
    s_cmp_lg_u32 s67, 0
    s_waitcnt vmcnt(0)
    s_cbranch_scc1 LFL_sp2
LFL_ok2:
    s_waitcnt vmcnt(2) lgkmcnt(0)
    s_barrier
    s_add_u32 m0, s69, 105472
    s_nop 0
    buffer_load_dwordx4 v26, s[32:35], s6 offen lds
    buffer_load_dwordx4 v27, s[32:35], s6 offen offset:1024 lds
    ds_write_b128 v29, v[104:107] offset:57344
    ds_write_b128 v29, v[108:111] offset:58368
    ds_write_b128 v30, v[112:115] offset:0
    ds_write_b128 v30, v[116:119] offset:1024
    s_waitcnt vmcnt(2) lgkmcnt(0)
    s_barrier
    s_cmp_lg_u32 s68, 3
    s_cbranch_scc1 LFL_pi3
    s_and_b32 s49, s63, 0xffff0000
    s_cbranch_scc0 LFL_pi3
    s_mov_b32 exec_hi, s49
    s_mov_b32 exec_lo, 0
    buffer_load_dword v24, v28, s[36:39], s57 offen sc1
    s_mov_b64 exec, -1
LFL_pi3:
    s_add_u32 m0, s69, 138240
    s_nop 0
    buffer_load_dwordx4 v26, s[32:35], s46 offen lds
    buffer_load_dwordx4 v27, s[32:35], s46 offen offset:1024 lds
    ds_write_b128 v30, v[120:123] offset:8192
    ds_write_b128 v30, v[124:127] offset:9216
    ds_write_b128 v30, v[128:131] offset:24576
    ds_write_b128 v30, v[132:135] offset:25600
    s_cmp_lg_u32 s68, 3
    s_cbranch_scc1 LFL_ok3
    s_and_b32 s49, s63, 0xffff0000
    s_cbranch_scc0 LFL_ok3
    s_mov_b32 s67, 262144
    s_waitcnt vmcnt(2)
LFL_sp3:
    v_cmp_ne_u32 vcc, s58, v24
    s_nop 0
    s_and_b64 s[62:63], s[62:63], vcc
    s_and_b32 s49, s63, 0xffff0000
    s_cbranch_scc0 LFL_ok3
    s_sleep 2
    s_mov_b32 exec_hi, s49
    s_mov_b32 exec_lo, 0
    buffer_load_dword v24, v28, s[36:39], s57 offen sc1
    s_mov_b64 exec, -1
    s_sub_u32 s67, s67, 1
    s_cmp_lg_u32 s67, 0
    s_waitcnt vmcnt(0)
    s_cbranch_scc1 LFL_sp3
LFL_ok3:
    s_waitcnt vmcnt(2) lgkmcnt(0)
    s_barrier
    ds_write_b128 v30, v[136:139] offset:32768
    ds_write_b128 v30, v[140:143] offset:33792
    ds_write_b128 v30, v[144:147] offset:40960
    ds_write_b128 v30, v[148:151] offset:41984
    s_waitcnt vmcnt(0) lgkmcnt(0)
    s_barrier
    ds_write_b128 v30, v[152:155] offset:57344
    ds_write_b128 v30, v[156:159] offset:58368
    s_waitcnt lgkmcnt(0)
    s_barrier
    ds_write_b128 v29, v[160:163] offset:0
    ds_write_b128 v29, v[164:167] offset:1024
    ds_write_b128 v29, v[168:171] offset:8192
    ds_write_b128 v29, v[172:175] offset:9216
    s_waitcnt lgkmcnt(0)
    s_barrier
    s_endpgm
LFL_X:
    v_xor_b32 v4, v2, v3
    v_lshl_add_u32 v10, v4, 4, v1
    v_xor_b32 v11, 64, v10
    v_add_u32 v12, 18432, v10
    v_add_u32 v13, 27648, v11
    v_add_u32 v11, 9216, v11
    s_mul_i32 s55, s23, 163840
    s_lshr_b32 s59, s10, 1
    s_lshl_b32 s59, s59, 7
    s_and_b32 s60, s59, 128
    s_waitcnt lgkmcnt(0)
    s_mov_b32 s24, s4
    s_mov_b32 s25, s5
    s_mov_b32 s26, 2621440
    s_mov_b32 s27, 0x20000
    s_xor_b32 s50, s59, 0
    s_add_u32 s61, s55, s50
    s_mov_b32 m0, 56320
    s_add_u32 s49, s61, 0
    buffer_load_dwordx4 v10, s[24:27], s49 offen offset:0 lds
    buffer_load_dwordx4 v11, s[24:27], s49 offen offset:1024 lds
    buffer_load_dwordx4 v12, s[24:27], s49 offen offset:2048 lds
    buffer_load_dwordx4 v13, s[24:27], s49 offen offset:3072 lds
    s_mov_b32 m0, 60416
    s_add_u32 s49, s61, 40960
    buffer_load_dwordx4 v10, s[24:27], s49 offen offset:0 lds
    buffer_load_dwordx4 v11, s[24:27], s49 offen offset:1024 lds
    buffer_load_dwordx4 v12, s[24:27], s49 offen offset:2048 lds
    buffer_load_dwordx4 v13, s[24:27], s49 offen offset:3072 lds
    s_mov_b32 m0, 64512
    s_add_u32 s49, s61, 81920
    buffer_load_dwordx4 v10, s[24:27], s49 offen offset:0 lds
    buffer_load_dwordx4 v11, s[24:27], s49 offen offset:1024 lds
    buffer_load_dwordx4 v12, s[24:27], s49 offen offset:2048 lds
    buffer_load_dwordx4 v13, s[24:27], s49 offen offset:3072 lds
    s_mov_b32 m0, 68608
    s_add_u32 s49, s61, 122880
    buffer_load_dwordx4 v10, s[24:27], s49 offen offset:0 lds
    buffer_load_dwordx4 v11, s[24:27], s49 offen offset:1024 lds
    buffer_load_dwordx4 v12, s[24:27], s49 offen offset:2048 lds
    buffer_load_dwordx4 v13, s[24:27], s49 offen offset:3072 lds
    v_lshlrev_b32 v2, 1, v2
    v_xor_b32 v2, v2, v3
    v_lshl_add_u32 v26, v2, 4, v1
    v_add_u32 v27, 9216, v26
    v_lshlrev_b32 v20, 4, v0
    v_lshlrev_b32 v21, 2, v0
    v_mov_b32 v28, 0
    v_mov_b32 v24, 0
    s_mov_b32 s58, 0
    s_mov_b32 s36, s20
    s_mov_b32 s37, s21
    s_mov_b32 s38, 11640832
    s_mov_b32 s39, 0x20000
    s_mov_b32 s40, s14
    s_mov_b32 s41, s15
    s_mov_b32 s42, 1966080
    s_mov_b32 s43, 0x20000
    s_mov_b32 s32, s8
    s_mov_b32 s33, s9
    s_mov_b32 s34, 819200
    s_mov_b32 s35, 0x20000
    s_mov_b32 s72, s18
    s_mov_b32 s73, s19
    s_mov_b32 s74, 256
    s_mov_b32 s75, 0x20000
    s_sub_u32 s49, s53, 16
    s_lshr_b32 s50, s49, 2
    s_and_b32 s51, s49, 3
    s_sub_u32 s52, s49, 6
    s_lshr_b32 s52, s52, 1
    s_and_b32 s70, s49, 1
    s_cmp_lt_u32 s49, 12
    s_cselect_b32 s71, s50, s52
    s_cselect_b32 s70, s51, s70
    s_mul_i32 s70, s70, 6
    s_and_b32 s50, s53, 3
    s_and_b32 s51, s53, 1
    s_lshl_b32 s51, s51, 1
    s_cmp_lt_u32 s53, 28
    s_cselect_b32 s50, s50, s51
    s_lshl_b32 s50, s50, 1
    s_mul_i32 s11, s71, 3
    s_add_u32 s11, s11, s50
    s_lshr_b32 s49, s54, 1
    s_lshl_b32 s49, s49, 5
    s_add_u32 s70, s70, s49
    s_and_b32 s49, s54, 1
    s_mul_i32 s49, s49, 5
    s_add_u32 s71, s71, s49
    s_and_b32 s11, s11, 0
    s_lshl_b32 s50, s71, 7
    s_lshr_b32 s51, s68, 1
    s_mul_i32 s49, s51, 122880
    s_and_b32 s52, s68, 1
    s_mul_i32 s52, s52, 20480
    s_add_u32 s64, s50, s49
    s_add_u32 s64, s64, s52
    s_mul_i32 s49, s68, 20480
    s_add_u32 s65, s50, s49
    s_mul_i32 s51, s51, 204800
    s_lshr_b32 s52, s52, 1
    s_add_u32 s51, s51, s52
    s_add_u32 s66, s50, s51
    s_add_u32 s66, s66, 81920
    s_lshl_b32 s69, s68, 11
    v_add_u32 v29, s69, v20
    v_add_u32 v29, 23552, v29
    v_add_u32 v30, 0x10000, v29
    s_mov_b32 s24, s4
    s_mov_b32 s25, s5
    s_mov_b32 s26, 2621440
    s_mov_b32 s27, 0x20000
    s_xor_b32 s49, s11, 0
    s_mul_i32 s50, s49, 245760
    s_add_u32 s12, s50, s64
    s_mul_i32 s50, s49, 102400
    s_add_u32 s4, s50, s65
    s_xor_b32 s49, s11, 1
    s_mul_i32 s50, s49, 245760
    s_add_u32 s13, s50, s64
    s_mul_i32 s50, s49, 102400
    s_add_u32 s5, s50, s65
    s_xor_b32 s49, s11, 2
    s_mul_i32 s50, s49, 245760
    s_add_u32 s14, s50, s64
    s_mul_i32 s50, s49, 102400
    s_add_u32 s6, s50, s65
    s_xor_b32 s49, s11, 3
    s_mul_i32 s50, s49, 245760
    s_add_u32 s15, s50, s64
    s_mul_i32 s50, s49, 102400
    s_add_u32 s7, s50, s65
    s_xor_b32 s49, s11, 4
    s_mul_i32 s50, s49, 245760
    s_add_u32 s16, s50, s64
    s_mul_i32 s50, s49, 102400
    s_add_u32 s44, s50, s65
    s_xor_b32 s49, s11, 5
    s_mul_i32 s50, s49, 245760
    s_add_u32 s17, s50, s64
    s_mul_i32 s50, s49, 102400
    s_add_u32 s45, s50, s65
    s_xor_b32 s49, s11, 6
    s_mul_i32 s50, s49, 245760
    s_add_u32 s18, s50, s64
    s_mul_i32 s50, s49, 102400
    s_add_u32 s46, s50, s65
    s_xor_b32 s49, s11, 7
    s_mul_i32 s50, s49, 245760
    s_add_u32 s19, s50, s64
    s_mul_i32 s50, s49, 102400
    s_add_u32 s47, s50, s65
    s_and_b32 s49, s53, 3
    s_and_b32 s50, s53, 1
    s_lshl_b32 s50, s50, 1
    s_cmp_lt_u32 s53, 28
    s_cselect_b32 s49, s49, s50
    s_lshr_b32 s50, s11, 2
    s_xor_b32 s65, s49, s50
    v_mov_b32 v4, 0
    v_and_b32 v5, 12, v21
    ds_write_b32 v5, v4 offset:3008
    s_lshl_b32 s50, s23, 14
    s_lshl_b32 s51, s3, 10
    s_add_u32 s50, s50, s51
    s_add_u32 s50, s50, 8921088
    v_lshlrev_b32 v3, 3, v0
    v_add_u32 v8, s50, v3
    v_add_u32 v8, 768, v8
    v_and_b32 v9, 28, v21
    v_subrev_u32 v3, 384, v8
    v_cmp_gt_u32 vcc, 16, v0
    s_nop 1
    v_cndmask_b32 v8, v3, v8, vcc
    s_lshr_b32 s49, s70, 3
    s_add_u32 s50, s70, 5
    s_lshr_b32 s50, s50, 3
    s_lshl_b32 s49, s49, 14
    s_lshl_b32 s50, s50, 14
    v_and_b32 v4, 8, v0
    v_cmp_eq_u32 vcc, 0, v4
    v_mov_b32 v3, s49
    v_mov_b32 v4, s50
    v_cndmask_b32 v3, v4, v3, vcc
    v_and_b32 v4, 7, v0
    v_lshl_add_u32 v3, v4, 10, v3
    v_lshrrev_b32 v4, 4, v0
    v_lshlrev_b32 v4, 8, v4
    v_add_u32 v4, 8192, v4
    v_cmp_gt_u32 vcc, 48, v0
    s_nop 1
    v_cndmask_b32 v4, 0, v4, vcc
    v_add_u32 v28, v3, v4
    s_lshl_b32 s49, s23, 7
    v_add_u32 v14, s49, v0
    v_add_u32 v15, 64, v14
    v_and_b32 v3, 7, v14
    v_lshrrev_b32 v14, 3, v14
    v_lshlrev_b32 v14, 10, v14
    v_lshl_add_u32 v14, v3, 3, v14
    v_and_b32 v3, 7, v15
    v_lshrrev_b32 v15, 3, v15
    v_lshlrev_b32 v15, 10, v15
    v_lshl_add_u32 v15, v3, 3, v15
    s_xor_b32 s50, s59, 128
    s_add_u32 s61, s55, s50
    s_mov_b32 m0, 23552
    s_add_u32 s49, s61, 0
    buffer_load_dwordx4 v10, s[24:27], s49 offen offset:0 lds
    buffer_load_dwordx4 v11, s[24:27], s49 offen offset:1024 lds
    buffer_load_dwordx4 v12, s[24:27], s49 offen offset:2048 lds
    buffer_load_dwordx4 v13, s[24:27], s49 offen offset:3072 lds
    s_mov_b32 m0, 27648
    s_add_u32 s49, s61, 40960
    buffer_load_dwordx4 v10, s[24:27], s49 offen offset:0 lds
    buffer_load_dwordx4 v11, s[24:27], s49 offen offset:1024 lds
    buffer_load_dwordx4 v12, s[24:27], s49 offen offset:2048 lds
    buffer_load_dwordx4 v13, s[24:27], s49 offen offset:3072 lds
    s_waitcnt vmcnt(8) lgkmcnt(0)
    s_barrier
    v_mov_b32 v6, 0
    buffer_load_dword v5, v6, s[72:75], 0 offen sc1
    s_mov_b32 m0, 31744
    s_add_u32 s49, s61, 81920
    buffer_load_dwordx4 v10, s[24:27], s49 offen offset:0 lds
    buffer_load_dwordx4 v11, s[24:27], s49 offen offset:1024 lds
    buffer_load_dwordx4 v12, s[24:27], s49 offen offset:2048 lds
    buffer_load_dwordx4 v13, s[24:27], s49 offen offset:3072 lds
    s_mov_b32 m0, 35840
    s_add_u32 s49, s61, 122880
    buffer_load_dwordx4 v10, s[24:27], s49 offen offset:0 lds
    buffer_load_dwordx4 v11, s[24:27], s49 offen offset:1024 lds
    buffer_load_dwordx4 v12, s[24:27], s49 offen offset:2048 lds
    buffer_load_dwordx4 v13, s[24:27], s49 offen offset:3072 lds
    s_xor_b32 s50, s59, 256
    s_add_u32 s61, s55, s50
    s_mov_b32 m0, 39936
    s_add_u32 s49, s61, 0
    buffer_load_dwordx4 v10, s[24:27], s49 offen offset:0 lds
    buffer_load_dwordx4 v11, s[24:27], s49 offen offset:1024 lds
    buffer_load_dwordx4 v12, s[24:27], s49 offen offset:2048 lds
    buffer_load_dwordx4 v13, s[24:27], s49 offen offset:3072 lds
    s_mov_b32 m0, 44032
    s_add_u32 s49, s61, 40960
    buffer_load_dwordx4 v10, s[24:27], s49 offen offset:0 lds
    buffer_load_dwordx4 v11, s[24:27], s49 offen offset:1024 lds
    buffer_load_dwordx4 v12, s[24:27], s49 offen offset:2048 lds
    buffer_load_dwordx4 v13, s[24:27], s49 offen offset:3072 lds
    s_barrier
    s_mov_b32 m0, 48128
    s_add_u32 s49, s61, 81920
    buffer_load_dwordx4 v10, s[24:27], s49 offen offset:0 lds
    buffer_load_dwordx4 v11, s[24:27], s49 offen offset:1024 lds
    buffer_load_dwordx4 v12, s[24:27], s49 offen offset:2048 lds
    buffer_load_dwordx4 v13, s[24:27], s49 offen offset:3072 lds
    s_mov_b32 m0, 52224
    s_add_u32 s49, s61, 122880
    buffer_load_dwordx4 v10, s[24:27], s49 offen offset:0 lds
    buffer_load_dwordx4 v11, s[24:27], s49 offen offset:1024 lds
    buffer_load_dwordx4 v12, s[24:27], s49 offen offset:2048 lds
    buffer_load_dwordx4 v13, s[24:27], s49 offen offset:3072 lds
    s_waitcnt vmcnt(16)
    s_barrier
    ds_read_b32 v4, v9 offset:2944
    s_mov_b32 s67, 262144
LFL_nc:
    v_readfirstlane_b32 s58, v5
    s_nop 0
    s_cmp_lg_u32 s58, 0
    s_cbranch_scc1 LFL_nd
    s_sleep 4
    buffer_load_dword v5, v6, s[72:75], 0 offen sc1
    s_sub_u32 s67, s67, 1
    s_cmp_lg_u32 s67, 0
    s_waitcnt vmcnt(0)
    s_cbranch_scc1 LFL_nc
LFL_nd:
    ds_write_b32 v6, v5 offset:3040
    s_waitcnt lgkmcnt(0)
    s_mov_b32 exec_lo, 0xffff0000
    v_mov_b32 v4, 0
    v_mov_b32 v5, 0
    s_mov_b32 exec_lo, -1
    s_mov_b32 exec_hi, 0
    buffer_store_dwordx2 v[4:5], v8, s[36:39], 0 offen sc1
    s_mov_b64 exec, -1
    s_xor_b32 s50, s59, 384
    s_add_u32 s61, s55, s50
    s_mov_b32 m0, 56320
    s_add_u32 s49, s61, 0
    buffer_load_dwordx4 v10, s[24:27], s49 offen offset:0 lds
    buffer_load_dwordx4 v11, s[24:27], s49 offen offset:1024 lds
    buffer_load_dwordx4 v12, s[24:27], s49 offen offset:2048 lds
    buffer_load_dwordx4 v13, s[24:27], s49 offen offset:3072 lds
    s_mov_b32 m0, 60416
    s_add_u32 s49, s61, 40960
    buffer_load_dwordx4 v10, s[24:27], s49 offen offset:0 lds
    buffer_load_dwordx4 v11, s[24:27], s49 offen offset:1024 lds
    buffer_load_dwordx4 v12, s[24:27], s49 offen offset:2048 lds
    buffer_load_dwordx4 v13, s[24:27], s49 offen offset:3072 lds
    s_barrier
    v_mov_b32 v4, s58
    v_mov_b32 v5, s58
    v_subrev_u32 v7, 512, v8
    s_mov_b64 exec, 0xffff
    buffer_store_dwordx2 v[4:5], v7, s[36:39], 0 offen sc1
    s_mov_b64 exec, -1
    s_mov_b32 m0, 64512
    s_add_u32 s49, s61, 81920
    buffer_load_dwordx4 v10, s[24:27], s49 offen offset:0 lds
    buffer_load_dwordx4 v11, s[24:27], s49 offen offset:1024 lds
    buffer_load_dwordx4 v12, s[24:27], s49 offen offset:2048 lds
    buffer_load_dwordx4 v13, s[24:27], s49 offen offset:3072 lds
    s_mov_b32 m0, 68608
    s_add_u32 s49, s61, 122880
    buffer_load_dwordx4 v10, s[24:27], s49 offen offset:0 lds
    buffer_load_dwordx4 v11, s[24:27], s49 offen offset:1024 lds
    buffer_load_dwordx4 v12, s[24:27], s49 offen offset:2048 lds
    buffer_load_dwordx4 v13, s[24:27], s49 offen offset:3072 lds
    s_waitcnt vmcnt(18)
    s_barrier
    s_xor_b32 s50, s59, 512
    s_add_u32 s61, s55, s50
    s_mov_b32 m0, 23552
    s_add_u32 s49, s61, 0
    buffer_load_dwordx4 v10, s[24:27], s49 offen offset:0 lds
    buffer_load_dwordx4 v11, s[24:27], s49 offen offset:1024 lds
    buffer_load_dwordx4 v12, s[24:27], s49 offen offset:2048 lds
    buffer_load_dwordx4 v13, s[24:27], s49 offen offset:3072 lds
    s_mov_b32 m0, 27648
    s_add_u32 s49, s61, 40960
    buffer_load_dwordx4 v10, s[24:27], s49 offen offset:0 lds
    buffer_load_dwordx4 v11, s[24:27], s49 offen offset:1024 lds
    buffer_load_dwordx4 v12, s[24:27], s49 offen offset:2048 lds
    buffer_load_dwordx4 v13, s[24:27], s49 offen offset:3072 lds
    s_barrier
    s_mov_b32 m0, 31744
    s_add_u32 s49, s61, 81920
    buffer_load_dwordx4 v10, s[24:27], s49 offen offset:0 lds
    buffer_load_dwordx4 v11, s[24:27], s49 offen offset:1024 lds
    buffer_load_dwordx4 v12, s[24:27], s49 offen offset:2048 lds
    buffer_load_dwordx4 v13, s[24:27], s49 offen offset:3072 lds
    s_mov_b32 m0, 35840
    s_add_u32 s49, s61, 122880
    buffer_load_dwordx4 v10, s[24:27], s49 offen offset:0 lds
    buffer_load_dwordx4 v11, s[24:27], s49 offen offset:1024 lds
    buffer_load_dwordx4 v12, s[24:27], s49 offen offset:2048 lds
    buffer_load_dwordx4 v13, s[24:27], s49 offen offset:3072 lds
    s_waitcnt vmcnt(16)
    s_barrier
    s_xor_b32 s50, s59, 640
    s_add_u32 s61, s55, s50
    s_mov_b32 m0, 39936
    s_add_u32 s49, s61, 0
    buffer_load_dwordx4 v10, s[24:27], s49 offen offset:0 lds
    buffer_load_dwordx4 v11, s[24:27], s49 offen offset:1024 lds
    buffer_load_dwordx4 v12, s[24:27], s49 offen offset:2048 lds
    buffer_load_dwordx4 v13, s[24:27], s49 offen offset:3072 lds
    s_mov_b32 m0, 44032
    s_add_u32 s49, s61, 40960
    buffer_load_dwordx4 v10, s[24:27], s49 offen offset:0 lds
    buffer_load_dwordx4 v11, s[24:27], s49 offen offset:1024 lds
    buffer_load_dwordx4 v12, s[24:27], s49 offen offset:2048 lds
    buffer_load_dwordx4 v13, s[24:27], s49 offen offset:3072 lds
    s_barrier
    s_mov_b32 m0, 48128
    s_add_u32 s49, s61, 81920
    buffer_load_dwordx4 v10, s[24:27], s49 offen offset:0 lds
    buffer_load_dwordx4 v11, s[24:27], s49 offen offset:1024 lds
    buffer_load_dwordx4 v12, s[24:27], s49 offen offset:2048 lds
    buffer_load_dwordx4 v13, s[24:27], s49 offen offset:3072 lds
    s_mov_b32 m0, 52224
    s_add_u32 s49, s61, 122880
    buffer_load_dwordx4 v10, s[24:27], s49 offen offset:0 lds
    buffer_load_dwordx4 v11, s[24:27], s49 offen offset:1024 lds
    buffer_load_dwordx4 v12, s[24:27], s49 offen offset:2048 lds
    buffer_load_dwordx4 v13, s[24:27], s49 offen offset:3072 lds
    s_waitcnt vmcnt(16)
    s_barrier
    s_xor_b32 s50, s59, 768
    s_add_u32 s61, s55, s50
    s_mov_b32 m0, 56320
    s_add_u32 s49, s61, 0
    buffer_load_dwordx4 v10, s[24:27], s49 offen offset:0 lds
    buffer_load_dwordx4 v11, s[24:27], s49 offen offset:1024 lds
    buffer_load_dwordx4 v12, s[24:27], s49 offen offset:2048 lds
    buffer_load_dwordx4 v13, s[24:27], s49 offen offset:3072 lds
    s_mov_b32 m0, 60416
    s_add_u32 s49, s61, 40960
    buffer_load_dwordx4 v10, s[24:27], s49 offen offset:0 lds
    buffer_load_dwordx4 v11, s[24:27], s49 offen offset:1024 lds
    buffer_load_dwordx4 v12, s[24:27], s49 offen offset:2048 lds
    buffer_load_dwordx4 v13, s[24:27], s49 offen offset:3072 lds
    s_barrier
    s_mov_b32 m0, 64512
    s_add_u32 s49, s61, 81920
    buffer_load_dwordx4 v10, s[24:27], s49 offen offset:0 lds
    buffer_load_dwordx4 v11, s[24:27], s49 offen offset:1024 lds
    buffer_load_dwordx4 v12, s[24:27], s49 offen offset:2048 lds
    buffer_load_dwordx4 v13, s[24:27], s49 offen offset:3072 lds
    s_mov_b32 m0, 68608
    s_add_u32 s49, s61, 122880
    buffer_load_dwordx4 v10, s[24:27], s49 offen offset:0 lds
    buffer_load_dwordx4 v11, s[24:27], s49 offen offset:1024 lds
    buffer_load_dwordx4 v12, s[24:27], s49 offen offset:2048 lds
    buffer_load_dwordx4 v13, s[24:27], s49 offen offset:3072 lds
    s_waitcnt vmcnt(16)
    s_barrier
    s_xor_b32 s50, s59, 896
    s_add_u32 s61, s55, s50
    s_mov_b32 m0, 23552
    s_add_u32 s49, s61, 0
    buffer_load_dwordx4 v10, s[24:27], s49 offen offset:0 lds
    buffer_load_dwordx4 v11, s[24:27], s49 offen offset:1024 lds
    buffer_load_dwordx4 v12, s[24:27], s49 offen offset:2048 lds
    buffer_load_dwordx4 v13, s[24:27], s49 offen offset:3072 lds
    s_mov_b32 m0, 27648
    s_add_u32 s49, s61, 40960
    buffer_load_dwordx4 v10, s[24:27], s49 offen offset:0 lds
    buffer_load_dwordx4 v11, s[24:27], s49 offen offset:1024 lds
    buffer_load_dwordx4 v12, s[24:27], s49 offen offset:2048 lds
    buffer_load_dwordx4 v13, s[24:27], s49 offen offset:3072 lds
    s_barrier
    s_mov_b32 m0, 31744
    s_add_u32 s49, s61, 81920
    buffer_load_dwordx4 v10, s[24:27], s49 offen offset:0 lds
    buffer_load_dwordx4 v11, s[24:27], s49 offen offset:1024 lds
    buffer_load_dwordx4 v12, s[24:27], s49 offen offset:2048 lds
    buffer_load_dwordx4 v13, s[24:27], s49 offen offset:3072 lds
    s_mov_b32 m0, 35840
    s_add_u32 s49, s61, 122880
    buffer_load_dwordx4 v10, s[24:27], s49 offen offset:0 lds
    buffer_load_dwordx4 v11, s[24:27], s49 offen offset:1024 lds
    buffer_load_dwordx4 v12, s[24:27], s49 offen offset:2048 lds
    buffer_load_dwordx4 v13, s[24:27], s49 offen offset:3072 lds
    s_waitcnt vmcnt(16)
    s_barrier
    s_xor_b32 s50, s60, 1024
    s_add_u32 s61, s55, s50
    s_mov_b32 m0, 39936
    s_add_u32 s49, s61, 0
    buffer_load_dwordx4 v10, s[24:27], s49 offen offset:0 lds
    buffer_load_dwordx4 v11, s[24:27], s49 offen offset:1024 lds
    buffer_load_dwordx4 v12, s[24:27], s49 offen offset:2048 lds
    buffer_load_dwordx4 v13, s[24:27], s49 offen offset:3072 lds
    s_mov_b32 m0, 44032
    s_add_u32 s49, s61, 40960
    buffer_load_dwordx4 v10, s[24:27], s49 offen offset:0 lds
    buffer_load_dwordx4 v11, s[24:27], s49 offen offset:1024 lds
    buffer_load_dwordx4 v12, s[24:27], s49 offen offset:2048 lds
    buffer_load_dwordx4 v13, s[24:27], s49 offen offset:3072 lds
    s_barrier
    s_mov_b32 m0, 48128
    s_add_u32 s49, s61, 81920
    buffer_load_dwordx4 v10, s[24:27], s49 offen offset:0 lds
    buffer_load_dwordx4 v11, s[24:27], s49 offen offset:1024 lds
    buffer_load_dwordx4 v12, s[24:27], s49 offen offset:2048 lds
    buffer_load_dwordx4 v13, s[24:27], s49 offen offset:3072 lds
    s_mov_b32 m0, 52224
    s_add_u32 s49, s61, 122880
    buffer_load_dwordx4 v10, s[24:27], s49 offen offset:0 lds
    buffer_load_dwordx4 v11, s[24:27], s49 offen offset:1024 lds
    buffer_load_dwordx4 v12, s[24:27], s49 offen offset:2048 lds
    buffer_load_dwordx4 v13, s[24:27], s49 offen offset:3072 lds
    s_waitcnt vmcnt(16)
    s_barrier
    s_mov_b32 s51, 8921088
    buffer_load_dwordx2 v[32:33], v14, s[36:39], s51 offen offset:768 sc1
    buffer_load_dwordx2 v[34:35], v15, s[36:39], s51 offen offset:768 sc1
    s_xor_b32 s50, s60, 1152
    s_add_u32 s61, s55, s50
    s_mov_b32 m0, 56320
    s_add_u32 s49, s61, 0
    buffer_load_dwordx4 v10, s[24:27], s49 offen offset:0 lds
    buffer_load_dwordx4 v11, s[24:27], s49 offen offset:1024 lds
    buffer_load_dwordx4 v12, s[24:27], s49 offen offset:2048 lds
    buffer_load_dwordx4 v13, s[24:27], s49 offen offset:3072 lds
    s_mov_b32 m0, 60416
    s_add_u32 s49, s61, 40960
    buffer_load_dwordx4 v10, s[24:27], s49 offen offset:0 lds
    buffer_load_dwordx4 v11, s[24:27], s49 offen offset:1024 lds
    buffer_load_dwordx4 v12, s[24:27], s49 offen offset:2048 lds
    buffer_load_dwordx4 v13, s[24:27], s49 offen offset:3072 lds
    s_barrier
    s_mov_b32 m0, 64512
    s_add_u32 s49, s61, 81920
    buffer_load_dwordx4 v10, s[24:27], s49 offen offset:0 lds
    buffer_load_dwordx4 v11, s[24:27], s49 offen offset:1024 lds
    buffer_load_dwordx4 v12, s[24:27], s49 offen offset:2048 lds
    buffer_load_dwordx4 v13, s[24:27], s49 offen offset:3072 lds
    s_mov_b32 m0, 68608
    s_add_u32 s49, s61, 122880
    buffer_load_dwordx4 v10, s[24:27], s49 offen offset:0 lds
    buffer_load_dwordx4 v11, s[24:27], s49 offen offset:1024 lds
    buffer_load_dwordx4 v12, s[24:27], s49 offen offset:2048 lds
    buffer_load_dwordx4 v13, s[24:27], s49 offen offset:3072 lds
    s_waitcnt vmcnt(18)
    s_barrier
    s_add_u32 s49, s12, 81920
    buffer_load_dwordx4 v[64:67], v26, s[40:43], s49 offen
    buffer_load_dwordx4 v[68:71], v27, s[40:43], s49 offen offset:1024
    s_add_u32 s49, s13, 81920
    buffer_load_dwordx4 v[72:75], v26, s[40:43], s49 offen
    buffer_load_dwordx4 v[76:79], v27, s[40:43], s49 offen offset:1024
    s_waitcnt vmcnt(20)
    s_barrier
    s_mov_b32 s67, 262144
    s_mov_b32 s51, 8921088
LFL_rc:
    v_xor_b32 v4, s58, v33
    v_xor_b32 v5, s58, v35
    v_or_b32 v4, v4, v5
    v_cmp_ne_u32 vcc, 0, v4
    s_nop 0
    s_cmp_eq_u64 vcc, 0
    s_cbranch_scc1 LFL_rd
    s_sleep 4
    buffer_load_dwordx2 v[32:33], v14, s[36:39], s51 offen offset:768 sc1
    buffer_load_dwordx2 v[34:35], v15, s[36:39], s51 offen offset:768 sc1
    s_sub_u32 s67, s67, 1
    s_cmp_lg_u32 s67, 0
    s_waitcnt vmcnt(0)
    s_cbranch_scc1 LFL_rc
LFL_rd:
    s_add_u32 s49, s15, 81920
    buffer_load_dwordx4 v[80:83], v26, s[40:43], s49 offen
    buffer_load_dwordx4 v[84:87], v27, s[40:43], s49 offen offset:1024
    s_add_u32 s49, s16, 81920
    buffer_load_dwordx4 v[88:91], v26, s[40:43], s49 offen
    buffer_load_dwordx4 v[92:95], v27, s[40:43], s49 offen offset:1024
    s_add_u32 s49, s17, 81920
    buffer_load_dwordx4 v[96:99], v26, s[40:43], s49 offen
    buffer_load_dwordx4 v[100:103], v27, s[40:43], s49 offen offset:1024
    v_lshlrev_b32 v6, 16, v32
    v_and_b32 v7, 0xffff0000, v32
    v_rcp_f32 v8, v7
    v_xor_b32 v6, 0x80000000, v6
    v_mul_f32 v8, 0xbfb8aa3b, v8
    ds_write_b32 v21, v6 offset:0
    ds_write_b32 v21, v8 offset:640
    ds_write_b32 v21, v7 offset:1280
    s_waitcnt vmcnt(10)
    s_barrier
    s_add_u32 s49, s19, 81920
    buffer_load_dwordx4 v[104:107], v26, s[40:43], s49 offen
    buffer_load_dwordx4 v[108:111], v27, s[40:43], s49 offen offset:1024
    buffer_load_dwordx4 v[112:115], v26, s[32:35], s4 offen
    buffer_load_dwordx4 v[116:119], v27, s[32:35], s4 offen offset:1024
    buffer_load_dwordx4 v[120:123], v26, s[32:35], s5 offen
    buffer_load_dwordx4 v[124:127], v27, s[32:35], s5 offen offset:1024
    v_lshlrev_b32 v6, 16, v34
    v_and_b32 v7, 0xffff0000, v34
    v_rcp_f32 v8, v7
    v_xor_b32 v6, 0x80000000, v6
    v_mul_f32 v8, 0xbfb8aa3b, v8
    ds_write_b32 v21, v6 offset:256
    ds_write_b32 v21, v8 offset:896
    ds_write_b32 v21, v7 offset:1536
    s_waitcnt lgkmcnt(0)
    s_barrier
    buffer_load_dwordx4 v[128:131], v26, s[32:35], s7 offen
    buffer_load_dwordx4 v[132:135], v27, s[32:35], s7 offen offset:1024
    buffer_load_dwordx4 v[136:139], v26, s[32:35], s44 offen
    buffer_load_dwordx4 v[140:143], v27, s[32:35], s44 offen offset:1024
    buffer_load_dwordx4 v[144:147], v26, s[32:35], s45 offen
    buffer_load_dwordx4 v[148:151], v27, s[32:35], s45 offen offset:1024
    s_barrier
    buffer_load_dwordx4 v[152:155], v26, s[32:35], s47 offen
    buffer_load_dwordx4 v[156:159], v27, s[32:35], s47 offen offset:1024
    s_add_u32 s49, s66, 0
    buffer_load_dwordx4 v[160:163], v26, s[32:35], s49 offen
    s_add_u32 s49, s49, 92160
    buffer_load_dwordx4 v[164:167], v27, s[32:35], s49 offen offset:1024
    s_branch LFL_tail
L_FC:
    v_lshrrev_b32 v1, 5, v0
    v_mul_u32_u24 v1, 1280, v1
    v_and_b32 v2, 31, v0
    v_lshl_add_u32 v1, v2, 3, v1
    s_lshl_b32 s49, s23, 4
    s_add_u32 s49, s49, s3
    s_lshl_b32 s49, s49, 2
    s_add_u32 s49, s49, s22
    s_mul_i32 s49, s49, 2560
    s_getpc_b64 s[56:57]
L_pcF:
    s_lshl_b32 s51, s53, 2
    s_add_u32 s51, s51, s22
    s_mul_i32 s51, s51, 384
    v_lshlrev_b32 v4, 7, v0
    v_add_u32 v4, s51, v4
    v_min_u32 v4, L_end-parallel_sum__sliding_local_dilated__dense_activation_silu__prompt_kernel, v4
    s_sub_u32 s56, s56, L_pcF-parallel_sum__sliding_local_dilated__dense_activation_silu__prompt_kernel
    s_subb_u32 s57, s57, 0
    v_mov_b32 v5, s57
    v_add_co_u32 v4, vcc, s56, v4
    s_nop 1
    v_addc_co_u32 v5, vcc, 0, v5, vcc
    s_mov_b64 exec, 7
    global_load_dword v212, v[4:5], off
    s_mov_b64 exec, -1
    s_waitcnt lgkmcnt(0)
    s_mov_b32 s24, s4
    s_mov_b32 s25, s5
    s_mov_b32 s26, 2621440
    s_mov_b32 s27, 0x20000
    buffer_load_dwordx2 v[200:201], v1, s[24:27], s49 offen offset:0
    buffer_load_dwordx2 v[202:203], v1, s[24:27], s49 offen offset:256
    buffer_load_dwordx2 v[204:205], v1, s[24:27], s49 offen offset:512
    buffer_load_dwordx2 v[206:207], v1, s[24:27], s49 offen offset:768
    buffer_load_dwordx2 v[208:209], v1, s[24:27], s49 offen offset:1024
    s_mov_b32 s36, s20
    s_mov_b32 s37, s21
    s_mov_b32 s38, 11640832
    s_mov_b32 s39, 0x20000
    s_mov_b32 s44, s16
    s_mov_b32 s45, s17
    s_mov_b32 s46, 2621440
    s_mov_b32 s47, 0x20000
    s_mov_b32 s28, s20
    s_mov_b32 s29, s21
    s_mov_b32 s30, 8912896
    s_mov_b32 s31, 0x20000
    s_sub_u32 s49, s53, 16
    s_lshr_b32 s50, s49, 2
    s_and_b32 s51, s49, 3
    s_sub_u32 s52, s49, 6
    s_lshr_b32 s52, s52, 1
    s_and_b32 s70, s49, 1
    s_cmp_lt_u32 s49, 12
    s_cselect_b32 s71, s50, s52
    s_cselect_b32 s70, s51, s70
    s_mul_i32 s70, s70, 6
    s_and_b32 s50, s53, 3
    s_and_b32 s51, s53, 1
    s_lshl_b32 s51, s51, 1
    s_cmp_lt_u32 s53, 28
    s_cselect_b32 s50, s50, s51
    s_lshl_b32 s50, s50, 1
    s_mul_i32 s11, s71, 3
    s_add_u32 s11, s11, s50
    s_lshr_b32 s49, s54, 1
    s_lshl_b32 s49, s49, 5
    s_add_u32 s70, s70, s49
    s_and_b32 s49, s54, 1
    s_mul_i32 s49, s49, 5
    s_add_u32 s71, s71, s49
    s_and_b32 s11, s11, 0
    s_and_b32 s60, s22, 1
    s_lshr_b32 s61, s22, 1
    s_mul_i32 s49, s60, 3
    s_add_u32 s49, s49, s70
    s_lshl_b32 s4, s49, 11
    s_lshl_b32 s50, s61, 10
    s_add_u32 s4, s4, s50
    s_mul_i32 s49, s49, 20480
    s_lshl_b32 s50, s71, 7
    s_lshl_b32 s51, s61, 6
    s_add_u32 s49, s49, s50
    s_add_u32 s6, s49, s51
    s_add_u32 s7, s6, 20480
    s_add_u32 s8, s7, 20480
    s_xor_b32 s12, s11, 0
    s_lshl_b32 s12, s12, 18
    s_add_u32 s12, s12, s4
    s_xor_b32 s13, s11, 1
    s_lshl_b32 s13, s13, 18
    s_add_u32 s13, s13, s4
    s_xor_b32 s14, s11, 2
    s_lshl_b32 s14, s14, 18
    s_add_u32 s14, s14, s4
    s_xor_b32 s15, s11, 3
    s_lshl_b32 s15, s15, 18
    s_add_u32 s15, s15, s4
    s_xor_b32 s16, s11, 4
    s_lshl_b32 s16, s16, 18
    s_add_u32 s16, s16, s4
    s_xor_b32 s17, s11, 5
    s_lshl_b32 s17, s17, 18
    s_add_u32 s17, s17, s4
    s_xor_b32 s18, s11, 6
    s_lshl_b32 s18, s18, 18
    s_add_u32 s18, s18, s4
    s_xor_b32 s19, s11, 7
    s_lshl_b32 s19, s19, 18
    s_add_u32 s19, s19, s4
    s_add_u32 s5, s4, 8650752
    s_add_u32 s4, s4, 8388608
    s_lshl_b32 s9, s23, 14
    s_lshl_b32 s49, s3, 10
    s_add_u32 s9, s9, s49
    s_add_u32 s9, s9, 8921088
    v_lshlrev_b32 v251, 4, v0
    v_add_u32 v250, 4096, v251
    v_lshrrev_b32 v1, 2, v0
    v_and_b32 v2, 3, v0
    v_mul_u32_u24 v3, 1280, v1
    v_lshl_add_u32 v247, v2, 4, v3
    v_mul_u32_u24 v3, 80, v1
    v_lshl_add_u32 v243, v2, 4, v3
    v_lshlrev_b32 v1, 7, v1
    v_lshl_add_u32 v1, v2, 3, v1
    v_bfe_u32 v2, v0, 3, 2
    s_lshl_b32 s49, s61, 12
    s_add_u32 s49, s49, 23552
    v_add_u32 v1, s49, v1
    s_lshl_b32 s49, s61, 1
    s_xor_b32 s50, s49, 0
    v_xor_b32 v3, s50, v2
    v_lshl_add_u32 v255, v3, 5, v1
    s_xor_b32 s50, s49, 1
    v_xor_b32 v3, s50, v2
    v_lshl_add_u32 v254, v3, 5, v1
    s_xor_b32 s50, s49, 2
    v_xor_b32 v3, s50, v2
    v_lshl_add_u32 v253, v3, 5, v1
    s_xor_b32 s50, s49, 3
    v_xor_b32 v3, s50, v2
    v_lshl_add_u32 v252, v3, 5, v1
    v_and_b32 v4, 15, v0
    v_lshlrev_b32 v1, 7, v4
    v_lshrrev_b32 v5, 4, v0
    v_lshl_add_u32 v1, v5, 3, v1
    v_bfe_u32 v2, v0, 1, 2
    s_mul_i32 s50, s60, 6144
    s_add_u32 s50, s50, 3072
    v_add_u32 v1, s50, v1
    s_xor_b32 s50, s49, 0
    v_xor_b32 v3, s50, v2
    v_lshl_add_u32 v249, v3, 5, v1
    s_xor_b32 s50, s49, 1
    v_xor_b32 v3, s50, v2
    v_lshl_add_u32 v248, v3, 5, v1
    s_mul_i32 s49, s22, 6144
    s_add_u32 s49, s49, 56320
    v_add_u32 v246, s49, v251
    s_xor_b32 s50, s22, 2
    s_mul_i32 s50, s50, 6144
    s_add_u32 s50, s50, 56320
    v_add_u32 v245, s50, v251
    v_mul_u32_u24 v1, 80, v4
    v_lshl_add_u32 v1, v5, 3, v1
    v_add_u32 v244, s50, v1
    v_add_u32 v243, s50, v243
    v_and_b32 v242, 0x30, v0
    v_lshlrev_b32 v241, 2, v4
    v_lshlrev_b32 v240, 3, v0
    s_lshr_b32 s58, s22, 1
    s_and_b32 s52, s22, 1
    s_mul_i32 s49, s58, 384
    v_add_u32 v242, s49, v242
    s_lshl_b32 s49, s52, 8
    v_add_u32 v241, s49, v241
    s_lshl_b32 s49, s23, 14
    s_lshl_b32 s50, s52, 13
    s_add_u32 s49, s49, s50
    s_lshl_b32 s50, s58, 10
    s_add_u32 s49, s49, s50
    s_lshl_b32 s50, s48, 18
    s_add_u32 s59, s49, s50
    s_add_u32 s60, s59, 2097152
    s_add_u32 s61, s59, 4194304
    v_and_b32 v1, 15, v0
    v_lshrrev_b32 v2, 4, v0
    v_lshrrev_b32 v3, 1, v1
    v_xor_b32 v2, v2, v3
    v_lshlrev_b32 v1, 7, v1
    v_lshl_add_u32 v14, v2, 4, v1
    s_and_b32 s49, s10, 1
    s_lshl_b32 s49, s49, 6
    v_xor_b32 v14, s49, v14
    v_xor_b32 v15, 64, v14
    v_lshrrev_b32 v1, 2, v0
    v_mul_u32_u24 v1, 384, v1
    v_and_b32 v2, 3, v0
    v_lshl_add_u32 v1, v2, 3, v1
    v_bfe_u32 v2, v0, 3, 2
    s_mul_i32 s49, s58, 6
    s_add_u32 s50, s49, 0
    v_xor_b32 v3, s50, v2
    v_lshl_add_u32 v8, v3, 5, v1
    s_add_u32 s50, s49, 1
    v_xor_b32 v3, s50, v2
    v_lshl_add_u32 v9, v3, 5, v1
    s_add_u32 s50, s49, 2
    v_xor_b32 v3, s50, v2
    v_lshl_add_u32 v10, v3, 5, v1
    s_add_u32 s50, s49, 3
    v_xor_b32 v3, s50, v2
    v_lshl_add_u32 v11, v3, 5, v1
    s_mov_b32 s55, 72704
    s_mov_b32 s56, 56320
    v_add_u32 v4, s55, v8
    v_add_u32 v5, s55, v9
    v_add_u32 v6, s55, v10
    v_add_u32 v7, s55, v11
    v_add_u32 v12, s56, v14
    v_add_u32 v13, s56, v15
    v_mov_b64 v[28:29], 0
    v_mov_b64 v[30:31], 0
    v_mov_b64 v[32:33], 0
    v_mov_b64 v[34:35], 0
    v_mov_b64 v[36:37], 0
    v_mov_b64 v[38:39], 0
    v_mov_b64 v[40:41], 0
    v_mov_b64 v[42:43], 0
    v_mov_b64 v[44:45], 0
    v_mov_b64 v[46:47], 0
    v_mov_b64 v[48:49], 0
    v_mov_b64 v[50:51], 0
    v_mov_b64 v[52:53], 0
    v_mov_b64 v[54:55], 0
    v_mov_b64 v[56:57], 0
    v_mov_b64 v[58:59], 0
    v_mov_b64 v[60:61], 0
    v_mov_b64 v[62:63], 0
    v_mov_b64 v[64:65], 0
    v_mov_b64 v[66:67], 0
    v_mov_b64 v[68:69], 0
    v_mov_b64 v[70:71], 0
    v_mov_b64 v[72:73], 0
    v_mov_b64 v[74:75], 0
    v_mov_b64 v[76:77], 0
    v_mov_b64 v[78:79], 0
    v_mov_b64 v[80:81], 0
    v_mov_b64 v[82:83], 0
    v_mov_b64 v[84:85], 0
    v_mov_b64 v[86:87], 0
    v_mov_b64 v[88:89], 0
    v_mov_b64 v[90:91], 0
    v_mov_b64 v[92:93], 0
    v_mov_b64 v[94:95], 0
    v_mov_b64 v[96:97], 0
    v_mov_b64 v[98:99], 0
    v_mov_b64 v[100:101], 0
    v_mov_b64 v[102:103], 0
    v_mov_b64 v[104:105], 0
    v_mov_b64 v[106:107], 0
    v_mov_b64 v[108:109], 0
    v_mov_b64 v[110:111], 0
    v_mov_b64 v[112:113], 0
    v_mov_b64 v[114:115], 0
    v_mov_b64 v[116:117], 0
    v_mov_b64 v[118:119], 0
    v_mov_b64 v[120:121], 0
    v_mov_b64 v[122:123], 0
    v_mov_b64 v[124:125], 0
    v_mov_b64 v[126:127], 0
    v_mov_b64 v[128:129], 0
    v_mov_b64 v[130:131], 0
    v_mov_b64 v[132:133], 0
    v_mov_b64 v[134:135], 0
    v_mov_b64 v[184:185], 0
    v_mov_b64 v[186:187], 0
    s_mov_b32 exec_lo, 0x00010001
    s_mov_b32 exec_hi, 0x00010001
    v_mov_b32 v184, 0x3f803f80
    v_mov_b32 v185, 0x3f803f80
    v_mov_b32 v186, 0x3f803f80
    v_mov_b32 v187, 0x3f803f80
    s_mov_b64 exec, -1
    s_waitcnt vmcnt(0)
    v_lshlrev_b32 v216, 16, v200
    v_and_b32 v200, 0xffff0000, v200
    v_add_f32 v214, v216, v200
    v_mul_f32 v215, v216, v216
    v_fmac_f32 v215, v200, v200
    v_lshlrev_b32 v216, 16, v201
    v_and_b32 v201, 0xffff0000, v201
    v_add_f32 v214, v214, v216
    v_fmac_f32 v215, v216, v216
    v_add_f32 v214, v214, v201
    v_fmac_f32 v215, v201, v201
    v_lshlrev_b32 v216, 16, v202
    v_and_b32 v202, 0xffff0000, v202
    v_add_f32 v214, v214, v216
    v_fmac_f32 v215, v216, v216
    v_add_f32 v214, v214, v202
    v_fmac_f32 v215, v202, v202
    v_lshlrev_b32 v216, 16, v203
    v_and_b32 v203, 0xffff0000, v203
    v_add_f32 v214, v214, v216
    v_fmac_f32 v215, v216, v216
    v_add_f32 v214, v214, v203
    v_fmac_f32 v215, v203, v203
    v_lshlrev_b32 v216, 16, v204
    v_and_b32 v204, 0xffff0000, v204
    v_add_f32 v214, v214, v216
    v_fmac_f32 v215, v216, v216
    v_add_f32 v214, v214, v204
    v_fmac_f32 v215, v204, v204
    v_lshlrev_b32 v216, 16, v205
    v_and_b32 v205, 0xffff0000, v205
    v_add_f32 v214, v214, v216
    v_fmac_f32 v215, v216, v216
    v_add_f32 v214, v214, v205
    v_fmac_f32 v215, v205, v205
    v_lshlrev_b32 v216, 16, v206
    v_and_b32 v206, 0xffff0000, v206
    v_add_f32 v214, v214, v216
    v_fmac_f32 v215, v216, v216
    v_add_f32 v214, v214, v206
    v_fmac_f32 v215, v206, v206
    v_lshlrev_b32 v216, 16, v207
    v_and_b32 v207, 0xffff0000, v207
    v_add_f32 v214, v214, v216
    v_fmac_f32 v215, v216, v216
    v_add_f32 v214, v214, v207
    v_fmac_f32 v215, v207, v207
    v_lshlrev_b32 v216, 16, v208
    v_and_b32 v208, 0xffff0000, v208
    v_add_f32 v214, v214, v216
    v_fmac_f32 v215, v216, v216
    v_add_f32 v214, v214, v208
    v_fmac_f32 v215, v208, v208
    v_lshlrev_b32 v216, 16, v209
    v_and_b32 v209, 0xffff0000, v209
    v_add_f32 v214, v214, v216
    v_fmac_f32 v215, v216, v216
    v_add_f32 v214, v214, v209
    v_fmac_f32 v215, v209, v209
    s_nop 0
    v_add_f32_dpp v214, v214, v214 quad_perm:[1,0,3,2] row_mask:0xf bank_mask:0xf
    v_add_f32_dpp v215, v215, v215 quad_perm:[1,0,3,2] row_mask:0xf bank_mask:0xf
    s_nop 0
    v_add_f32_dpp v214, v214, v214 quad_perm:[2,3,0,1] row_mask:0xf bank_mask:0xf
    v_add_f32_dpp v215, v215, v215 quad_perm:[2,3,0,1] row_mask:0xf bank_mask:0xf
    s_nop 0
    v_add_f32_dpp v214, v214, v214 row_half_mirror row_mask:0xf bank_mask:0xf
    v_add_f32_dpp v215, v215, v215 row_half_mirror row_mask:0xf bank_mask:0xf
    s_nop 0
    v_add_f32_dpp v214, v214, v214 row_mirror row_mask:0xf bank_mask:0xf
    v_add_f32_dpp v215, v215, v215 row_mirror row_mask:0xf bank_mask:0xf
    v_mov_b32 v216, v214
    v_mov_b32 v217, v215
    s_nop 0
    v_permlane16_swap_b32 v214, v216
    v_permlane16_swap_b32 v215, v217
    v_add_f32 v214, v214, v216
    v_add_f32 v215, v215, v217
    v_mul_f32 v214, 0x3acccccd, v214
    v_mul_f32 v215, 0x3acccccd, v215
    v_fma_f32 v215, -v214, v214, v215
    v_max_f32 v215, 0, v215
    v_cvt_pk_bf16_f32 v215, v215, v215
    v_and_b32 v215, 0xffff0000, v215
    v_add_f32 v215, 0x3727c5ac, v215
    v_cvt_pk_bf16_f32 v215, v215, v215
    v_and_b32 v215, 0xffff0000, v215
    v_sqrt_f32 v215, v215
    s_nop 0
    v_cvt_pk_bf16_f32 v214, v214, v215
    v_lshrrev_b32 v216, 3, v0
    s_lshl_b32 s49, s22, 3
    v_add_u32 v216, s49, v216
    s_mov_b32 exec_lo, 1
    s_mov_b32 exec_hi, 1
    ds_write_b32 v216, v214 offset:2944
    s_mov_b64 exec, -1
    s_waitcnt lgkmcnt(0)
    s_bitcmp1_b32 s22, 0
    s_cbranch_scc1 L_FC1
    s_barrier
    ds_read_b64_tr_b16 v[188:189], v4 offset:0
    ds_read_b64_tr_b16 v[190:191], v4 offset:6144
    ds_read_b128 v[152:155], v12 offset:0
    ds_read_b128 v[156:159], v12 offset:2048
    ds_read_b128 v[160:163], v12 offset:4096
    ds_read_b128 v[164:167], v12 offset:6144
    ds_read_b64_tr_b16 v[192:193], v5 offset:0
    ds_read_b64_tr_b16 v[194:195], v5 offset:6144
    ds_read_b64_tr_b16 v[196:197], v6 offset:0
    ds_read_b64_tr_b16 v[198:199], v6 offset:6144
    s_mov_b32 s57, 10
.p2align 6
LFC0_loop:
    s_waitcnt lgkmcnt(4)
    v_mfma_f32_16x16x32_bf16 v[28:31], v[188:191], v[152:155], v[28:31]
    ds_read_b64_tr_b16 v[200:201], v7 offset:0
    s_add_u32 s55, s55, 12288
    v_mfma_f32_16x16x32_bf16 v[32:35], v[188:191], v[156:159], v[32:35]
    ds_read_b64_tr_b16 v[202:203], v7 offset:6144
    s_cmp_ge_u32 s55, 134144
    v_mfma_f32_16x16x32_bf16 v[124:127], v[188:191], v[184:187], v[124:127]
    s_cselect_b32 s55, 72704, s55
    v_add_u32 v16, s55, v8
    v_mfma_f32_16x16x32_bf16 v[36:39], v[188:191], v[160:163], v[36:39]
    v_add_u32 v17, s55, v9
    v_mfma_f32_16x16x32_bf16 v[40:43], v[188:191], v[164:167], v[40:43]
    ds_read_b64_tr_b16 v[204:205], v4 offset:128
    s_waitcnt lgkmcnt(5)
    v_mfma_f32_16x16x32_bf16 v[56:59], v[192:195], v[164:167], v[56:59]
    ds_read_b64_tr_b16 v[206:207], v4 offset:6272
    v_add_u32 v18, s55, v10
    v_mfma_f32_16x16x32_bf16 v[52:55], v[192:195], v[160:163], v[52:55]
    v_mfma_f32_16x16x32_bf16 v[128:131], v[192:195], v[184:187], v[128:131]
    v_add_u32 v19, s55, v11
    v_mfma_f32_16x16x32_bf16 v[48:51], v[192:195], v[156:159], v[48:51]
    ds_read_b64_tr_b16 v[208:209], v5 offset:128
    v_mfma_f32_16x16x32_bf16 v[44:47], v[192:195], v[152:155], v[44:47]
    ds_read_b64_tr_b16 v[210:211], v5 offset:6272
    s_waitcnt lgkmcnt(6)
    v_mfma_f32_16x16x32_bf16 v[60:63], v[196:199], v[152:155], v[60:63]
    v_mfma_f32_16x16x32_bf16 v[64:67], v[196:199], v[156:159], v[64:67]
    v_mfma_f32_16x16x32_bf16 v[132:135], v[196:199], v[184:187], v[132:135]
    v_mfma_f32_16x16x32_bf16 v[68:71], v[196:199], v[160:163], v[68:71]
    v_mfma_f32_16x16x32_bf16 v[72:75], v[196:199], v[164:167], v[72:75]
    s_waitcnt lgkmcnt(4)
    v_mfma_f32_16x16x32_bf16 v[88:91], v[200:203], v[164:167], v[88:91]
    s_barrier
    ds_read_b64_tr_b16 v[188:189], v16 offset:0
    v_mfma_f32_16x16x32_bf16 v[84:87], v[200:203], v[160:163], v[84:87]
    ds_read_b64_tr_b16 v[190:191], v16 offset:6144
    v_mfma_f32_16x16x32_bf16 v[80:83], v[200:203], v[156:159], v[80:83]
    ds_read_b128 v[168:171], v13 offset:0
    v_mfma_f32_16x16x32_bf16 v[76:79], v[200:203], v[152:155], v[76:79]
    ds_read_b128 v[172:175], v13 offset:2048
    s_waitcnt lgkmcnt(6)
    v_mfma_f32_16x16x32_bf16 v[92:95], v[204:207], v[152:155], v[92:95]
    ds_read_b128 v[176:179], v13 offset:4096
    v_mfma_f32_16x16x32_bf16 v[96:99], v[204:207], v[156:159], v[96:99]
    ds_read_b128 v[180:183], v13 offset:6144
    v_mfma_f32_16x16x32_bf16 v[100:103], v[204:207], v[160:163], v[100:103]
    ds_read_b64_tr_b16 v[192:193], v17 offset:0
    v_mfma_f32_16x16x32_bf16 v[104:107], v[204:207], v[164:167], v[104:107]
    ds_read_b64_tr_b16 v[194:195], v17 offset:6144
    s_waitcnt lgkmcnt(8)
    v_mfma_f32_16x16x32_bf16 v[120:123], v[208:211], v[164:167], v[120:123]
    ds_read_b64_tr_b16 v[196:197], v18 offset:0
    v_mfma_f32_16x16x32_bf16 v[116:119], v[208:211], v[160:163], v[116:119]
    ds_read_b64_tr_b16 v[198:199], v18 offset:6144
    v_mfma_f32_16x16x32_bf16 v[112:115], v[208:211], v[156:159], v[112:115]
    v_mfma_f32_16x16x32_bf16 v[108:111], v[208:211], v[152:155], v[108:111]
    s_waitcnt lgkmcnt(4)
    v_mfma_f32_16x16x32_bf16 v[28:31], v[188:191], v[168:171], v[28:31]
    ds_read_b64_tr_b16 v[200:201], v19 offset:0
    s_add_u32 s55, s55, 12288
    v_mfma_f32_16x16x32_bf16 v[32:35], v[188:191], v[172:175], v[32:35]
    ds_read_b64_tr_b16 v[202:203], v19 offset:6144
    s_cmp_ge_u32 s55, 134144
    v_mfma_f32_16x16x32_bf16 v[124:127], v[188:191], v[184:187], v[124:127]
    s_cselect_b32 s55, 72704, s55
    v_add_u32 v4, s55, v8
    v_mfma_f32_16x16x32_bf16 v[36:39], v[188:191], v[176:179], v[36:39]
    v_add_u32 v5, s55, v9
    v_mfma_f32_16x16x32_bf16 v[40:43], v[188:191], v[180:183], v[40:43]
    ds_read_b64_tr_b16 v[204:205], v16 offset:128
    s_waitcnt lgkmcnt(5)
    v_mfma_f32_16x16x32_bf16 v[56:59], v[192:195], v[180:183], v[56:59]
    ds_read_b64_tr_b16 v[206:207], v16 offset:6272
    v_add_u32 v6, s55, v10
    v_mfma_f32_16x16x32_bf16 v[52:55], v[192:195], v[176:179], v[52:55]
    v_mfma_f32_16x16x32_bf16 v[128:131], v[192:195], v[184:187], v[128:131]
    v_add_u32 v7, s55, v11
    s_add_u32 s56, s56, 16384
    s_cmp_ge_u32 s56, 72704
    v_mfma_f32_16x16x32_bf16 v[48:51], v[192:195], v[172:175], v[48:51]
    ds_read_b64_tr_b16 v[208:209], v17 offset:128
    s_cselect_b32 s56, 23552, s56
    v_mfma_f32_16x16x32_bf16 v[44:47], v[192:195], v[168:171], v[44:47]
    ds_read_b64_tr_b16 v[210:211], v17 offset:6272
    s_waitcnt lgkmcnt(6)
    v_mfma_f32_16x16x32_bf16 v[60:63], v[196:199], v[168:171], v[60:63]
    v_add_u32 v12, s56, v14
    v_mfma_f32_16x16x32_bf16 v[64:67], v[196:199], v[172:175], v[64:67]
    v_mfma_f32_16x16x32_bf16 v[132:135], v[196:199], v[184:187], v[132:135]
    v_mfma_f32_16x16x32_bf16 v[68:71], v[196:199], v[176:179], v[68:71]
    v_mfma_f32_16x16x32_bf16 v[72:75], v[196:199], v[180:183], v[72:75]
    v_add_u32 v13, s56, v15
    s_sub_u32 s57, s57, 1
    s_waitcnt lgkmcnt(4)
    v_mfma_f32_16x16x32_bf16 v[88:91], v[200:203], v[180:183], v[88:91]
    s_barrier
    ds_read_b64_tr_b16 v[188:189], v4 offset:0
    v_mfma_f32_16x16x32_bf16 v[84:87], v[200:203], v[176:179], v[84:87]
    ds_read_b64_tr_b16 v[190:191], v4 offset:6144
    s_cmp_lg_u32 s57, 0
    v_mfma_f32_16x16x32_bf16 v[80:83], v[200:203], v[172:175], v[80:83]
    ds_read_b128 v[152:155], v12 offset:0
    v_mfma_f32_16x16x32_bf16 v[76:79], v[200:203], v[168:171], v[76:79]
    ds_read_b128 v[156:159], v12 offset:2048
    s_waitcnt lgkmcnt(6)
    v_mfma_f32_16x16x32_bf16 v[92:95], v[204:207], v[168:171], v[92:95]
    ds_read_b128 v[160:163], v12 offset:4096
    v_mfma_f32_16x16x32_bf16 v[96:99], v[204:207], v[172:175], v[96:99]
    ds_read_b128 v[164:167], v12 offset:6144
    v_mfma_f32_16x16x32_bf16 v[100:103], v[204:207], v[176:179], v[100:103]
    ds_read_b64_tr_b16 v[192:193], v5 offset:0
    v_mfma_f32_16x16x32_bf16 v[104:107], v[204:207], v[180:183], v[104:107]
    ds_read_b64_tr_b16 v[194:195], v5 offset:6144
    s_waitcnt lgkmcnt(8)
    v_mfma_f32_16x16x32_bf16 v[120:123], v[208:211], v[180:183], v[120:123]
    ds_read_b64_tr_b16 v[196:197], v6 offset:0
    v_mfma_f32_16x16x32_bf16 v[116:119], v[208:211], v[176:179], v[116:119]
    ds_read_b64_tr_b16 v[198:199], v6 offset:6144
    v_mfma_f32_16x16x32_bf16 v[112:115], v[208:211], v[172:175], v[112:115]
    v_mfma_f32_16x16x32_bf16 v[108:111], v[208:211], v[168:171], v[108:111]
    s_cbranch_scc1 LFC0_loop
    s_mov_b32 exec_lo, 0x00010001
    s_mov_b32 exec_hi, 0x00010001
    ds_write_b128 v242, v[124:127] offset:1920
    ds_write_b128 v242, v[128:131] offset:1984
    ds_write_b128 v242, v[132:135] offset:2048
    s_mov_b64 exec, -1
LFC_common:
    s_waitcnt vmcnt(0) lgkmcnt(0)
    ds_read_b32 v136, v241 offset:0
    ds_read_b32 v137, v241 offset:640
    ds_read_b32 v144, v241 offset:1280
    ds_read_b32 v138, v241 offset:64
    ds_read_b32 v139, v241 offset:704
    ds_read_b32 v146, v241 offset:1344
    ds_read_b32 v140, v241 offset:128
    ds_read_b32 v141, v241 offset:768
    ds_read_b32 v148, v241 offset:1408
    ds_read_b32 v142, v241 offset:192
    ds_read_b32 v143, v241 offset:832
    ds_read_b32 v150, v241 offset:1472
    s_barrier
    s_waitcnt lgkmcnt(6)
    ds_read_b128 v[152:155], v242 offset:1920
    ds_read_b128 v[156:159], v242 offset:1984
    ds_read_b128 v[160:163], v242 offset:2048
    ds_read_b128 v[164:167], v242 offset:2112
    ds_read_b128 v[168:171], v242 offset:2176
    ds_read_b128 v[172:175], v242 offset:2240
    s_waitcnt lgkmcnt(4)
    v_pk_fma_f32 v[28:29], v[152:153], v[136:137], v[28:29] op_sel_hi:[1,0,1]
    v_pk_fma_f32 v[30:31], v[154:155], v[136:137], v[30:31] op_sel_hi:[1,0,1]
    v_pk_fma_f32 v[44:45], v[156:157], v[136:137], v[44:45] op_sel_hi:[1,0,1]
    v_pk_fma_f32 v[46:47], v[158:159], v[136:137], v[46:47] op_sel_hi:[1,0,1]
    v_pk_mul_f32 v[182:183], v[28:29], v[136:137] op_sel:[0,1] op_sel_hi:[1,1]
    v_pk_mul_f32 v[184:185], v[30:31], v[136:137] op_sel:[0,1] op_sel_hi:[1,1]
    v_pk_mul_f32 v[186:187], v[44:45], v[136:137] op_sel:[0,1] op_sel_hi:[1,1]
    v_pk_mul_f32 v[188:189], v[46:47], v[136:137] op_sel:[0,1] op_sel_hi:[1,1]
    v_exp_f32 v182, v182
    v_exp_f32 v183, v183
    v_exp_f32 v184, v184
    v_exp_f32 v185, v185
    v_exp_f32 v186, v186
    v_exp_f32 v187, v187
    v_exp_f32 v188, v188
    v_exp_f32 v189, v189
    v_pk_fma_f32 v[182:183], v[182:183], v[144:145], v[144:145] op_sel_hi:[1,0,0]
    v_pk_fma_f32 v[184:185], v[184:185], v[144:145], v[144:145] op_sel_hi:[1,0,0]
    v_pk_fma_f32 v[186:187], v[186:187], v[144:145], v[144:145] op_sel_hi:[1,0,0]
    v_pk_fma_f32 v[188:189], v[188:189], v[144:145], v[144:145] op_sel_hi:[1,0,0]
    v_rcp_f32 v182, v182
    v_rcp_f32 v183, v183
    v_rcp_f32 v184, v184
    v_rcp_f32 v185, v185
    v_rcp_f32 v186, v186
    v_rcp_f32 v187, v187
    v_rcp_f32 v188, v188
    v_rcp_f32 v189, v189
    v_pk_mul_f32 v[28:29], v[28:29], v[182:183]
    v_pk_mul_f32 v[30:31], v[30:31], v[184:185]
    v_pk_mul_f32 v[44:45], v[44:45], v[186:187]
    v_pk_mul_f32 v[46:47], v[46:47], v[188:189]
    v_cvt_pk_bf16_f32 v28, v28, v29
    v_cvt_pk_bf16_f32 v29, v30, v31
    v_cvt_pk_bf16_f32 v30, v44, v45
    v_cvt_pk_bf16_f32 v31, v46, v47
    s_waitcnt lgkmcnt(0)
    v_pk_fma_f32 v[32:33], v[152:153], v[138:139], v[32:33] op_sel_hi:[1,0,1]
    v_pk_fma_f32 v[34:35], v[154:155], v[138:139], v[34:35] op_sel_hi:[1,0,1]
    v_pk_fma_f32 v[48:49], v[156:157], v[138:139], v[48:49] op_sel_hi:[1,0,1]
    v_pk_fma_f32 v[50:51], v[158:159], v[138:139], v[50:51] op_sel_hi:[1,0,1]
    v_pk_mul_f32 v[190:191], v[32:33], v[138:139] op_sel:[0,1] op_sel_hi:[1,1]
    v_pk_mul_f32 v[192:193], v[34:35], v[138:139] op_sel:[0,1] op_sel_hi:[1,1]
    v_pk_mul_f32 v[194:195], v[48:49], v[138:139] op_sel:[0,1] op_sel_hi:[1,1]
    v_pk_mul_f32 v[196:197], v[50:51], v[138:139] op_sel:[0,1] op_sel_hi:[1,1]
    v_exp_f32 v190, v190
    v_exp_f32 v191, v191
    v_exp_f32 v192, v192
    v_exp_f32 v193, v193
    v_exp_f32 v194, v194
    v_exp_f32 v195, v195
    v_exp_f32 v196, v196
    v_exp_f32 v197, v197
    v_pk_fma_f32 v[190:191], v[190:191], v[146:147], v[146:147] op_sel_hi:[1,0,0]
    v_pk_fma_f32 v[192:193], v[192:193], v[146:147], v[146:147] op_sel_hi:[1,0,0]
    v_pk_fma_f32 v[194:195], v[194:195], v[146:147], v[146:147] op_sel_hi:[1,0,0]
    v_pk_fma_f32 v[196:197], v[196:197], v[146:147], v[146:147] op_sel_hi:[1,0,0]
    v_rcp_f32 v190, v190
    v_rcp_f32 v191, v191
    v_rcp_f32 v192, v192
    v_rcp_f32 v193, v193
    v_rcp_f32 v194, v194
    v_rcp_f32 v195, v195
    v_rcp_f32 v196, v196
    v_rcp_f32 v197, v197
    v_pk_mul_f32 v[32:33], v[32:33], v[190:191]
    v_pk_mul_f32 v[34:35], v[34:35], v[192:193]
    v_pk_mul_f32 v[48:49], v[48:49], v[194:195]
    v_pk_mul_f32 v[50:51], v[50:51], v[196:197]
    v_cvt_pk_bf16_f32 v32, v32, v33
    v_cvt_pk_bf16_f32 v33, v34, v35
    v_cvt_pk_bf16_f32 v34, v48, v49
    v_cvt_pk_bf16_f32 v35, v50, v51
    v_pk_fma_f32 v[36:37], v[152:153], v[140:141], v[36:37] op_sel_hi:[1,0,1]
    v_pk_fma_f32 v[38:39], v[154:155], v[140:141], v[38:39] op_sel_hi:[1,0,1]
    v_pk_fma_f32 v[52:53], v[156:157], v[140:141], v[52:53] op_sel_hi:[1,0,1]
    v_pk_fma_f32 v[54:55], v[158:159], v[140:141], v[54:55] op_sel_hi:[1,0,1]
    v_pk_mul_f32 v[182:183], v[36:37], v[140:141] op_sel:[0,1] op_sel_hi:[1,1]
    v_pk_mul_f32 v[184:185], v[38:39], v[140:141] op_sel:[0,1] op_sel_hi:[1,1]
    v_pk_mul_f32 v[186:187], v[52:53], v[140:141] op_sel:[0,1] op_sel_hi:[1,1]
    v_pk_mul_f32 v[188:189], v[54:55], v[140:141] op_sel:[0,1] op_sel_hi:[1,1]
    v_exp_f32 v182, v182
    v_exp_f32 v183, v183
    v_exp_f32 v184, v184
    v_exp_f32 v185, v185
    v_exp_f32 v186, v186
    v_exp_f32 v187, v187
    v_exp_f32 v188, v188
    v_exp_f32 v189, v189
    v_pk_fma_f32 v[182:183], v[182:183], v[148:149], v[148:149] op_sel_hi:[1,0,0]
    v_pk_fma_f32 v[184:185], v[184:185], v[148:149], v[148:149] op_sel_hi:[1,0,0]
    v_pk_fma_f32 v[186:187], v[186:187], v[148:149], v[148:149] op_sel_hi:[1,0,0]
    v_pk_fma_f32 v[188:189], v[188:189], v[148:149], v[148:149] op_sel_hi:[1,0,0]
    v_rcp_f32 v182, v182
    v_rcp_f32 v183, v183
    v_rcp_f32 v184, v184
    v_rcp_f32 v185, v185
    v_rcp_f32 v186, v186
    v_rcp_f32 v187, v187
    v_rcp_f32 v188, v188
    v_rcp_f32 v189, v189
    v_pk_mul_f32 v[36:37], v[36:37], v[182:183]
    v_pk_mul_f32 v[38:39], v[38:39], v[184:185]
    v_pk_mul_f32 v[52:53], v[52:53], v[186:187]
    v_pk_mul_f32 v[54:55], v[54:55], v[188:189]
    v_cvt_pk_bf16_f32 v36, v36, v37
    v_cvt_pk_bf16_f32 v37, v38, v39
    v_cvt_pk_bf16_f32 v38, v52, v53
    v_cvt_pk_bf16_f32 v39, v54, v55
    v_pk_fma_f32 v[40:41], v[152:153], v[142:143], v[40:41] op_sel_hi:[1,0,1]
    v_pk_fma_f32 v[42:43], v[154:155], v[142:143], v[42:43] op_sel_hi:[1,0,1]
    v_pk_fma_f32 v[56:57], v[156:157], v[142:143], v[56:57] op_sel_hi:[1,0,1]
    v_pk_fma_f32 v[58:59], v[158:159], v[142:143], v[58:59] op_sel_hi:[1,0,1]
    v_pk_mul_f32 v[190:191], v[40:41], v[142:143] op_sel:[0,1] op_sel_hi:[1,1]
    v_pk_mul_f32 v[192:193], v[42:43], v[142:143] op_sel:[0,1] op_sel_hi:[1,1]
    v_pk_mul_f32 v[194:195], v[56:57], v[142:143] op_sel:[0,1] op_sel_hi:[1,1]
    v_pk_mul_f32 v[196:197], v[58:59], v[142:143] op_sel:[0,1] op_sel_hi:[1,1]
    v_exp_f32 v190, v190
    v_exp_f32 v191, v191
    v_exp_f32 v192, v192
    v_exp_f32 v193, v193
    v_exp_f32 v194, v194
    v_exp_f32 v195, v195
    v_exp_f32 v196, v196
    v_exp_f32 v197, v197
    v_pk_fma_f32 v[190:191], v[190:191], v[150:151], v[150:151] op_sel_hi:[1,0,0]
    v_pk_fma_f32 v[192:193], v[192:193], v[150:151], v[150:151] op_sel_hi:[1,0,0]
    v_pk_fma_f32 v[194:195], v[194:195], v[150:151], v[150:151] op_sel_hi:[1,0,0]
    v_pk_fma_f32 v[196:197], v[196:197], v[150:151], v[150:151] op_sel_hi:[1,0,0]
    v_rcp_f32 v190, v190
    v_rcp_f32 v191, v191
    v_rcp_f32 v192, v192
    v_rcp_f32 v193, v193
    v_rcp_f32 v194, v194
    v_rcp_f32 v195, v195
    v_rcp_f32 v196, v196
    v_rcp_f32 v197, v197
    v_pk_mul_f32 v[40:41], v[40:41], v[190:191]
    v_pk_mul_f32 v[42:43], v[42:43], v[192:193]
    v_pk_mul_f32 v[56:57], v[56:57], v[194:195]
    v_pk_mul_f32 v[58:59], v[58:59], v[196:197]
    v_cvt_pk_bf16_f32 v40, v40, v41
    v_cvt_pk_bf16_f32 v41, v42, v43
    v_cvt_pk_bf16_f32 v42, v56, v57
    v_cvt_pk_bf16_f32 v43, v58, v59
    buffer_store_dwordx4 v[28:31], v251, s[36:39], s59 offen offset:0 sc1
    buffer_store_dwordx4 v[32:35], v251, s[36:39], s59 offen offset:2048 sc1
    buffer_store_dwordx4 v[36:39], v250, s[36:39], s59 offen offset:0 sc1
    buffer_store_dwordx4 v[40:43], v250, s[36:39], s59 offen offset:2048 sc1
    v_pk_fma_f32 v[60:61], v[160:161], v[136:137], v[60:61] op_sel_hi:[1,0,1]
    v_pk_fma_f32 v[62:63], v[162:163], v[136:137], v[62:63] op_sel_hi:[1,0,1]
    v_pk_fma_f32 v[76:77], v[164:165], v[136:137], v[76:77] op_sel_hi:[1,0,1]
    v_pk_fma_f32 v[78:79], v[166:167], v[136:137], v[78:79] op_sel_hi:[1,0,1]
    v_pk_mul_f32 v[182:183], v[60:61], v[136:137] op_sel:[0,1] op_sel_hi:[1,1]
    v_pk_mul_f32 v[184:185], v[62:63], v[136:137] op_sel:[0,1] op_sel_hi:[1,1]
    v_pk_mul_f32 v[186:187], v[76:77], v[136:137] op_sel:[0,1] op_sel_hi:[1,1]
    v_pk_mul_f32 v[188:189], v[78:79], v[136:137] op_sel:[0,1] op_sel_hi:[1,1]
    v_exp_f32 v182, v182
    v_exp_f32 v183, v183
    v_exp_f32 v184, v184
    v_exp_f32 v185, v185
    v_exp_f32 v186, v186
    v_exp_f32 v187, v187
    v_exp_f32 v188, v188
    v_exp_f32 v189, v189
    v_pk_fma_f32 v[182:183], v[182:183], v[144:145], v[144:145] op_sel_hi:[1,0,0]
    v_pk_fma_f32 v[184:185], v[184:185], v[144:145], v[144:145] op_sel_hi:[1,0,0]
    v_pk_fma_f32 v[186:187], v[186:187], v[144:145], v[144:145] op_sel_hi:[1,0,0]
    v_pk_fma_f32 v[188:189], v[188:189], v[144:145], v[144:145] op_sel_hi:[1,0,0]
    v_rcp_f32 v182, v182
    v_rcp_f32 v183, v183
    v_rcp_f32 v184, v184
    v_rcp_f32 v185, v185
    v_rcp_f32 v186, v186
    v_rcp_f32 v187, v187
    v_rcp_f32 v188, v188
    v_rcp_f32 v189, v189
    v_pk_mul_f32 v[60:61], v[60:61], v[182:183]
    v_pk_mul_f32 v[62:63], v[62:63], v[184:185]
    v_pk_mul_f32 v[76:77], v[76:77], v[186:187]
    v_pk_mul_f32 v[78:79], v[78:79], v[188:189]
    v_cvt_pk_bf16_f32 v60, v60, v61
    v_cvt_pk_bf16_f32 v61, v62, v63
    v_cvt_pk_bf16_f32 v62, v76, v77
    v_cvt_pk_bf16_f32 v63, v78, v79
    buffer_store_dwordx4 v[60:63], v251, s[36:39], s60 offen offset:0 sc1
    v_pk_fma_f32 v[64:65], v[160:161], v[138:139], v[64:65] op_sel_hi:[1,0,1]
    v_pk_fma_f32 v[66:67], v[162:163], v[138:139], v[66:67] op_sel_hi:[1,0,1]
    v_pk_fma_f32 v[80:81], v[164:165], v[138:139], v[80:81] op_sel_hi:[1,0,1]
    v_pk_fma_f32 v[82:83], v[166:167], v[138:139], v[82:83] op_sel_hi:[1,0,1]
    v_pk_mul_f32 v[190:191], v[64:65], v[138:139] op_sel:[0,1] op_sel_hi:[1,1]
    v_pk_mul_f32 v[192:193], v[66:67], v[138:139] op_sel:[0,1] op_sel_hi:[1,1]
    v_pk_mul_f32 v[194:195], v[80:81], v[138:139] op_sel:[0,1] op_sel_hi:[1,1]
    v_pk_mul_f32 v[196:197], v[82:83], v[138:139] op_sel:[0,1] op_sel_hi:[1,1]
    v_exp_f32 v190, v190
    v_exp_f32 v191, v191
    v_exp_f32 v192, v192
    v_exp_f32 v193, v193
    v_exp_f32 v194, v194
    v_exp_f32 v195, v195
    v_exp_f32 v196, v196
    v_exp_f32 v197, v197
    v_pk_fma_f32 v[190:191], v[190:191], v[146:147], v[146:147] op_sel_hi:[1,0,0]
    v_pk_fma_f32 v[192:193], v[192:193], v[146:147], v[146:147] op_sel_hi:[1,0,0]
    v_pk_fma_f32 v[194:195], v[194:195], v[146:147], v[146:147] op_sel_hi:[1,0,0]
    v_pk_fma_f32 v[196:197], v[196:197], v[146:147], v[146:147] op_sel_hi:[1,0,0]
    v_rcp_f32 v190, v190
    v_rcp_f32 v191, v191
    v_rcp_f32 v192, v192
    v_rcp_f32 v193, v193
    v_rcp_f32 v194, v194
    v_rcp_f32 v195, v195
    v_rcp_f32 v196, v196
    v_rcp_f32 v197, v197
    v_pk_mul_f32 v[64:65], v[64:65], v[190:191]
    v_pk_mul_f32 v[66:67], v[66:67], v[192:193]
    v_pk_mul_f32 v[80:81], v[80:81], v[194:195]
    v_pk_mul_f32 v[82:83], v[82:83], v[196:197]
    v_cvt_pk_bf16_f32 v64, v64, v65
    v_cvt_pk_bf16_f32 v65, v66, v67
    v_cvt_pk_bf16_f32 v66, v80, v81
    v_cvt_pk_bf16_f32 v67, v82, v83
    buffer_store_dwordx4 v[64:67], v251, s[36:39], s60 offen offset:2048 sc1
    v_pk_fma_f32 v[68:69], v[160:161], v[140:141], v[68:69] op_sel_hi:[1,0,1]
    v_pk_fma_f32 v[70:71], v[162:163], v[140:141], v[70:71] op_sel_hi:[1,0,1]
    v_pk_fma_f32 v[84:85], v[164:165], v[140:141], v[84:85] op_sel_hi:[1,0,1]
    v_pk_fma_f32 v[86:87], v[166:167], v[140:141], v[86:87] op_sel_hi:[1,0,1]
    v_pk_mul_f32 v[182:183], v[68:69], v[140:141] op_sel:[0,1] op_sel_hi:[1,1]
    v_pk_mul_f32 v[184:185], v[70:71], v[140:141] op_sel:[0,1] op_sel_hi:[1,1]
    v_pk_mul_f32 v[186:187], v[84:85], v[140:141] op_sel:[0,1] op_sel_hi:[1,1]
    v_pk_mul_f32 v[188:189], v[86:87], v[140:141] op_sel:[0,1] op_sel_hi:[1,1]
    v_exp_f32 v182, v182
    v_exp_f32 v183, v183
    v_exp_f32 v184, v184
    v_exp_f32 v185, v185
    v_exp_f32 v186, v186
    v_exp_f32 v187, v187
    v_exp_f32 v188, v188
    v_exp_f32 v189, v189
    v_pk_fma_f32 v[182:183], v[182:183], v[148:149], v[148:149] op_sel_hi:[1,0,0]
    v_pk_fma_f32 v[184:185], v[184:185], v[148:149], v[148:149] op_sel_hi:[1,0,0]
    v_pk_fma_f32 v[186:187], v[186:187], v[148:149], v[148:149] op_sel_hi:[1,0,0]
    v_pk_fma_f32 v[188:189], v[188:189], v[148:149], v[148:149] op_sel_hi:[1,0,0]
    v_rcp_f32 v182, v182
    v_rcp_f32 v183, v183
    v_rcp_f32 v184, v184
    v_rcp_f32 v185, v185
    v_rcp_f32 v186, v186
    v_rcp_f32 v187, v187
    v_rcp_f32 v188, v188
    v_rcp_f32 v189, v189
    v_pk_mul_f32 v[68:69], v[68:69], v[182:183]
    v_pk_mul_f32 v[70:71], v[70:71], v[184:185]
    v_pk_mul_f32 v[84:85], v[84:85], v[186:187]
    v_pk_mul_f32 v[86:87], v[86:87], v[188:189]
    v_cvt_pk_bf16_f32 v68, v68, v69
    v_cvt_pk_bf16_f32 v69, v70, v71
    v_cvt_pk_bf16_f32 v70, v84, v85
    v_cvt_pk_bf16_f32 v71, v86, v87
    buffer_store_dwordx4 v[68:71], v250, s[36:39], s60 offen offset:0 sc1
    v_pk_fma_f32 v[72:73], v[160:161], v[142:143], v[72:73] op_sel_hi:[1,0,1]
    v_pk_fma_f32 v[74:75], v[162:163], v[142:143], v[74:75] op_sel_hi:[1,0,1]
    v_pk_fma_f32 v[88:89], v[164:165], v[142:143], v[88:89] op_sel_hi:[1,0,1]
    v_pk_fma_f32 v[90:91], v[166:167], v[142:143], v[90:91] op_sel_hi:[1,0,1]
    v_pk_mul_f32 v[190:191], v[72:73], v[142:143] op_sel:[0,1] op_sel_hi:[1,1]
    v_pk_mul_f32 v[192:193], v[74:75], v[142:143] op_sel:[0,1] op_sel_hi:[1,1]
    v_pk_mul_f32 v[194:195], v[88:89], v[142:143] op_sel:[0,1] op_sel_hi:[1,1]
    v_pk_mul_f32 v[196:197], v[90:91], v[142:143] op_sel:[0,1] op_sel_hi:[1,1]
    v_exp_f32 v190, v190
    v_exp_f32 v191, v191
    v_exp_f32 v192, v192
    v_exp_f32 v193, v193
    v_exp_f32 v194, v194
    v_exp_f32 v195, v195
    v_exp_f32 v196, v196
    v_exp_f32 v197, v197
    v_pk_fma_f32 v[190:191], v[190:191], v[150:151], v[150:151] op_sel_hi:[1,0,0]
    v_pk_fma_f32 v[192:193], v[192:193], v[150:151], v[150:151] op_sel_hi:[1,0,0]
    v_pk_fma_f32 v[194:195], v[194:195], v[150:151], v[150:151] op_sel_hi:[1,0,0]
    v_pk_fma_f32 v[196:197], v[196:197], v[150:151], v[150:151] op_sel_hi:[1,0,0]
    v_rcp_f32 v190, v190
    v_rcp_f32 v191, v191
    v_rcp_f32 v192, v192
    v_rcp_f32 v193, v193
    v_rcp_f32 v194, v194
    v_rcp_f32 v195, v195
    v_rcp_f32 v196, v196
    v_rcp_f32 v197, v197
    v_pk_mul_f32 v[72:73], v[72:73], v[190:191]
    v_pk_mul_f32 v[74:75], v[74:75], v[192:193]
    v_pk_mul_f32 v[88:89], v[88:89], v[194:195]
    v_pk_mul_f32 v[90:91], v[90:91], v[196:197]
    v_cvt_pk_bf16_f32 v72, v72, v73
    v_cvt_pk_bf16_f32 v73, v74, v75
    v_cvt_pk_bf16_f32 v74, v88, v89
    v_cvt_pk_bf16_f32 v75, v90, v91
    buffer_store_dwordx4 v[72:75], v250, s[36:39], s60 offen offset:2048 sc1
    v_pk_fma_f32 v[92:93], v[168:169], v[136:137], v[92:93] op_sel_hi:[1,0,1]
    v_pk_fma_f32 v[94:95], v[170:171], v[136:137], v[94:95] op_sel_hi:[1,0,1]
    v_pk_fma_f32 v[108:109], v[172:173], v[136:137], v[108:109] op_sel_hi:[1,0,1]
    v_pk_fma_f32 v[110:111], v[174:175], v[136:137], v[110:111] op_sel_hi:[1,0,1]
    v_pk_mul_f32 v[182:183], v[92:93], v[136:137] op_sel:[0,1] op_sel_hi:[1,1]
    v_pk_mul_f32 v[184:185], v[94:95], v[136:137] op_sel:[0,1] op_sel_hi:[1,1]
    v_pk_mul_f32 v[186:187], v[108:109], v[136:137] op_sel:[0,1] op_sel_hi:[1,1]
    v_pk_mul_f32 v[188:189], v[110:111], v[136:137] op_sel:[0,1] op_sel_hi:[1,1]
    v_exp_f32 v182, v182
    v_exp_f32 v183, v183
    v_exp_f32 v184, v184
    v_exp_f32 v185, v185
    v_exp_f32 v186, v186
    v_exp_f32 v187, v187
    v_exp_f32 v188, v188
    v_exp_f32 v189, v189
    v_pk_fma_f32 v[182:183], v[182:183], v[144:145], v[144:145] op_sel_hi:[1,0,0]
    v_pk_fma_f32 v[184:185], v[184:185], v[144:145], v[144:145] op_sel_hi:[1,0,0]
    v_pk_fma_f32 v[186:187], v[186:187], v[144:145], v[144:145] op_sel_hi:[1,0,0]
    v_pk_fma_f32 v[188:189], v[188:189], v[144:145], v[144:145] op_sel_hi:[1,0,0]
    v_rcp_f32 v182, v182
    v_rcp_f32 v183, v183
    v_rcp_f32 v184, v184
    v_rcp_f32 v185, v185
    v_rcp_f32 v186, v186
    v_rcp_f32 v187, v187
    v_rcp_f32 v188, v188
    v_rcp_f32 v189, v189
    v_pk_mul_f32 v[92:93], v[92:93], v[182:183]
    v_pk_mul_f32 v[94:95], v[94:95], v[184:185]
    v_pk_mul_f32 v[108:109], v[108:109], v[186:187]
    v_pk_mul_f32 v[110:111], v[110:111], v[188:189]
    v_cvt_pk_bf16_f32 v92, v92, v93
    v_cvt_pk_bf16_f32 v93, v94, v95
    v_cvt_pk_bf16_f32 v94, v108, v109
    v_cvt_pk_bf16_f32 v95, v110, v111
    buffer_store_dwordx4 v[92:95], v251, s[36:39], s61 offen offset:0 sc1
    v_pk_fma_f32 v[96:97], v[168:169], v[138:139], v[96:97] op_sel_hi:[1,0,1]
    v_pk_fma_f32 v[98:99], v[170:171], v[138:139], v[98:99] op_sel_hi:[1,0,1]
    v_pk_fma_f32 v[112:113], v[172:173], v[138:139], v[112:113] op_sel_hi:[1,0,1]
    v_pk_fma_f32 v[114:115], v[174:175], v[138:139], v[114:115] op_sel_hi:[1,0,1]
    v_pk_mul_f32 v[190:191], v[96:97], v[138:139] op_sel:[0,1] op_sel_hi:[1,1]
    v_pk_mul_f32 v[192:193], v[98:99], v[138:139] op_sel:[0,1] op_sel_hi:[1,1]
    v_pk_mul_f32 v[194:195], v[112:113], v[138:139] op_sel:[0,1] op_sel_hi:[1,1]
    v_pk_mul_f32 v[196:197], v[114:115], v[138:139] op_sel:[0,1] op_sel_hi:[1,1]
    v_exp_f32 v190, v190
    v_exp_f32 v191, v191
    v_exp_f32 v192, v192
    v_exp_f32 v193, v193
    v_exp_f32 v194, v194
    v_exp_f32 v195, v195
    v_exp_f32 v196, v196
    v_exp_f32 v197, v197
    v_pk_fma_f32 v[190:191], v[190:191], v[146:147], v[146:147] op_sel_hi:[1,0,0]
    v_pk_fma_f32 v[192:193], v[192:193], v[146:147], v[146:147] op_sel_hi:[1,0,0]
    v_pk_fma_f32 v[194:195], v[194:195], v[146:147], v[146:147] op_sel_hi:[1,0,0]
    v_pk_fma_f32 v[196:197], v[196:197], v[146:147], v[146:147] op_sel_hi:[1,0,0]
    v_rcp_f32 v190, v190
    v_rcp_f32 v191, v191
    v_rcp_f32 v192, v192
    v_rcp_f32 v193, v193
    v_rcp_f32 v194, v194
    v_rcp_f32 v195, v195
    v_rcp_f32 v196, v196
    v_rcp_f32 v197, v197
    v_pk_mul_f32 v[96:97], v[96:97], v[190:191]
    v_pk_mul_f32 v[98:99], v[98:99], v[192:193]
    v_pk_mul_f32 v[112:113], v[112:113], v[194:195]
    v_pk_mul_f32 v[114:115], v[114:115], v[196:197]
    v_cvt_pk_bf16_f32 v96, v96, v97
    v_cvt_pk_bf16_f32 v97, v98, v99
    v_cvt_pk_bf16_f32 v98, v112, v113
    v_cvt_pk_bf16_f32 v99, v114, v115
    buffer_store_dwordx4 v[96:99], v251, s[36:39], s61 offen offset:2048 sc1
    v_pk_fma_f32 v[100:101], v[168:169], v[140:141], v[100:101] op_sel_hi:[1,0,1]
    v_pk_fma_f32 v[102:103], v[170:171], v[140:141], v[102:103] op_sel_hi:[1,0,1]
    v_pk_fma_f32 v[116:117], v[172:173], v[140:141], v[116:117] op_sel_hi:[1,0,1]
    v_pk_fma_f32 v[118:119], v[174:175], v[140:141], v[118:119] op_sel_hi:[1,0,1]
    v_pk_mul_f32 v[182:183], v[100:101], v[140:141] op_sel:[0,1] op_sel_hi:[1,1]
    v_pk_mul_f32 v[184:185], v[102:103], v[140:141] op_sel:[0,1] op_sel_hi:[1,1]
    v_pk_mul_f32 v[186:187], v[116:117], v[140:141] op_sel:[0,1] op_sel_hi:[1,1]
    v_pk_mul_f32 v[188:189], v[118:119], v[140:141] op_sel:[0,1] op_sel_hi:[1,1]
    v_exp_f32 v182, v182
    v_exp_f32 v183, v183
    v_exp_f32 v184, v184
    v_exp_f32 v185, v185
    v_exp_f32 v186, v186
    v_exp_f32 v187, v187
    v_exp_f32 v188, v188
    v_exp_f32 v189, v189
    v_pk_fma_f32 v[182:183], v[182:183], v[148:149], v[148:149] op_sel_hi:[1,0,0]
    v_pk_fma_f32 v[184:185], v[184:185], v[148:149], v[148:149] op_sel_hi:[1,0,0]
    v_pk_fma_f32 v[186:187], v[186:187], v[148:149], v[148:149] op_sel_hi:[1,0,0]
    v_pk_fma_f32 v[188:189], v[188:189], v[148:149], v[148:149] op_sel_hi:[1,0,0]
    v_rcp_f32 v182, v182
    v_rcp_f32 v183, v183
    v_rcp_f32 v184, v184
    v_rcp_f32 v185, v185
    v_rcp_f32 v186, v186
    v_rcp_f32 v187, v187
    v_rcp_f32 v188, v188
    v_rcp_f32 v189, v189
    v_pk_mul_f32 v[100:101], v[100:101], v[182:183]
    v_pk_mul_f32 v[102:103], v[102:103], v[184:185]
    v_pk_mul_f32 v[116:117], v[116:117], v[186:187]
    v_pk_mul_f32 v[118:119], v[118:119], v[188:189]
    v_cvt_pk_bf16_f32 v100, v100, v101
    v_cvt_pk_bf16_f32 v101, v102, v103
    v_cvt_pk_bf16_f32 v102, v116, v117
    v_cvt_pk_bf16_f32 v103, v118, v119
    buffer_store_dwordx4 v[100:103], v250, s[36:39], s61 offen offset:0 sc1
    v_pk_fma_f32 v[104:105], v[168:169], v[142:143], v[104:105] op_sel_hi:[1,0,1]
    v_pk_fma_f32 v[106:107], v[170:171], v[142:143], v[106:107] op_sel_hi:[1,0,1]
    v_pk_fma_f32 v[120:121], v[172:173], v[142:143], v[120:121] op_sel_hi:[1,0,1]
    v_pk_fma_f32 v[122:123], v[174:175], v[142:143], v[122:123] op_sel_hi:[1,0,1]
    v_pk_mul_f32 v[190:191], v[104:105], v[142:143] op_sel:[0,1] op_sel_hi:[1,1]
    v_pk_mul_f32 v[192:193], v[106:107], v[142:143] op_sel:[0,1] op_sel_hi:[1,1]
    v_pk_mul_f32 v[194:195], v[120:121], v[142:143] op_sel:[0,1] op_sel_hi:[1,1]
    v_pk_mul_f32 v[196:197], v[122:123], v[142:143] op_sel:[0,1] op_sel_hi:[1,1]
    v_exp_f32 v190, v190
    v_exp_f32 v191, v191
    v_exp_f32 v192, v192
    v_exp_f32 v193, v193
    v_exp_f32 v194, v194
    v_exp_f32 v195, v195
    v_exp_f32 v196, v196
    v_exp_f32 v197, v197
    v_pk_fma_f32 v[190:191], v[190:191], v[150:151], v[150:151] op_sel_hi:[1,0,0]
    v_pk_fma_f32 v[192:193], v[192:193], v[150:151], v[150:151] op_sel_hi:[1,0,0]
    v_pk_fma_f32 v[194:195], v[194:195], v[150:151], v[150:151] op_sel_hi:[1,0,0]
    v_pk_fma_f32 v[196:197], v[196:197], v[150:151], v[150:151] op_sel_hi:[1,0,0]
    v_rcp_f32 v190, v190
    v_rcp_f32 v191, v191
    v_rcp_f32 v192, v192
    v_rcp_f32 v193, v193
    v_rcp_f32 v194, v194
    v_rcp_f32 v195, v195
    v_rcp_f32 v196, v196
    v_rcp_f32 v197, v197
    v_pk_mul_f32 v[104:105], v[104:105], v[190:191]
    v_pk_mul_f32 v[106:107], v[106:107], v[192:193]
    v_pk_mul_f32 v[120:121], v[120:121], v[194:195]
    v_pk_mul_f32 v[122:123], v[122:123], v[196:197]
    v_cvt_pk_bf16_f32 v104, v104, v105
    v_cvt_pk_bf16_f32 v105, v106, v107
    v_cvt_pk_bf16_f32 v106, v120, v121
    v_cvt_pk_bf16_f32 v107, v122, v123
    buffer_store_dwordx4 v[104:107], v250, s[36:39], s61 offen offset:2048 sc1
    s_mov_b32 s56, 0xffff0000
    s_waitcnt vmcnt(0)
    v_mov_b32 v12, 1
    v_mov_b32 v13, 0
    s_mov_b64 exec, 1
    ds_add_rtn_u32 v14, v13, v12 offset:3016
    s_mov_b64 exec, -1
    ds_read_b32 v16, v13 offset:3040
    ds_read_b32 v17, v13 offset:3040
    s_waitcnt lgkmcnt(0)
    v_readfirstlane_b32 s49, v14
    s_nop 0
    s_cmp_lg_u32 s49, 3
    s_cbranch_scc1 L2FC_fr
    s_mov_b64 exec, 0xffff
    buffer_store_dwordx2 v[16:17], v240, s[36:39], s9 offen offset:512 sc1
    s_mov_b64 exec, -1
L2FC_fr:
    s_barrier
    buffer_load_dwordx4 v[104:107], v251, s[28:31], s12 offen offset:0 sc1
    buffer_load_dwordx4 v[108:111], v251, s[28:31], s12 offen offset:2048 sc1
    buffer_load_dwordx4 v[112:115], v250, s[28:31], s12 offen offset:0 sc1
    s_add_u32 s12, s12, 2097152
    buffer_load_dwordx4 v[116:119], v251, s[28:31], s13 offen offset:0 sc1
    buffer_load_dwordx4 v[120:123], v251, s[28:31], s13 offen offset:2048 sc1
    buffer_load_dwordx4 v[124:127], v250, s[28:31], s13 offen offset:0 sc1
    s_add_u32 s13, s13, 2097152
    buffer_load_dwordx4 v[128:131], v251, s[28:31], s14 offen offset:0 sc1
    buffer_load_dwordx4 v[132:135], v251, s[28:31], s14 offen offset:2048 sc1
    buffer_load_dwordx4 v[136:139], v250, s[28:31], s14 offen offset:0 sc1
    s_add_u32 s14, s14, 2097152
    buffer_load_dwordx4 v[140:143], v251, s[28:31], s15 offen offset:0 sc1
    buffer_load_dwordx4 v[144:147], v251, s[28:31], s15 offen offset:2048 sc1
    buffer_load_dwordx4 v[148:151], v250, s[28:31], s15 offen offset:0 sc1
    s_add_u32 s15, s15, 2097152
    buffer_load_dwordx4 v[152:155], v251, s[28:31], s16 offen offset:0 sc1
    buffer_load_dwordx4 v[156:159], v251, s[28:31], s16 offen offset:2048 sc1
    buffer_load_dwordx4 v[160:163], v250, s[28:31], s16 offen offset:0 sc1
    s_add_u32 s16, s16, 2097152
    ds_read_b64 v[200:201], v249 offset:0
    ds_read_b64 v[202:203], v248 offset:0
    ds_read_b64 v[204:205], v249 offset:2048
    ds_read_b64 v[206:207], v248 offset:2048
    ds_read_b64 v[208:209], v249 offset:4096
    ds_read_b64 v[210:211], v248 offset:4096
    v_mov_b32 v48, 0
    v_mov_b32 v49, 0
    v_mov_b32 v50, 0
    v_mov_b32 v51, 0
    v_mov_b32 v52, 0
    v_mov_b32 v53, 0
    v_mov_b32 v54, 0
    v_mov_b32 v55, 0
    v_mov_b32 v56, 0
    v_mov_b32 v57, 0
    v_mov_b32 v58, 0
    v_mov_b32 v59, 0
    v_mov_b32 v60, 0
    v_mov_b32 v61, 0
    v_mov_b32 v62, 0
    v_mov_b32 v63, 0
    v_mov_b32 v64, 0
    v_mov_b32 v65, 0
    v_mov_b32 v66, 0
    v_mov_b32 v67, 0
    v_mov_b32 v68, 0
    v_mov_b32 v69, 0
    v_mov_b32 v70, 0
    v_mov_b32 v71, 0
    s_waitcnt lgkmcnt(0)
    v_lshlrev_b32 v24, 16, v200
    v_and_b32 v25, 0xffff0000, v200
    v_lshlrev_b32 v26, 16, v201
    v_and_b32 v27, 0xffff0000, v201
    v_lshlrev_b32 v36, 16, v202
    v_and_b32 v37, 0xffff0000, v202
    v_lshlrev_b32 v38, 16, v203
    v_and_b32 v39, 0xffff0000, v203
    v_lshlrev_b32 v28, 16, v204
    v_and_b32 v29, 0xffff0000, v204
    v_lshlrev_b32 v30, 16, v205
    v_and_b32 v31, 0xffff0000, v205
    v_lshlrev_b32 v40, 16, v206
    v_and_b32 v41, 0xffff0000, v206
    v_lshlrev_b32 v42, 16, v207
    v_and_b32 v43, 0xffff0000, v207
    v_lshlrev_b32 v32, 16, v208
    v_and_b32 v33, 0xffff0000, v208
    v_lshlrev_b32 v34, 16, v209
    v_and_b32 v35, 0xffff0000, v209
    v_lshlrev_b32 v44, 16, v210
    v_and_b32 v45, 0xffff0000, v210
    v_lshlrev_b32 v46, 16, v211
    v_and_b32 v47, 0xffff0000, v211
    ds_read_b64_tr_b16 v[72:73], v255 offset:0
    ds_read_b64_tr_b16 v[74:75], v255 offset:2048
    ds_read_b64_tr_b16 v[76:77], v254 offset:0
    ds_read_b64_tr_b16 v[78:79], v254 offset:2048
    ds_read_b64_tr_b16 v[80:81], v253 offset:0
    ds_read_b64_tr_b16 v[82:83], v253 offset:2048
    ds_read_b64_tr_b16 v[84:85], v252 offset:0
    ds_read_b64_tr_b16 v[86:87], v252 offset:2048
    s_mov_b32 s57, 4
.p2align 6
L2FC_loop:
    s_waitcnt vmcnt(12) lgkmcnt(4)
    v_mfma_f32_16x16x32_bf16 v[24:27], v[72:75], v[104:107], v[24:27]
    ds_read_b64_tr_b16 v[88:89], v255 offset:8192
    buffer_load_dwordx4 v[164:167], v251, s[28:31], s17 offen offset:0 sc1
    v_mfma_f32_16x16x32_bf16 v[28:31], v[72:75], v[108:111], v[28:31]
    ds_read_b64_tr_b16 v[90:91], v255 offset:10240
    buffer_load_dwordx4 v[168:171], v251, s[28:31], s17 offen offset:2048 sc1
    v_mfma_f32_16x16x32_bf16 v[32:35], v[72:75], v[112:115], v[32:35]
    ds_read_b64_tr_b16 v[92:93], v254 offset:8192
    buffer_load_dwordx4 v[172:175], v250, s[28:31], s17 offen offset:0 sc1
    v_mfma_f32_16x16x32_bf16 v[44:47], v[76:79], v[112:115], v[44:47]
    ds_read_b64_tr_b16 v[94:95], v254 offset:10240
    s_add_u32 s17, s17, 2097152
    v_mfma_f32_16x16x32_bf16 v[40:43], v[76:79], v[108:111], v[40:43]
    ds_read_b64_tr_b16 v[96:97], v253 offset:8192
    s_cmp_eq_u32 s57, 1
    v_mfma_f32_16x16x32_bf16 v[36:39], v[76:79], v[104:107], v[36:39]
    ds_read_b64_tr_b16 v[98:99], v253 offset:10240
    s_waitcnt lgkmcnt(6)
    v_mfma_f32_16x16x32_bf16 v[48:51], v[80:83], v[104:107], v[48:51]
    ds_read_b64_tr_b16 v[100:101], v252 offset:8192
    s_cselect_b32 s12, s4, s12
    v_mfma_f32_16x16x32_bf16 v[52:55], v[80:83], v[108:111], v[52:55]
    ds_read_b64_tr_b16 v[102:103], v252 offset:10240
    s_cselect_b32 s13, s5, s13
    v_mfma_f32_16x16x32_bf16 v[56:59], v[80:83], v[112:115], v[56:59]
    s_cselect_b32 s14, s30, s14
    v_mfma_f32_16x16x32_bf16 v[68:71], v[84:87], v[112:115], v[68:71]
    s_cselect_b32 s15, s30, s15
    v_mfma_f32_16x16x32_bf16 v[64:67], v[84:87], v[108:111], v[64:67]
    s_cselect_b32 s16, s30, s16
    v_mfma_f32_16x16x32_bf16 v[60:63], v[84:87], v[104:107], v[60:63]
    s_waitcnt vmcnt(12) lgkmcnt(4)
    v_mfma_f32_16x16x32_bf16 v[24:27], v[88:91], v[116:119], v[24:27]
    ds_read_b64_tr_b16 v[72:73], v255 offset:16384
    buffer_load_dwordx4 v[176:179], v251, s[28:31], s18 offen offset:0 sc1
    v_mfma_f32_16x16x32_bf16 v[28:31], v[88:91], v[120:123], v[28:31]
    ds_read_b64_tr_b16 v[74:75], v255 offset:18432
    v_mfma_f32_16x16x32_bf16 v[32:35], v[88:91], v[124:127], v[32:35]
    ds_read_b64_tr_b16 v[76:77], v254 offset:16384
    v_mfma_f32_16x16x32_bf16 v[44:47], v[92:95], v[124:127], v[44:47]
    ds_read_b64_tr_b16 v[78:79], v254 offset:18432
    v_mfma_f32_16x16x32_bf16 v[40:43], v[92:95], v[120:123], v[40:43]
    ds_read_b64_tr_b16 v[80:81], v253 offset:16384
    v_mfma_f32_16x16x32_bf16 v[36:39], v[92:95], v[116:119], v[36:39]
    ds_read_b64_tr_b16 v[82:83], v253 offset:18432
    s_waitcnt lgkmcnt(6)
    v_mfma_f32_16x16x32_bf16 v[48:51], v[96:99], v[116:119], v[48:51]
    ds_read_b64_tr_b16 v[84:85], v252 offset:16384
    v_mfma_f32_16x16x32_bf16 v[52:55], v[96:99], v[120:123], v[52:55]
    ds_read_b64_tr_b16 v[86:87], v252 offset:18432
    v_mfma_f32_16x16x32_bf16 v[56:59], v[96:99], v[124:127], v[56:59]
    buffer_load_dwordx4 v[180:183], v251, s[28:31], s18 offen offset:2048 sc1
    v_mfma_f32_16x16x32_bf16 v[68:71], v[100:103], v[124:127], v[68:71]
    buffer_load_dwordx4 v[184:187], v250, s[28:31], s18 offen offset:0 sc1
    v_mfma_f32_16x16x32_bf16 v[64:67], v[100:103], v[120:123], v[64:67]
    s_add_u32 s18, s18, 2097152
    v_mfma_f32_16x16x32_bf16 v[60:63], v[100:103], v[116:119], v[60:63]
    s_waitcnt vmcnt(12) lgkmcnt(4)
    v_mfma_f32_16x16x32_bf16 v[24:27], v[72:75], v[128:131], v[24:27]
    ds_read_b64_tr_b16 v[88:89], v255 offset:24576
    buffer_load_dwordx4 v[188:191], v251, s[28:31], s19 offen offset:0 sc1
    v_mfma_f32_16x16x32_bf16 v[28:31], v[72:75], v[132:135], v[28:31]
    ds_read_b64_tr_b16 v[90:91], v255 offset:26624
    v_mfma_f32_16x16x32_bf16 v[32:35], v[72:75], v[136:139], v[32:35]
    ds_read_b64_tr_b16 v[92:93], v254 offset:24576
    v_mfma_f32_16x16x32_bf16 v[44:47], v[76:79], v[136:139], v[44:47]
    ds_read_b64_tr_b16 v[94:95], v254 offset:26624
    v_mfma_f32_16x16x32_bf16 v[40:43], v[76:79], v[132:135], v[40:43]
    ds_read_b64_tr_b16 v[96:97], v253 offset:24576
    v_mfma_f32_16x16x32_bf16 v[36:39], v[76:79], v[128:131], v[36:39]
    ds_read_b64_tr_b16 v[98:99], v253 offset:26624
    s_waitcnt lgkmcnt(6)
    v_mfma_f32_16x16x32_bf16 v[48:51], v[80:83], v[128:131], v[48:51]
    ds_read_b64_tr_b16 v[100:101], v252 offset:24576
    v_mfma_f32_16x16x32_bf16 v[52:55], v[80:83], v[132:135], v[52:55]
    ds_read_b64_tr_b16 v[102:103], v252 offset:26624
    v_mfma_f32_16x16x32_bf16 v[56:59], v[80:83], v[136:139], v[56:59]
    buffer_load_dwordx4 v[192:195], v251, s[28:31], s19 offen offset:2048 sc1
    v_mfma_f32_16x16x32_bf16 v[68:71], v[84:87], v[136:139], v[68:71]
    buffer_load_dwordx4 v[196:199], v250, s[28:31], s19 offen offset:0 sc1
    v_mfma_f32_16x16x32_bf16 v[64:67], v[84:87], v[132:135], v[64:67]
    s_add_u32 s19, s19, 2097152
    v_mfma_f32_16x16x32_bf16 v[60:63], v[84:87], v[128:131], v[60:63]
    s_waitcnt vmcnt(12) lgkmcnt(4)
    v_mfma_f32_16x16x32_bf16 v[24:27], v[88:91], v[140:143], v[24:27]
    s_barrier
    ds_read_b64_tr_b16 v[72:73], v255 offset:32768
    v_mfma_f32_16x16x32_bf16 v[28:31], v[88:91], v[144:147], v[28:31]
    ds_read_b64_tr_b16 v[74:75], v255 offset:34816
    buffer_load_dwordx4 v[104:107], v251, s[28:31], s12 offen offset:0 sc1
    v_mfma_f32_16x16x32_bf16 v[32:35], v[88:91], v[148:151], v[32:35]
    ds_read_b64_tr_b16 v[76:77], v254 offset:32768
    v_mfma_f32_16x16x32_bf16 v[44:47], v[92:95], v[148:151], v[44:47]
    ds_read_b64_tr_b16 v[78:79], v254 offset:34816
    v_mfma_f32_16x16x32_bf16 v[40:43], v[92:95], v[144:147], v[40:43]
    ds_read_b64_tr_b16 v[80:81], v253 offset:32768
    v_mfma_f32_16x16x32_bf16 v[36:39], v[92:95], v[140:143], v[36:39]
    ds_read_b64_tr_b16 v[82:83], v253 offset:34816
    s_waitcnt lgkmcnt(6)
    v_mfma_f32_16x16x32_bf16 v[48:51], v[96:99], v[140:143], v[48:51]
    ds_read_b64_tr_b16 v[84:85], v252 offset:32768
    v_mfma_f32_16x16x32_bf16 v[52:55], v[96:99], v[144:147], v[52:55]
    ds_read_b64_tr_b16 v[86:87], v252 offset:34816
    v_mfma_f32_16x16x32_bf16 v[56:59], v[96:99], v[148:151], v[56:59]
    buffer_load_dwordx4 v[108:111], v251, s[28:31], s12 offen offset:2048 sc1
    v_mfma_f32_16x16x32_bf16 v[68:71], v[100:103], v[148:151], v[68:71]
    buffer_load_dwordx4 v[112:115], v250, s[28:31], s12 offen offset:0 sc1
    v_mfma_f32_16x16x32_bf16 v[64:67], v[100:103], v[144:147], v[64:67]
    s_add_u32 s12, s12, 2097152
    v_mfma_f32_16x16x32_bf16 v[60:63], v[100:103], v[140:143], v[60:63]
    s_waitcnt vmcnt(12) lgkmcnt(4)
    v_mfma_f32_16x16x32_bf16 v[24:27], v[72:75], v[152:155], v[24:27]
    ds_read_b64_tr_b16 v[88:89], v255 offset:40960
    buffer_load_dwordx4 v[116:119], v251, s[28:31], s13 offen offset:0 sc1
    v_mfma_f32_16x16x32_bf16 v[28:31], v[72:75], v[156:159], v[28:31]
    ds_read_b64_tr_b16 v[90:91], v255 offset:43008
    v_mfma_f32_16x16x32_bf16 v[32:35], v[72:75], v[160:163], v[32:35]
    ds_read_b64_tr_b16 v[92:93], v254 offset:40960
    v_mfma_f32_16x16x32_bf16 v[44:47], v[76:79], v[160:163], v[44:47]
    ds_read_b64_tr_b16 v[94:95], v254 offset:43008
    v_mfma_f32_16x16x32_bf16 v[40:43], v[76:79], v[156:159], v[40:43]
    ds_read_b64_tr_b16 v[96:97], v253 offset:40960
    v_mfma_f32_16x16x32_bf16 v[36:39], v[76:79], v[152:155], v[36:39]
    ds_read_b64_tr_b16 v[98:99], v253 offset:43008
    s_waitcnt lgkmcnt(6)
    v_mfma_f32_16x16x32_bf16 v[48:51], v[80:83], v[152:155], v[48:51]
    ds_read_b64_tr_b16 v[100:101], v252 offset:40960
    v_mfma_f32_16x16x32_bf16 v[52:55], v[80:83], v[156:159], v[52:55]
    ds_read_b64_tr_b16 v[102:103], v252 offset:43008
    v_mfma_f32_16x16x32_bf16 v[56:59], v[80:83], v[160:163], v[56:59]
    buffer_load_dwordx4 v[120:123], v251, s[28:31], s13 offen offset:2048 sc1
    v_mfma_f32_16x16x32_bf16 v[68:71], v[84:87], v[160:163], v[68:71]
    buffer_load_dwordx4 v[124:127], v250, s[28:31], s13 offen offset:0 sc1
    v_mfma_f32_16x16x32_bf16 v[64:67], v[84:87], v[156:159], v[64:67]
    s_add_u32 s13, s13, 2097152
    v_mfma_f32_16x16x32_bf16 v[60:63], v[84:87], v[152:155], v[60:63]
    s_waitcnt vmcnt(12) lgkmcnt(4)
    v_mfma_f32_16x16x32_bf16 v[24:27], v[88:91], v[164:167], v[24:27]
    ds_read_b64_tr_b16 v[72:73], v255 offset:49152
    buffer_load_dwordx4 v[128:131], v251, s[28:31], s14 offen offset:0 sc1
    v_mfma_f32_16x16x32_bf16 v[28:31], v[88:91], v[168:171], v[28:31]
    ds_read_b64_tr_b16 v[74:75], v255 offset:51200
    buffer_load_dwordx4 v[132:135], v251, s[28:31], s14 offen offset:2048 sc1
    v_mfma_f32_16x16x32_bf16 v[32:35], v[88:91], v[172:175], v[32:35]
    ds_read_b64_tr_b16 v[76:77], v254 offset:49152
    v_mfma_f32_16x16x32_bf16 v[44:47], v[92:95], v[172:175], v[44:47]
    ds_read_b64_tr_b16 v[78:79], v254 offset:51200
    v_mfma_f32_16x16x32_bf16 v[40:43], v[92:95], v[168:171], v[40:43]
    ds_read_b64_tr_b16 v[80:81], v253 offset:49152
    v_mfma_f32_16x16x32_bf16 v[36:39], v[92:95], v[164:167], v[36:39]
    ds_read_b64_tr_b16 v[82:83], v253 offset:51200
    s_waitcnt lgkmcnt(6)
    v_mfma_f32_16x16x32_bf16 v[48:51], v[96:99], v[164:167], v[48:51]
    ds_read_b64_tr_b16 v[84:85], v252 offset:49152
    v_mfma_f32_16x16x32_bf16 v[52:55], v[96:99], v[168:171], v[52:55]
    ds_read_b64_tr_b16 v[86:87], v252 offset:51200
    v_mfma_f32_16x16x32_bf16 v[56:59], v[96:99], v[172:175], v[56:59]
    buffer_load_dwordx4 v[136:139], v250, s[28:31], s14 offen offset:0 sc1
    v_mfma_f32_16x16x32_bf16 v[68:71], v[100:103], v[172:175], v[68:71]
    s_add_u32 s14, s14, 2097152
    v_mfma_f32_16x16x32_bf16 v[64:67], v[100:103], v[168:171], v[64:67]
    s_sub_u32 s56, 0, s56
    v_mfma_f32_16x16x32_bf16 v[60:63], v[100:103], v[164:167], v[60:63]
    s_waitcnt vmcnt(12) lgkmcnt(4)
    v_mfma_f32_16x16x32_bf16 v[24:27], v[72:75], v[176:179], v[24:27]
    ds_read_b64_tr_b16 v[88:89], v255 offset:57344
    buffer_load_dwordx4 v[140:143], v251, s[28:31], s15 offen offset:0 sc1
    v_mfma_f32_16x16x32_bf16 v[28:31], v[72:75], v[180:183], v[28:31]
    ds_read_b64_tr_b16 v[90:91], v255 offset:59392
    v_mfma_f32_16x16x32_bf16 v[32:35], v[72:75], v[184:187], v[32:35]
    ds_read_b64_tr_b16 v[92:93], v254 offset:57344
    v_mfma_f32_16x16x32_bf16 v[44:47], v[76:79], v[184:187], v[44:47]
    ds_read_b64_tr_b16 v[94:95], v254 offset:59392
    v_mfma_f32_16x16x32_bf16 v[40:43], v[76:79], v[180:183], v[40:43]
    ds_read_b64_tr_b16 v[96:97], v253 offset:57344
    v_mfma_f32_16x16x32_bf16 v[36:39], v[76:79], v[176:179], v[36:39]
    ds_read_b64_tr_b16 v[98:99], v253 offset:59392
    s_waitcnt lgkmcnt(6)
    v_mfma_f32_16x16x32_bf16 v[48:51], v[80:83], v[176:179], v[48:51]
    ds_read_b64_tr_b16 v[100:101], v252 offset:57344
    v_mfma_f32_16x16x32_bf16 v[52:55], v[80:83], v[180:183], v[52:55]
    ds_read_b64_tr_b16 v[102:103], v252 offset:59392
    v_mfma_f32_16x16x32_bf16 v[56:59], v[80:83], v[184:187], v[56:59]
    buffer_load_dwordx4 v[144:147], v251, s[28:31], s15 offen offset:2048 sc1
    v_mfma_f32_16x16x32_bf16 v[68:71], v[84:87], v[184:187], v[68:71]
    buffer_load_dwordx4 v[148:151], v250, s[28:31], s15 offen offset:0 sc1
    v_mfma_f32_16x16x32_bf16 v[64:67], v[84:87], v[180:183], v[64:67]
    s_add_u32 s15, s15, 2097152
    v_mfma_f32_16x16x32_bf16 v[60:63], v[84:87], v[176:179], v[60:63]
    s_waitcnt vmcnt(12) lgkmcnt(4)
    v_mfma_f32_16x16x32_bf16 v[24:27], v[88:91], v[188:191], v[24:27]
    s_barrier
    v_add_u32 v255, s56, v255
    ds_read_b64_tr_b16 v[72:73], v255 offset:0
    v_mfma_f32_16x16x32_bf16 v[28:31], v[88:91], v[192:195], v[28:31]
    ds_read_b64_tr_b16 v[74:75], v255 offset:2048
    buffer_load_dwordx4 v[152:155], v251, s[28:31], s16 offen offset:0 sc1
    v_mfma_f32_16x16x32_bf16 v[32:35], v[88:91], v[196:199], v[32:35]
    v_add_u32 v254, s56, v254
    ds_read_b64_tr_b16 v[76:77], v254 offset:0
    v_mfma_f32_16x16x32_bf16 v[44:47], v[92:95], v[196:199], v[44:47]
    ds_read_b64_tr_b16 v[78:79], v254 offset:2048
    buffer_load_dwordx4 v[156:159], v251, s[28:31], s16 offen offset:2048 sc1
    v_mfma_f32_16x16x32_bf16 v[40:43], v[92:95], v[192:195], v[40:43]
    v_add_u32 v253, s56, v253
    ds_read_b64_tr_b16 v[80:81], v253 offset:0
    v_mfma_f32_16x16x32_bf16 v[36:39], v[92:95], v[188:191], v[36:39]
    ds_read_b64_tr_b16 v[82:83], v253 offset:2048
    s_waitcnt lgkmcnt(6)
    v_mfma_f32_16x16x32_bf16 v[48:51], v[96:99], v[188:191], v[48:51]
    v_add_u32 v252, s56, v252
    ds_read_b64_tr_b16 v[84:85], v252 offset:0
    v_mfma_f32_16x16x32_bf16 v[52:55], v[96:99], v[192:195], v[52:55]
    ds_read_b64_tr_b16 v[86:87], v252 offset:2048
    buffer_load_dwordx4 v[160:163], v250, s[28:31], s16 offen offset:0 sc1
    v_mfma_f32_16x16x32_bf16 v[56:59], v[96:99], v[196:199], v[56:59]
    s_add_u32 s16, s16, 2097152
    v_mfma_f32_16x16x32_bf16 v[68:71], v[100:103], v[196:199], v[68:71]
    s_sub_u32 s57, s57, 1
    v_mfma_f32_16x16x32_bf16 v[64:67], v[100:103], v[192:195], v[64:67]
    s_cmp_lg_u32 s57, 0
    v_mfma_f32_16x16x32_bf16 v[60:63], v[100:103], v[188:191], v[60:63]
    s_cbranch_scc1 L2FC_loop
    s_waitcnt vmcnt(12) lgkmcnt(4)
    v_mfma_f32_16x16x32_bf16 v[24:27], v[72:75], v[104:107], v[24:27]
    ds_read_b64_tr_b16 v[88:89], v255 offset:8192
    v_mfma_f32_16x16x32_bf16 v[28:31], v[72:75], v[108:111], v[28:31]
    ds_read_b64_tr_b16 v[90:91], v255 offset:10240
    v_mfma_f32_16x16x32_bf16 v[32:35], v[72:75], v[112:115], v[32:35]
    ds_read_b64_tr_b16 v[92:93], v254 offset:8192
    v_mfma_f32_16x16x32_bf16 v[44:47], v[76:79], v[112:115], v[44:47]
    ds_read_b64_tr_b16 v[94:95], v254 offset:10240
    v_mfma_f32_16x16x32_bf16 v[40:43], v[76:79], v[108:111], v[40:43]
    ds_read_b64_tr_b16 v[96:97], v253 offset:8192
    v_mfma_f32_16x16x32_bf16 v[36:39], v[76:79], v[104:107], v[36:39]
    ds_read_b64_tr_b16 v[98:99], v253 offset:10240
    s_waitcnt lgkmcnt(6)
    v_mfma_f32_16x16x32_bf16 v[48:51], v[80:83], v[104:107], v[48:51]
    ds_read_b64_tr_b16 v[100:101], v252 offset:8192
    v_mfma_f32_16x16x32_bf16 v[52:55], v[80:83], v[108:111], v[52:55]
    ds_read_b64_tr_b16 v[102:103], v252 offset:10240
    v_mfma_f32_16x16x32_bf16 v[56:59], v[80:83], v[112:115], v[56:59]
    v_mfma_f32_16x16x32_bf16 v[68:71], v[84:87], v[112:115], v[68:71]
    v_mfma_f32_16x16x32_bf16 v[64:67], v[84:87], v[108:111], v[64:67]
    v_mfma_f32_16x16x32_bf16 v[60:63], v[84:87], v[104:107], v[60:63]
    s_waitcnt vmcnt(9) lgkmcnt(0)
    v_mfma_f32_16x16x32_bf16 v[48:51], v[96:99], v[116:119], v[48:51]
    v_mfma_f32_16x16x32_bf16 v[52:55], v[96:99], v[120:123], v[52:55]
    v_mfma_f32_16x16x32_bf16 v[56:59], v[96:99], v[124:127], v[56:59]
    v_mfma_f32_16x16x32_bf16 v[60:63], v[100:103], v[116:119], v[60:63]
    v_mfma_f32_16x16x32_bf16 v[64:67], v[100:103], v[120:123], v[64:67]
    v_mfma_f32_16x16x32_bf16 v[68:71], v[100:103], v[124:127], v[68:71]
    v_mfma_f32_16x16x32_bf16 v[24:27], v[88:91], v[116:119], v[24:27]
    s_nop 1
    ds_write_b128 v246, v[48:51] offset:0
    v_mfma_f32_16x16x32_bf16 v[28:31], v[88:91], v[120:123], v[28:31]
    ds_write_b128 v246, v[52:55] offset:1024
    v_mfma_f32_16x16x32_bf16 v[32:35], v[88:91], v[124:127], v[32:35]
    ds_write_b128 v246, v[56:59] offset:2048
    v_mfma_f32_16x16x32_bf16 v[36:39], v[92:95], v[116:119], v[36:39]
    ds_write_b128 v246, v[60:63] offset:3072
    v_mfma_f32_16x16x32_bf16 v[40:43], v[92:95], v[120:123], v[40:43]
    ds_write_b128 v246, v[64:67] offset:4096
    v_mfma_f32_16x16x32_bf16 v[44:47], v[92:95], v[124:127], v[44:47]
    ds_write_b128 v246, v[68:71] offset:5120
    s_waitcnt lgkmcnt(0)
    s_barrier
    ds_read_b128 v[72:75], v245 offset:0
    ds_read_b128 v[84:87], v245 offset:3072
    ds_read_b128 v[76:79], v245 offset:1024
    ds_read_b128 v[88:91], v245 offset:4096
    ds_read_b128 v[80:83], v245 offset:2048
    ds_read_b128 v[92:95], v245 offset:5120
    s_waitcnt lgkmcnt(5)
    v_pk_add_f32 v[24:25], v[24:25], v[72:73]
    v_pk_add_f32 v[26:27], v[26:27], v[74:75]
    v_cvt_pk_bf16_f32 v200, v24, v25
    v_cvt_pk_bf16_f32 v201, v26, v27
    ds_write_b64 v244, v[200:201] offset:32768
    s_waitcnt lgkmcnt(5)
    v_pk_add_f32 v[36:37], v[36:37], v[84:85]
    v_pk_add_f32 v[38:39], v[38:39], v[86:87]
    v_cvt_pk_bf16_f32 v202, v36, v37
    v_cvt_pk_bf16_f32 v203, v38, v39
    ds_write_b64 v244, v[202:203] offset:32800
    ds_read_b128 v[212:215], v243 offset:32768
    s_waitcnt lgkmcnt(6)
    v_pk_add_f32 v[28:29], v[28:29], v[76:77]
    v_pk_add_f32 v[30:31], v[30:31], v[78:79]
    v_cvt_pk_bf16_f32 v204, v28, v29
    v_cvt_pk_bf16_f32 v205, v30, v31
    ds_write_b64 v244, v[204:205] offset:34048
    s_waitcnt lgkmcnt(6)
    v_pk_add_f32 v[40:41], v[40:41], v[88:89]
    v_pk_add_f32 v[42:43], v[42:43], v[90:91]
    v_cvt_pk_bf16_f32 v206, v40, v41
    v_cvt_pk_bf16_f32 v207, v42, v43
    ds_write_b64 v244, v[206:207] offset:34080
    ds_read_b128 v[216:219], v243 offset:34048
    s_waitcnt lgkmcnt(7)
    v_pk_add_f32 v[32:33], v[32:33], v[80:81]
    v_pk_add_f32 v[34:35], v[34:35], v[82:83]
    v_cvt_pk_bf16_f32 v208, v32, v33
    v_cvt_pk_bf16_f32 v209, v34, v35
    ds_write_b64 v244, v[208:209] offset:35328
    s_waitcnt lgkmcnt(7)
    v_pk_add_f32 v[44:45], v[44:45], v[92:93]
    v_pk_add_f32 v[46:47], v[46:47], v[94:95]
    v_cvt_pk_bf16_f32 v210, v44, v45
    v_cvt_pk_bf16_f32 v211, v46, v47
    ds_write_b64 v244, v[210:211] offset:35360
    ds_read_b128 v[220:223], v243 offset:35328
    s_waitcnt lgkmcnt(6)
    buffer_store_dwordx4 v[212:215], v247, s[44:47], s6 offen
    s_waitcnt lgkmcnt(3)
    buffer_store_dwordx4 v[216:219], v247, s[44:47], s7 offen
    s_waitcnt lgkmcnt(0)
    buffer_store_dwordx4 v[220:223], v247, s[44:47], s8 offen
    s_endpgm
L_FC1:
    s_barrier
    ds_read_b64_tr_b16 v[188:189], v4 offset:0
    ds_read_b64_tr_b16 v[190:191], v4 offset:6144
    ds_read_b128 v[152:155], v12 offset:8192
    ds_read_b128 v[156:159], v12 offset:10240
    ds_read_b128 v[160:163], v12 offset:12288
    ds_read_b128 v[164:167], v12 offset:14336
    ds_read_b64_tr_b16 v[192:193], v5 offset:0
    ds_read_b64_tr_b16 v[194:195], v5 offset:6144
    ds_read_b64_tr_b16 v[196:197], v6 offset:0
    ds_read_b64_tr_b16 v[198:199], v6 offset:6144
    s_mov_b32 s57, 10
.p2align 6
LFC1_loop:
    s_waitcnt lgkmcnt(4)
    v_mfma_f32_16x16x32_bf16 v[28:31], v[188:191], v[152:155], v[28:31]
    ds_read_b64_tr_b16 v[200:201], v7 offset:0
    s_add_u32 s55, s55, 12288
    v_mfma_f32_16x16x32_bf16 v[32:35], v[188:191], v[156:159], v[32:35]
    ds_read_b64_tr_b16 v[202:203], v7 offset:6144
    s_cmp_ge_u32 s55, 134144
    v_mfma_f32_16x16x32_bf16 v[36:39], v[188:191], v[160:163], v[36:39]
    s_cselect_b32 s55, 72704, s55
    v_add_u32 v16, s55, v8
    v_mfma_f32_16x16x32_bf16 v[40:43], v[188:191], v[164:167], v[40:43]
    v_add_u32 v17, s55, v9
    s_waitcnt lgkmcnt(4)
    v_mfma_f32_16x16x32_bf16 v[56:59], v[192:195], v[164:167], v[56:59]
    ds_read_b64_tr_b16 v[204:205], v4 offset:128
    v_mfma_f32_16x16x32_bf16 v[52:55], v[192:195], v[160:163], v[52:55]
    ds_read_b64_tr_b16 v[206:207], v4 offset:6272
    v_add_u32 v18, s55, v10
    v_mfma_f32_16x16x32_bf16 v[48:51], v[192:195], v[156:159], v[48:51]
    v_mfma_f32_16x16x32_bf16 v[44:47], v[192:195], v[152:155], v[44:47]
    v_add_u32 v19, s55, v11
    s_waitcnt lgkmcnt(4)
    v_mfma_f32_16x16x32_bf16 v[60:63], v[196:199], v[152:155], v[60:63]
    ds_read_b64_tr_b16 v[208:209], v5 offset:128
    v_mfma_f32_16x16x32_bf16 v[64:67], v[196:199], v[156:159], v[64:67]
    ds_read_b64_tr_b16 v[210:211], v5 offset:6272
    v_mfma_f32_16x16x32_bf16 v[68:71], v[196:199], v[160:163], v[68:71]
    v_mfma_f32_16x16x32_bf16 v[72:75], v[196:199], v[164:167], v[72:75]
    s_waitcnt lgkmcnt(4)
    v_mfma_f32_16x16x32_bf16 v[88:91], v[200:203], v[164:167], v[88:91]
    v_mfma_f32_16x16x32_bf16 v[84:87], v[200:203], v[160:163], v[84:87]
    v_mfma_f32_16x16x32_bf16 v[124:127], v[200:203], v[184:187], v[124:127]
    v_mfma_f32_16x16x32_bf16 v[80:83], v[200:203], v[156:159], v[80:83]
    s_barrier
    ds_read_b64_tr_b16 v[188:189], v16 offset:0
    v_mfma_f32_16x16x32_bf16 v[76:79], v[200:203], v[152:155], v[76:79]
    ds_read_b64_tr_b16 v[190:191], v16 offset:6144
    s_waitcnt lgkmcnt(4)
    v_mfma_f32_16x16x32_bf16 v[92:95], v[204:207], v[152:155], v[92:95]
    ds_read_b128 v[168:171], v13 offset:8192
    v_mfma_f32_16x16x32_bf16 v[96:99], v[204:207], v[156:159], v[96:99]
    ds_read_b128 v[172:175], v13 offset:10240
    v_mfma_f32_16x16x32_bf16 v[128:131], v[204:207], v[184:187], v[128:131]
    ds_read_b128 v[176:179], v13 offset:12288
    v_mfma_f32_16x16x32_bf16 v[100:103], v[204:207], v[160:163], v[100:103]
    ds_read_b128 v[180:183], v13 offset:14336
    v_mfma_f32_16x16x32_bf16 v[104:107], v[204:207], v[164:167], v[104:107]
    ds_read_b64_tr_b16 v[192:193], v17 offset:0
    s_waitcnt lgkmcnt(7)
    v_mfma_f32_16x16x32_bf16 v[120:123], v[208:211], v[164:167], v[120:123]
    ds_read_b64_tr_b16 v[194:195], v17 offset:6144
    v_mfma_f32_16x16x32_bf16 v[116:119], v[208:211], v[160:163], v[116:119]
    ds_read_b64_tr_b16 v[196:197], v18 offset:0
    v_mfma_f32_16x16x32_bf16 v[132:135], v[208:211], v[184:187], v[132:135]
    ds_read_b64_tr_b16 v[198:199], v18 offset:6144
    v_mfma_f32_16x16x32_bf16 v[112:115], v[208:211], v[156:159], v[112:115]
    v_mfma_f32_16x16x32_bf16 v[108:111], v[208:211], v[152:155], v[108:111]
    s_waitcnt lgkmcnt(4)
    v_mfma_f32_16x16x32_bf16 v[28:31], v[188:191], v[168:171], v[28:31]
    ds_read_b64_tr_b16 v[200:201], v19 offset:0
    s_add_u32 s55, s55, 12288
    v_mfma_f32_16x16x32_bf16 v[32:35], v[188:191], v[172:175], v[32:35]
    ds_read_b64_tr_b16 v[202:203], v19 offset:6144
    s_cmp_ge_u32 s55, 134144
    v_mfma_f32_16x16x32_bf16 v[36:39], v[188:191], v[176:179], v[36:39]
    s_cselect_b32 s55, 72704, s55
    v_add_u32 v4, s55, v8
    v_mfma_f32_16x16x32_bf16 v[40:43], v[188:191], v[180:183], v[40:43]
    v_add_u32 v5, s55, v9
    s_waitcnt lgkmcnt(4)
    v_mfma_f32_16x16x32_bf16 v[56:59], v[192:195], v[180:183], v[56:59]
    ds_read_b64_tr_b16 v[204:205], v16 offset:128
    v_mfma_f32_16x16x32_bf16 v[52:55], v[192:195], v[176:179], v[52:55]
    ds_read_b64_tr_b16 v[206:207], v16 offset:6272
    v_add_u32 v6, s55, v10
    v_mfma_f32_16x16x32_bf16 v[48:51], v[192:195], v[172:175], v[48:51]
    v_mfma_f32_16x16x32_bf16 v[44:47], v[192:195], v[168:171], v[44:47]
    v_add_u32 v7, s55, v11
    s_add_u32 s56, s56, 16384
    s_waitcnt lgkmcnt(4)
    v_mfma_f32_16x16x32_bf16 v[60:63], v[196:199], v[168:171], v[60:63]
    ds_read_b64_tr_b16 v[208:209], v17 offset:128
    s_cmp_ge_u32 s56, 72704
    v_mfma_f32_16x16x32_bf16 v[64:67], v[196:199], v[172:175], v[64:67]
    ds_read_b64_tr_b16 v[210:211], v17 offset:6272
    s_cselect_b32 s56, 23552, s56
    v_mfma_f32_16x16x32_bf16 v[68:71], v[196:199], v[176:179], v[68:71]
    v_add_u32 v12, s56, v14
    v_mfma_f32_16x16x32_bf16 v[72:75], v[196:199], v[180:183], v[72:75]
    s_waitcnt lgkmcnt(4)
    v_mfma_f32_16x16x32_bf16 v[88:91], v[200:203], v[180:183], v[88:91]
    v_mfma_f32_16x16x32_bf16 v[84:87], v[200:203], v[176:179], v[84:87]
    v_mfma_f32_16x16x32_bf16 v[124:127], v[200:203], v[184:187], v[124:127]
    v_add_u32 v13, s56, v15
    s_sub_u32 s57, s57, 1
    s_cmp_lg_u32 s57, 0
    v_mfma_f32_16x16x32_bf16 v[80:83], v[200:203], v[172:175], v[80:83]
    s_barrier
    ds_read_b64_tr_b16 v[188:189], v4 offset:0
    v_mfma_f32_16x16x32_bf16 v[76:79], v[200:203], v[168:171], v[76:79]
    ds_read_b64_tr_b16 v[190:191], v4 offset:6144
    s_waitcnt lgkmcnt(4)
    v_mfma_f32_16x16x32_bf16 v[92:95], v[204:207], v[168:171], v[92:95]
    ds_read_b128 v[152:155], v12 offset:8192
    v_mfma_f32_16x16x32_bf16 v[96:99], v[204:207], v[172:175], v[96:99]
    ds_read_b128 v[156:159], v12 offset:10240
    v_mfma_f32_16x16x32_bf16 v[128:131], v[204:207], v[184:187], v[128:131]
    ds_read_b128 v[160:163], v12 offset:12288
    v_mfma_f32_16x16x32_bf16 v[100:103], v[204:207], v[176:179], v[100:103]
    ds_read_b128 v[164:167], v12 offset:14336
    v_mfma_f32_16x16x32_bf16 v[104:107], v[204:207], v[180:183], v[104:107]
    ds_read_b64_tr_b16 v[192:193], v5 offset:0
    s_waitcnt lgkmcnt(7)
    v_mfma_f32_16x16x32_bf16 v[120:123], v[208:211], v[180:183], v[120:123]
    ds_read_b64_tr_b16 v[194:195], v5 offset:6144
    v_mfma_f32_16x16x32_bf16 v[116:119], v[208:211], v[176:179], v[116:119]
    ds_read_b64_tr_b16 v[196:197], v6 offset:0
    v_mfma_f32_16x16x32_bf16 v[132:135], v[208:211], v[184:187], v[132:135]
    ds_read_b64_tr_b16 v[198:199], v6 offset:6144
    v_mfma_f32_16x16x32_bf16 v[112:115], v[208:211], v[172:175], v[112:115]
    v_mfma_f32_16x16x32_bf16 v[108:111], v[208:211], v[168:171], v[108:111]
    s_cbranch_scc1 LFC1_loop
    s_mov_b32 exec_lo, 0x00010001
    s_mov_b32 exec_hi, 0x00010001
    ds_write_b128 v242, v[124:127] offset:2112
    ds_write_b128 v242, v[128:131] offset:2176
    ds_write_b128 v242, v[132:135] offset:2240
    s_mov_b64 exec, -1
    s_branch LFC_common
L_end:
    s_endpgm

.section .rodata,"a"
.p2align 6
.amdhsa_kernel parallel_sum__sliding_local_dilated__dense_activation_silu__prompt_kernel
  .amdhsa_next_free_vgpr 256
  .amdhsa_next_free_sgpr 102
  .amdhsa_accum_offset 256
  .amdhsa_group_segment_fixed_size 0
  .amdhsa_kernarg_size 72
  .amdhsa_user_sgpr_count 2
  .amdhsa_user_sgpr_kernarg_segment_ptr 1
  .amdhsa_system_sgpr_workgroup_id_x 1
  .amdhsa_float_denorm_mode_32 3
.end_amdhsa_kernel
```
